```python
import torch

def _softmax(x, axis=-1):
    return torch.softmax(x, dim=axis)
def _gelu(x):
    return torch.nn.functional.gelu(x, approximate="tanh")
def _silu(x):
    return torch.nn.functional.silu(x)
def _sigmoid(x):
    return torch.sigmoid(x)
def _layernorm(x, axis=-1, eps=1e-5):
    m = x.mean(dim=axis, keepdim=True)
    v = x.var(dim=axis, keepdim=True, unbiased=False)
    return (x - m) / torch.sqrt(v + eps)
def _scatter_add(tgt, idx, src, axis=0):
    return tgt.clone().index_add_(axis, idx, src)
def _segment_sum(src, seg, n):
    out = torch.zeros((n,) + src.shape[1:], dtype=src.dtype)
    return out.index_add_(0, seg, src)
def _pad(x, pw):
    flat = tuple(v for pair in reversed(pw) for v in pair)
    return torch.nn.functional.pad(x, flat)

kernel_name = 'sequential_preLN__sliding_block__mixer_channel_mlp__prompt'

def setup_inputs():

    _w = (lambda a: (lambda t: t.to(torch.bfloat16) if t.is_floating_point() else t)(torch.as_tensor(a)))
    def _A_setup():
        B, S, D = 1, 2048, 1024
        return {
            "x": _w((lambda *s: torch.randn(*s, dtype=torch.bfloat16) * 0.05)(B, S, D)),
            "wqkv": _w((lambda *s: torch.randn(*s, dtype=torch.bfloat16) * 0.05)(D, 3 * D)),
            "wo": _w((lambda *s: torch.randn(*s, dtype=torch.bfloat16) * 0.05)(D, D)),
        }
    _A_in = _A_setup()

    def _B_setup():
        B, S, D, F = 1, 2048, 1024, 3584
        return {
            "x": _w((lambda *s: torch.randn(*s, dtype=torch.bfloat16) * 0.05)(B, S, D)),
            "w1": _w((lambda *s: torch.randn(*s, dtype=torch.bfloat16) * 3.2)(D, F) * (D ** -0.5)),
            "b1": _w((lambda *s: torch.randn(*s, dtype=torch.bfloat16) * 1.6)(F)),
            "w2": _w((lambda *s: torch.randn(*s, dtype=torch.bfloat16) * 0.4)(F, D) * (F ** -0.5)),
            "b2": _w((lambda *s: torch.randn(*s, dtype=torch.bfloat16) * 0.8)(D)),
        }
    _B_in = _B_setup()

    return {
        "A_x": _A_in["x"],
        "A_wqkv": _A_in["wqkv"],
        "A_wo": _A_in["wo"],
        "B_x": _B_in["x"],
        "B_w1": _B_in["w1"],
        "B_b1": _B_in["b1"],
        "B_w2": _B_in["w2"],
        "B_b2": _B_in["b2"],
    }

def reference(A_x, A_wqkv, A_wo, B_x, B_w1, B_b1, B_w2, B_b2):
    def _A_ref(x, wqkv, wo):
        B, S, D = x.shape
        H = 32; Dh = D // H; W = 256
        qkv = (lambda x, *d: x.permute(*d))((x @ wqkv).reshape(B, S, 3, H, Dh), 2, 0, 3, 1, 4)
        q, k, v = qkv[0], qkv[1], qkv[2]
        scores = torch.einsum("bhqd,bhkd->bhqk", q, k) * (Dh ** -0.5)
        idx = torch.arange(S)
        mask = (idx[:, None] - idx[None, :] >= 0) & (idx[:, None] - idx[None, :] < W)
        scores = torch.where(mask[None, None], scores, -1e9)
        p = _softmax(scores, axis=-1)
        o = torch.einsum("bhqk,bhkd->bhqd", p, v)
        return (lambda x, *d: x.permute(*d))(o, 0, 2, 1, 3).reshape(B, S, D) @ wo

    def _B_ref(x, w1, b1, w2, b2):
        y = _layernorm(x, axis=-1)
        h = _gelu(torch.einsum("bsd,df->bsf", y, w1) + b1)
        return torch.einsum("bsf,fd->bsd", h, w2) + b2

    x = A_x
    h = x + _A_ref(_layernorm(x, axis=-1), A_wqkv, A_wo)
    h2 = h + _B_ref(_layernorm(h, axis=-1), B_w1, B_b1, B_w2, B_b2)
    return h2
```

```asm
; @launch kernel=qa_kernel grid=(256,1,1) block=(512,1,1) lds=163840
.amdgcn_target "amdgcn-amd-amdhsa--gfx950"
.text
.p2align 8
.globl qa_kernel
.type qa_kernel,@function
qa_kernel:
    s_cmp_ge_u32 s2, 256
    s_cbranch_scc1 L_end_1
    s_getpc_b64 s[46:47]
L_pc_4:
    v_lshrrev_b32 v2, 5, v0
    v_and_b32 v3, 1, v0
    s_lshr_b32 s3, s2, 3
    s_lshl_b32 s3, s3, 4
    v_add3_u32 v2, v2, v3, s3
    v_lshlrev_b32 v2, 7, v2
    v_min_u32 v2, L_code_end-L_pc_4-4, v2
    s_mov_b64 exec, 3
    global_load_dword v254, v2, s[46:47]
    s_mov_b64 exec, -1
    s_load_dwordx2 s[24:25], s[0:1], 80
    s_load_dwordx2 s[58:59], s[0:1], 0
    s_load_dwordx2 s[26:27], s[0:1], 8
    s_memrealtime s[34:35]
    s_and_b32 s3, s2, 7
    s_lshr_b32 s46, s2, 3
    s_and_b32 s29, s3, 3
    s_lshl_b32 s29, s29, 3
    s_and_b32 s47, s46, 7
    s_add_u32 s29, s29, s47
    s_lshr_b32 s28, s3, 2
    s_lshl_b32 s28, s28, 2
    s_lshr_b32 s47, s46, 3
    s_add_u32 s28, s28, s47
    v_writelane_b32 v255, 0, 3
    v_writelane_b32 v255, 0, 5
    v_writelane_b32 v255, 0, 6
    v_writelane_b32 v255, 0, 7
Q_go:
    s_lshl_b32 s99, s28, 5
    s_add_u32 s99, s99, s29
    s_lshl_b32 s98, s28, 8
    v_and_b32 v1, 63, v0
    v_lshrrev_b32 v18, 6, v0
    s_nop 0
    v_readfirstlane_b32 s49, v18
    s_nop 3
    s_and_b32 s30, s49, 3
    s_mov_b32 s45, 1
    s_mov_b32 s101, 0
    s_mov_b32 s50, 0
    s_mov_b32 s51, 0
    s_mov_b32 s100, 98304
    s_cmp_ge_u32 s49, 4
    s_cbranch_scc1 L_loader_2
    s_waitcnt lgkmcnt(0)
    s_mov_b32 s4, s58
    s_mov_b32 s5, s59
    s_and_b32 s5, s5, 0xffff
    s_mov_b32 s6, 4194304
    s_mov_b32 s7, 0x00020000
    s_mov_b32 s8, s26
    s_mov_b32 s9, s27
    s_and_b32 s9, s9, 0xffff
    s_mov_b32 s10, 6291456
    s_mov_b32 s11, 0x00020000
    s_add_u32 s12, s24, 12582912
    s_addc_u32 s13, s25, 0
    s_and_b32 s13, s13, 0xffff
    s_mov_b32 s14, 4194304
    s_mov_b32 s15, 0x00020000
    s_add_u32 s16, s24, 4194304
    s_addc_u32 s17, s25, 0
    s_and_b32 s17, s17, 0xffff
    s_mov_b32 s18, 8388608
    s_mov_b32 s19, 0x00020000
    s_add_u32 s20, s34, 0x1000000
    s_addc_u32 s21, s35, 0
    s_add_u32 s36, s24, 3145728
    s_addc_u32 s37, s25, 0
    s_and_b32 s37, s37, 0xffff
    s_mov_b32 s38, 131072
    s_mov_b32 s39, 0x00020000
    v_mov_b32 v218, 0
    v_mov_b32 v219, 0
    v_mov_b32 v240, 0
    v_writelane_b32 v255, s34, 1
    v_writelane_b32 v255, s35, 2
    s_lshl_b32 s3, s2, 2
    s_add_u32 s93, s3, s30
    s_load_dwordx2 s[76:77], s[0:1], 16
    s_waitcnt lgkmcnt(0)
    s_mov_b32 s84, s76
    s_mov_b32 s85, s77
    s_and_b32 s85, s85, 0xffff
    s_mov_b32 s86, 2097152
    s_mov_b32 s87, 0x00020000
    s_mul_i32 s92, s93, 2048
    s_lshr_b32 s3, s2, 3
    s_lshl_b32 s3, s3, 2
    s_add_u32 s3, s3, s30
    s_lshl_b32 s92, s3, 14
    s_and_b32 s3, s2, 3
    s_mul_i32 s3, s3, 512
    s_add_u32 s92, s92, s3
    s_lshr_b32 s3, s2, 3
    s_lshl_b32 s3, s3, 2
    s_add_u32 s3, s3, s30
    v_lshrrev_b32 v18, 2, v1
    v_and_b32 v19, 3, v1
    v_lshlrev_b32 v19, 7, v19
    s_lshr_b32 s46, s28, 2
    s_lshl_b32 s46, s46, 10
    s_lshl_b32 s47, s3, 4
    s_add_u32 s46, s46, s47
    s_lshl_b32 s40, s46, 11
    s_sub_u32 s46, s3, 64
    s_lshr_b32 s47, s46, 4
    s_and_b32 s46, s46, 15
    s_mul_i32 s46, s46, 98304
    s_lshl_b32 s47, s47, 11
    s_add_u32 s46, s46, s47
    s_lshr_b32 s47, s29, 3
    s_lshl_b32 s47, s47, 9
    s_add_u32 s46, s46, s47
    s_cmp_ge_u32 s3, 112
    s_cselect_b32 s46, 0x60000000, s46
    s_mov_b32 s41, 1572864
    s_mov_b32 s47, 6144
    s_cmp_lt_u32 s3, 64
    s_cselect_b32 s40, s40, s46
    s_cselect_b32 s41, 512, s41
    s_cselect_b32 s47, 2048, s47
    s_cselect_b32 s88, s4, s8
    s_cselect_b32 s89, s5, s9
    s_cselect_b32 s90, s6, s10
    s_cselect_b32 s91, s7, s11
    v_mul_u32_u24 v18, s47, v18
    v_add_u32 v221, v18, v19
    s_cselect_b32 exec_lo, 0xcccccccc, -1
    s_cselect_b32 exec_hi, 0xcccccccc, -1
    s_lshr_b32 s3, s41, 1
    s_sub_u32 s40, s40, s3
    buffer_load_dword v232, v221, s[88:91], s40 offen
    s_add_u32 s40, s40, s41
    s_mov_b64 exec, -1
    buffer_load_dword v232, v221, s[88:91], s40 offen
    s_add_u32 s40, s40, s41
    s_cmp_lt_u32 s2, 224
    s_cbranch_scc1 L_vote_5
    s_load_dwordx2 s[52:53], s[0:1], 72
    s_sub_u32 s3, s2, 224
    s_lshl_b32 s3, s3, 2
    s_add_u32 s3, s3, s30
    s_lshr_b32 s46, s3, 5
    s_lshl_b32 s46, s46, 14
    s_and_b32 s3, s3, 31
    s_lshl_b32 s3, s3, 8
    s_add_u32 s46, s46, s3
    s_and_b32 s3, s30, 1
    s_lshl_b32 s3, s3, 13
    s_add_u32 s46, s46, s3
    s_add_u32 s46, s46, 22806528
    s_xor_b32 s47, s46, 0x2000
    s_load_dword s54, s[24:25], s46 offset:262144
    s_waitcnt lgkmcnt(0)
    s_memtime s[54:55]
    s_waitcnt lgkmcnt(0)
    s_load_dword s3, s[24:25], s46 offset:0
    s_waitcnt lgkmcnt(0)
    s_memtime s[56:57]
    s_waitcnt lgkmcnt(0)
    s_sub_u32 s48, s56, s54
    s_memtime s[54:55]
    s_waitcnt lgkmcnt(0)
    s_load_dword s3, s[24:25], s47 offset:0
    s_waitcnt lgkmcnt(0)
    s_memtime s[56:57]
    s_waitcnt lgkmcnt(0)
    s_sub_u32 s94, s56, s54
    s_memtime s[54:55]
    s_waitcnt lgkmcnt(0)
    s_load_dword s3, s[24:25], s47 offset:65536
    s_waitcnt lgkmcnt(0)
    s_memtime s[56:57]
    s_waitcnt lgkmcnt(0)
    s_sub_u32 s95, s56, s54
    s_memtime s[54:55]
    s_waitcnt lgkmcnt(0)
    s_load_dword s3, s[24:25], s46 offset:65536
    s_waitcnt lgkmcnt(0)
    s_memtime s[56:57]
    s_waitcnt lgkmcnt(0)
    s_sub_u32 s22, s56, s54
    s_min_u32 s48, s48, s22
    s_min_u32 s94, s94, s95
    s_cmp_lt_u32 s48, s94
    s_cselect_b32 s3, 0, 1
    s_xor_b32 s3, s3, s30
    s_lshr_b32 s46, s2, 2
    s_xor_b32 s3, s3, s46
    s_and_b32 s3, s3, 1
    s_add_u32 s3, s3, 0x10000
    s_and_b32 s53, s53, 0xffff
    s_movk_i32 s54, 256
    s_mov_b32 s55, 0x00020000
    v_mov_b32 v236, s3
    s_mov_b64 exec, 1
    buffer_atomic_add v236, off, s[52:55], 0 offset:4 sc0 sc1
    s_mov_b64 exec, -1
L_vote_5:
L_cpass_6:
    v_lshrrev_b32 v220, 3, v1
    v_lshlrev_b32 v220, 11, v220
    v_and_b32 v18, 7, v1
    v_lshl_add_u32 v220, v18, 6, v220
    v_and_b32 v18, 15, v1
    s_lshl_b32 s3, s30, 6
    v_add_u32 v18, s3, v18
    v_lshlrev_b32 v18, 7, v18
    v_lshrrev_b32 v19, 4, v1
    v_bfe_u32 v20, v1, 1, 3
    v_xor_b32 v21, v19, v20
    v_lshl_add_u32 v2, v21, 4, v18
    v_xor_b32 v21, 4, v21
    v_lshl_add_u32 v3, v21, 4, v18
    v_bfe_u32 v18, v1, 2, 2
    v_lshl_add_u32 v20, v19, 3, v18
    v_and_b32 v21, 1, v19
    v_mul_u32_u24 v20, 64, v20
    v_and_b32 v18, 3, v1
    v_lshl_add_u32 v20, v18, 3, v20
    v_add_u32 v20, 32768, v20
    v_xor_b32 v18, 0, v21
    v_lshl_add_u32 v18, v18, 5, v20
    v_add_u32 v4, 0, v18
    v_xor_b32 v18, 1, v21
    v_lshl_add_u32 v18, v18, 5, v20
    v_add_u32 v5, 0, v18
    v_xor_b32 v18, 0, v21
    v_lshl_add_u32 v18, v18, 5, v20
    v_add_u32 v6, 4096, v18
    v_xor_b32 v18, 1, v21
    v_lshl_add_u32 v18, v18, 5, v20
    v_add_u32 v7, 4096, v18
    v_xor_b32 v18, 0, v21
    v_lshl_add_u32 v18, v18, 5, v20
    v_add_u32 v8, 8192, v18
    v_xor_b32 v18, 1, v21
    v_lshl_add_u32 v18, v18, 5, v20
    v_add_u32 v9, 8192, v18
    v_mov_b32 v108, 0
    v_mov_b32 v109, 0
    v_mov_b32 v110, 0
    v_mov_b32 v111, 0
    v_mov_b32 v112, 0
    v_mov_b32 v113, 0
    v_mov_b32 v114, 0
    v_mov_b32 v115, 0
    v_mov_b32 v116, 0
    v_mov_b32 v117, 0
    v_mov_b32 v118, 0
    v_mov_b32 v119, 0
    v_mov_b32 v120, 0
    v_mov_b32 v121, 0
    v_mov_b32 v122, 0
    v_mov_b32 v123, 0
    v_mov_b32 v124, 0
    v_mov_b32 v125, 0
    v_mov_b32 v126, 0
    v_mov_b32 v127, 0
    v_mov_b32 v128, 0
    v_mov_b32 v129, 0
    v_mov_b32 v130, 0
    v_mov_b32 v131, 0
    v_mov_b32 v132, 0
    v_mov_b32 v133, 0
    v_mov_b32 v134, 0
    v_mov_b32 v135, 0
    v_mov_b32 v136, 0
    v_mov_b32 v137, 0
    v_mov_b32 v138, 0
    v_mov_b32 v139, 0
    v_mov_b32 v140, 0
    v_mov_b32 v141, 0
    v_mov_b32 v142, 0
    v_mov_b32 v143, 0
    v_mov_b32 v144, 0
    v_mov_b32 v145, 0
    v_mov_b32 v146, 0
    v_mov_b32 v147, 0
    v_mov_b32 v148, 0
    v_mov_b32 v149, 0
    v_mov_b32 v150, 0
    v_mov_b32 v151, 0
    v_mov_b32 v152, 0
    v_mov_b32 v153, 0
    v_mov_b32 v154, 0
    v_mov_b32 v155, 0
    v_mov_b32 v156, 0
    v_mov_b32 v157, 0
    v_mov_b32 v158, 0
    v_mov_b32 v159, 0
    v_mov_b32 v160, 0
    v_mov_b32 v161, 0
    v_mov_b32 v162, 0
    v_mov_b32 v163, 0
    v_mov_b32 v164, 0
    v_mov_b32 v165, 0
    v_mov_b32 v166, 0
    v_mov_b32 v167, 0
    v_mov_b32 v168, 0
    v_mov_b32 v169, 0
    v_mov_b32 v170, 0
    v_mov_b32 v171, 0
    v_mov_b32 v172, 0
    v_mov_b32 v173, 0
    v_mov_b32 v174, 0
    v_mov_b32 v175, 0
    v_mov_b32 v176, 0
    v_mov_b32 v177, 0
    v_mov_b32 v178, 0
    v_mov_b32 v179, 0
    v_mov_b32 v180, 0
    v_mov_b32 v181, 0
    v_mov_b32 v182, 0
    v_mov_b32 v183, 0
    v_mov_b32 v184, 0
    v_mov_b32 v185, 0
    v_mov_b32 v186, 0
    v_mov_b32 v187, 0
    v_mov_b32 v188, 0
    v_mov_b32 v189, 0
    v_mov_b32 v190, 0
    v_mov_b32 v191, 0
    v_mov_b32 v192, 0
    v_mov_b32 v193, 0
    v_mov_b32 v194, 0
    v_mov_b32 v195, 0
    v_mov_b32 v196, 0
    v_mov_b32 v197, 0
    v_mov_b32 v198, 0
    v_mov_b32 v199, 0
    v_mov_b32 v200, 0
    v_mov_b32 v201, 0
    v_mov_b32 v202, 0
    v_mov_b32 v203, 0
    v_mov_b32 v204, 0
    v_mov_b32 v205, 0
    v_mov_b32 v206, 0
    v_mov_b32 v207, 0
    v_mov_b32 v208, 0
    v_mov_b32 v209, 0
    v_mov_b32 v210, 0
    v_mov_b32 v211, 0
    v_mov_b32 v212, 0x3f803f80
    v_mov_b32 v213, 0x3f803f80
    v_mov_b32 v214, 0x3f803f80
    v_mov_b32 v215, 0x3f803f80
    s_mov_b32 s42, 0
    s_barrier
    v_add_u32 v10, s42, v2
    v_add_u32 v11, s42, v3
    v_add_u32 v12, s42, v4
    v_add_u32 v13, s42, v5
    v_add_u32 v14, s42, v6
    v_add_u32 v15, s42, v7
    v_add_u32 v16, s42, v8
    v_add_u32 v17, s42, v9
    s_add_u32 s42, s42, 45056
    s_cmp_ge_u32 s42, 135168
    s_cselect_b32 s42, 0, s42
    s_nop 0
    ds_read_b128 v[28:31], v10 offset:0
    ds_read_b64_tr_b16 v[60:61], v12 offset:0
    ds_read_b64_tr_b16 v[62:63], v12 offset:256
    ds_read_b128 v[32:35], v10 offset:2048
    ds_read_b64_tr_b16 v[64:65], v13 offset:0
    ds_read_b64_tr_b16 v[66:67], v13 offset:256
    ds_read_b128 v[36:39], v10 offset:4096
    ds_read_b64_tr_b16 v[68:69], v14 offset:0
    ds_read_b64_tr_b16 v[70:71], v14 offset:256
    ds_read_b128 v[40:43], v10 offset:6144
    ds_read_b64_tr_b16 v[72:73], v15 offset:0
    ds_read_b64_tr_b16 v[74:75], v15 offset:256
    ds_read_b64_tr_b16 v[76:77], v16 offset:0
    ds_read_b64_tr_b16 v[78:79], v16 offset:256
    ds_read_b64_tr_b16 v[80:81], v17 offset:0
    ds_read_b64_tr_b16 v[82:83], v17 offset:256
    s_waitcnt lgkmcnt(0)
    v_mfma_f32_16x16x32_bf16 v[108:111], v[60:63], v[28:31], v[108:111]
    ds_read_b128 v[44:47], v11 offset:0
    v_mfma_f32_16x16x32_bf16 v[112:115], v[60:63], v[32:35], v[112:115]
    ds_read_b64_tr_b16 v[84:85], v12 offset:2048
    v_mfma_f32_16x16x32_bf16 v[116:119], v[60:63], v[36:39], v[116:119]
    ds_read_b64_tr_b16 v[86:87], v12 offset:2304
    v_mfma_f32_16x16x32_bf16 v[120:123], v[60:63], v[40:43], v[120:123]
    ds_read_b128 v[48:51], v11 offset:2048
    v_mfma_f32_16x16x32_bf16 v[124:127], v[64:67], v[28:31], v[124:127]
    ds_read_b64_tr_b16 v[88:89], v13 offset:2048
    v_mfma_f32_16x16x32_bf16 v[128:131], v[64:67], v[32:35], v[128:131]
    ds_read_b64_tr_b16 v[90:91], v13 offset:2304
    v_mfma_f32_16x16x32_bf16 v[132:135], v[64:67], v[36:39], v[132:135]
    ds_read_b128 v[52:55], v11 offset:4096
    v_mfma_f32_16x16x32_bf16 v[136:139], v[64:67], v[40:43], v[136:139]
    ds_read_b64_tr_b16 v[92:93], v14 offset:2048
    v_mfma_f32_16x16x32_bf16 v[140:143], v[68:71], v[28:31], v[140:143]
    ds_read_b64_tr_b16 v[94:95], v14 offset:2304
    v_mfma_f32_16x16x32_bf16 v[144:147], v[68:71], v[32:35], v[144:147]
    ds_read_b128 v[56:59], v11 offset:6144
    v_mfma_f32_16x16x32_bf16 v[148:151], v[68:71], v[36:39], v[148:151]
    ds_read_b64_tr_b16 v[96:97], v15 offset:2048
    v_mfma_f32_16x16x32_bf16 v[152:155], v[68:71], v[40:43], v[152:155]
    ds_read_b64_tr_b16 v[98:99], v15 offset:2304
    v_mfma_f32_16x16x32_bf16 v[156:159], v[72:75], v[28:31], v[156:159]
    ds_read_b64_tr_b16 v[100:101], v16 offset:2048
    v_mfma_f32_16x16x32_bf16 v[160:163], v[72:75], v[32:35], v[160:163]
    ds_read_b64_tr_b16 v[102:103], v16 offset:2304
    v_mfma_f32_16x16x32_bf16 v[164:167], v[72:75], v[36:39], v[164:167]
    ds_read_b64_tr_b16 v[104:105], v17 offset:2048
    v_mfma_f32_16x16x32_bf16 v[168:171], v[72:75], v[40:43], v[168:171]
    ds_read_b64_tr_b16 v[106:107], v17 offset:2304
    v_mfma_f32_16x16x32_bf16 v[172:175], v[76:79], v[28:31], v[172:175]
    v_mfma_f32_16x16x32_bf16 v[176:179], v[76:79], v[32:35], v[176:179]
    v_mfma_f32_16x16x32_bf16 v[180:183], v[76:79], v[36:39], v[180:183]
    v_mfma_f32_16x16x32_bf16 v[184:187], v[76:79], v[40:43], v[184:187]
    v_mfma_f32_16x16x32_bf16 v[188:191], v[80:83], v[28:31], v[188:191]
    v_mfma_f32_16x16x32_bf16 v[192:195], v[80:83], v[32:35], v[192:195]
    v_mfma_f32_16x16x32_bf16 v[196:199], v[80:83], v[36:39], v[196:199]
    v_mfma_f32_16x16x32_bf16 v[200:203], v[80:83], v[40:43], v[200:203]
    s_cmp_lg_u32 s30, 0
    s_cbranch_scc1 L_csn_8
    v_mfma_f32_16x16x32_bf16 v[204:207], v[60:63], v[212:215], v[204:207]
    v_mfma_f32_16x16x32_bf16 v[208:211], v[76:79], v[212:215], v[208:211]
    s_branch L_cs_7
L_csn_8:
    s_cmp_lg_u32 s30, 1
    s_cbranch_scc1 L_csn_9
    v_mfma_f32_16x16x32_bf16 v[204:207], v[64:67], v[212:215], v[204:207]
    v_mfma_f32_16x16x32_bf16 v[208:211], v[80:83], v[212:215], v[208:211]
    s_branch L_cs_7
L_csn_9:
    s_cmp_lg_u32 s30, 2
    s_cbranch_scc1 L_csn_10
    v_mfma_f32_16x16x32_bf16 v[204:207], v[68:71], v[212:215], v[204:207]
    s_branch L_cs_7
L_csn_10:
    v_mfma_f32_16x16x32_bf16 v[204:207], v[72:75], v[212:215], v[204:207]
L_cs_7:
    s_waitcnt lgkmcnt(0)
    s_mov_b32 s48, 15
    s_mov_b32 s94, 15
    s_lshr_b32 s3, s2, 3
    s_mul_hi_u32 s46, s3, 1431655766
    s_mul_i32 s46, s46, 3
    s_sub_u32 s95, s3, s46
    s_mul_i32 s95, s95, 4
    s_add_u32 s95, s95, 3
    s_cmp_eq_u32 s30, 1
    s_cbranch_scc1 L_cloop_13
    s_cmp_eq_u32 s30, 2
    s_cbranch_scc1 L_cloop_14
    s_cmp_eq_u32 s30, 3
    s_cbranch_scc1 L_cloop_15
L_cloop_12:
    s_barrier
    v_add_u32 v10, s42, v2
    v_add_u32 v11, s42, v3
    v_add_u32 v12, s42, v4
    v_add_u32 v13, s42, v5
    v_add_u32 v14, s42, v6
    v_add_u32 v15, s42, v7
    v_add_u32 v16, s42, v8
    v_add_u32 v17, s42, v9
    s_add_u32 s42, s42, 45056
    s_cmp_ge_u32 s42, 135168
    s_cselect_b32 s42, 0, s42
    v_mfma_f32_16x16x32_bf16 v[108:111], v[84:87], v[44:47], v[108:111]
    ds_read_b128 v[28:31], v10 offset:0
    v_mfma_f32_16x16x32_bf16 v[112:115], v[84:87], v[48:51], v[112:115]
    ds_read_b64_tr_b16 v[60:61], v12 offset:0
    v_mfma_f32_16x16x32_bf16 v[116:119], v[84:87], v[52:55], v[116:119]
    ds_read_b64_tr_b16 v[62:63], v12 offset:256
    v_mfma_f32_16x16x32_bf16 v[120:123], v[84:87], v[56:59], v[120:123]
    ds_read_b128 v[32:35], v10 offset:2048
    v_mfma_f32_16x16x32_bf16 v[124:127], v[88:91], v[44:47], v[124:127]
    ds_read_b64_tr_b16 v[64:65], v13 offset:0
    v_mfma_f32_16x16x32_bf16 v[128:131], v[88:91], v[48:51], v[128:131]
    ds_read_b64_tr_b16 v[66:67], v13 offset:256
    v_mfma_f32_16x16x32_bf16 v[132:135], v[88:91], v[52:55], v[132:135]
    ds_read_b128 v[36:39], v10 offset:4096
    v_mfma_f32_16x16x32_bf16 v[136:139], v[88:91], v[56:59], v[136:139]
    ds_read_b64_tr_b16 v[68:69], v14 offset:0
    v_mfma_f32_16x16x32_bf16 v[140:143], v[92:95], v[44:47], v[140:143]
    ds_read_b64_tr_b16 v[70:71], v14 offset:256
    v_mfma_f32_16x16x32_bf16 v[144:147], v[92:95], v[48:51], v[144:147]
    ds_read_b128 v[40:43], v10 offset:6144
    v_mfma_f32_16x16x32_bf16 v[148:151], v[92:95], v[52:55], v[148:151]
    ds_read_b64_tr_b16 v[72:73], v15 offset:0
    v_mfma_f32_16x16x32_bf16 v[152:155], v[92:95], v[56:59], v[152:155]
    ds_read_b64_tr_b16 v[74:75], v15 offset:256
    v_mfma_f32_16x16x32_bf16 v[156:159], v[96:99], v[44:47], v[156:159]
    ds_read_b64_tr_b16 v[76:77], v16 offset:0
    v_mfma_f32_16x16x32_bf16 v[160:163], v[96:99], v[48:51], v[160:163]
    ds_read_b64_tr_b16 v[78:79], v16 offset:256
    v_mfma_f32_16x16x32_bf16 v[164:167], v[96:99], v[52:55], v[164:167]
    ds_read_b64_tr_b16 v[80:81], v17 offset:0
    v_mfma_f32_16x16x32_bf16 v[168:171], v[96:99], v[56:59], v[168:171]
    ds_read_b64_tr_b16 v[82:83], v17 offset:256
    v_mfma_f32_16x16x32_bf16 v[172:175], v[100:103], v[44:47], v[172:175]
    v_mfma_f32_16x16x32_bf16 v[176:179], v[100:103], v[48:51], v[176:179]
    v_mfma_f32_16x16x32_bf16 v[180:183], v[100:103], v[52:55], v[180:183]
    v_mfma_f32_16x16x32_bf16 v[184:187], v[100:103], v[56:59], v[184:187]
    v_mfma_f32_16x16x32_bf16 v[188:191], v[104:107], v[44:47], v[188:191]
    v_mfma_f32_16x16x32_bf16 v[192:195], v[104:107], v[48:51], v[192:195]
    v_mfma_f32_16x16x32_bf16 v[196:199], v[104:107], v[52:55], v[196:199]
    v_mfma_f32_16x16x32_bf16 v[200:203], v[104:107], v[56:59], v[200:203]
    v_mfma_f32_16x16x32_bf16 v[204:207], v[84:87], v[212:215], v[204:207]
    v_mfma_f32_16x16x32_bf16 v[208:211], v[100:103], v[212:215], v[208:211]
    s_waitcnt lgkmcnt(0)
    v_mfma_f32_16x16x32_bf16 v[108:111], v[60:63], v[28:31], v[108:111]
    ds_read_b128 v[44:47], v11 offset:0
    v_mfma_f32_16x16x32_bf16 v[112:115], v[60:63], v[32:35], v[112:115]
    ds_read_b64_tr_b16 v[84:85], v12 offset:2048
    v_mfma_f32_16x16x32_bf16 v[116:119], v[60:63], v[36:39], v[116:119]
    ds_read_b64_tr_b16 v[86:87], v12 offset:2304
    v_mfma_f32_16x16x32_bf16 v[120:123], v[60:63], v[40:43], v[120:123]
    ds_read_b128 v[48:51], v11 offset:2048
    v_mfma_f32_16x16x32_bf16 v[124:127], v[64:67], v[28:31], v[124:127]
    ds_read_b64_tr_b16 v[88:89], v13 offset:2048
    v_mfma_f32_16x16x32_bf16 v[128:131], v[64:67], v[32:35], v[128:131]
    ds_read_b64_tr_b16 v[90:91], v13 offset:2304
    v_mfma_f32_16x16x32_bf16 v[132:135], v[64:67], v[36:39], v[132:135]
    ds_read_b128 v[52:55], v11 offset:4096
    v_mfma_f32_16x16x32_bf16 v[136:139], v[64:67], v[40:43], v[136:139]
    ds_read_b64_tr_b16 v[92:93], v14 offset:2048
    v_mfma_f32_16x16x32_bf16 v[140:143], v[68:71], v[28:31], v[140:143]
    ds_read_b64_tr_b16 v[94:95], v14 offset:2304
    v_mfma_f32_16x16x32_bf16 v[144:147], v[68:71], v[32:35], v[144:147]
    ds_read_b128 v[56:59], v11 offset:6144
    v_mfma_f32_16x16x32_bf16 v[148:151], v[68:71], v[36:39], v[148:151]
    ds_read_b64_tr_b16 v[96:97], v15 offset:2048
    v_mfma_f32_16x16x32_bf16 v[152:155], v[68:71], v[40:43], v[152:155]
    ds_read_b64_tr_b16 v[98:99], v15 offset:2304
    v_mfma_f32_16x16x32_bf16 v[156:159], v[72:75], v[28:31], v[156:159]
    ds_read_b64_tr_b16 v[100:101], v16 offset:2048
    v_mfma_f32_16x16x32_bf16 v[160:163], v[72:75], v[32:35], v[160:163]
    ds_read_b64_tr_b16 v[102:103], v16 offset:2304
    v_mfma_f32_16x16x32_bf16 v[164:167], v[72:75], v[36:39], v[164:167]
    ds_read_b64_tr_b16 v[104:105], v17 offset:2048
    v_mfma_f32_16x16x32_bf16 v[168:171], v[72:75], v[40:43], v[168:171]
    ds_read_b64_tr_b16 v[106:107], v17 offset:2304
    v_mfma_f32_16x16x32_bf16 v[172:175], v[76:79], v[28:31], v[172:175]
    v_mfma_f32_16x16x32_bf16 v[176:179], v[76:79], v[32:35], v[176:179]
    v_mfma_f32_16x16x32_bf16 v[180:183], v[76:79], v[36:39], v[180:183]
    v_mfma_f32_16x16x32_bf16 v[184:187], v[76:79], v[40:43], v[184:187]
    v_mfma_f32_16x16x32_bf16 v[188:191], v[80:83], v[28:31], v[188:191]
    v_mfma_f32_16x16x32_bf16 v[192:195], v[80:83], v[32:35], v[192:195]
    v_mfma_f32_16x16x32_bf16 v[196:199], v[80:83], v[36:39], v[196:199]
    v_mfma_f32_16x16x32_bf16 v[200:203], v[80:83], v[40:43], v[200:203]
    v_mfma_f32_16x16x32_bf16 v[204:207], v[60:63], v[212:215], v[204:207]
    v_mfma_f32_16x16x32_bf16 v[208:211], v[76:79], v[212:215], v[208:211]
    s_cmp_eq_u32 s48, s94
    s_cbranch_scc1 L_pub_17
L_pubb_18:
    s_cmp_eq_u32 s48, s95
    s_cbranch_scc1 L_stg_19
L_stgb_20:
    s_waitcnt lgkmcnt(0)
    s_sub_u32 s48, s48, 1
    s_cmp_lg_u32 s48, 0
    s_cbranch_scc1 L_cloop_12
    s_branch L_cdone_16
L_cloop_13:
    s_barrier
    v_add_u32 v10, s42, v2
    v_add_u32 v11, s42, v3
    v_add_u32 v12, s42, v4
    v_add_u32 v13, s42, v5
    v_add_u32 v14, s42, v6
    v_add_u32 v15, s42, v7
    v_add_u32 v16, s42, v8
    v_add_u32 v17, s42, v9
    s_add_u32 s42, s42, 45056
    s_cmp_ge_u32 s42, 135168
    s_cselect_b32 s42, 0, s42
    v_mfma_f32_16x16x32_bf16 v[108:111], v[84:87], v[44:47], v[108:111]
    ds_read_b128 v[28:31], v10 offset:0
    v_mfma_f32_16x16x32_bf16 v[112:115], v[84:87], v[48:51], v[112:115]
    ds_read_b64_tr_b16 v[60:61], v12 offset:0
    v_mfma_f32_16x16x32_bf16 v[116:119], v[84:87], v[52:55], v[116:119]
    ds_read_b64_tr_b16 v[62:63], v12 offset:256
    v_mfma_f32_16x16x32_bf16 v[120:123], v[84:87], v[56:59], v[120:123]
    ds_read_b128 v[32:35], v10 offset:2048
    v_mfma_f32_16x16x32_bf16 v[124:127], v[88:91], v[44:47], v[124:127]
    ds_read_b64_tr_b16 v[64:65], v13 offset:0
    v_mfma_f32_16x16x32_bf16 v[128:131], v[88:91], v[48:51], v[128:131]
    ds_read_b64_tr_b16 v[66:67], v13 offset:256
    v_mfma_f32_16x16x32_bf16 v[132:135], v[88:91], v[52:55], v[132:135]
    ds_read_b128 v[36:39], v10 offset:4096
    v_mfma_f32_16x16x32_bf16 v[136:139], v[88:91], v[56:59], v[136:139]
    ds_read_b64_tr_b16 v[68:69], v14 offset:0
    v_mfma_f32_16x16x32_bf16 v[140:143], v[92:95], v[44:47], v[140:143]
    ds_read_b64_tr_b16 v[70:71], v14 offset:256
    v_mfma_f32_16x16x32_bf16 v[144:147], v[92:95], v[48:51], v[144:147]
    ds_read_b128 v[40:43], v10 offset:6144
    v_mfma_f32_16x16x32_bf16 v[148:151], v[92:95], v[52:55], v[148:151]
    ds_read_b64_tr_b16 v[72:73], v15 offset:0
    v_mfma_f32_16x16x32_bf16 v[152:155], v[92:95], v[56:59], v[152:155]
    ds_read_b64_tr_b16 v[74:75], v15 offset:256
    v_mfma_f32_16x16x32_bf16 v[156:159], v[96:99], v[44:47], v[156:159]
    ds_read_b64_tr_b16 v[76:77], v16 offset:0
    v_mfma_f32_16x16x32_bf16 v[160:163], v[96:99], v[48:51], v[160:163]
    ds_read_b64_tr_b16 v[78:79], v16 offset:256
    v_mfma_f32_16x16x32_bf16 v[164:167], v[96:99], v[52:55], v[164:167]
    ds_read_b64_tr_b16 v[80:81], v17 offset:0
    v_mfma_f32_16x16x32_bf16 v[168:171], v[96:99], v[56:59], v[168:171]
    ds_read_b64_tr_b16 v[82:83], v17 offset:256
    v_mfma_f32_16x16x32_bf16 v[172:175], v[100:103], v[44:47], v[172:175]
    v_mfma_f32_16x16x32_bf16 v[176:179], v[100:103], v[48:51], v[176:179]
    v_mfma_f32_16x16x32_bf16 v[180:183], v[100:103], v[52:55], v[180:183]
    v_mfma_f32_16x16x32_bf16 v[184:187], v[100:103], v[56:59], v[184:187]
    v_mfma_f32_16x16x32_bf16 v[188:191], v[104:107], v[44:47], v[188:191]
    v_mfma_f32_16x16x32_bf16 v[192:195], v[104:107], v[48:51], v[192:195]
    v_mfma_f32_16x16x32_bf16 v[196:199], v[104:107], v[52:55], v[196:199]
    v_mfma_f32_16x16x32_bf16 v[200:203], v[104:107], v[56:59], v[200:203]
    v_mfma_f32_16x16x32_bf16 v[204:207], v[88:91], v[212:215], v[204:207]
    v_mfma_f32_16x16x32_bf16 v[208:211], v[104:107], v[212:215], v[208:211]
    s_waitcnt lgkmcnt(0)
    v_mfma_f32_16x16x32_bf16 v[108:111], v[60:63], v[28:31], v[108:111]
    ds_read_b128 v[44:47], v11 offset:0
    v_mfma_f32_16x16x32_bf16 v[112:115], v[60:63], v[32:35], v[112:115]
    ds_read_b64_tr_b16 v[84:85], v12 offset:2048
    v_mfma_f32_16x16x32_bf16 v[116:119], v[60:63], v[36:39], v[116:119]
    ds_read_b64_tr_b16 v[86:87], v12 offset:2304
    v_mfma_f32_16x16x32_bf16 v[120:123], v[60:63], v[40:43], v[120:123]
    ds_read_b128 v[48:51], v11 offset:2048
    v_mfma_f32_16x16x32_bf16 v[124:127], v[64:67], v[28:31], v[124:127]
    ds_read_b64_tr_b16 v[88:89], v13 offset:2048
    v_mfma_f32_16x16x32_bf16 v[128:131], v[64:67], v[32:35], v[128:131]
    ds_read_b64_tr_b16 v[90:91], v13 offset:2304
    v_mfma_f32_16x16x32_bf16 v[132:135], v[64:67], v[36:39], v[132:135]
    ds_read_b128 v[52:55], v11 offset:4096
    v_mfma_f32_16x16x32_bf16 v[136:139], v[64:67], v[40:43], v[136:139]
    ds_read_b64_tr_b16 v[92:93], v14 offset:2048
    v_mfma_f32_16x16x32_bf16 v[140:143], v[68:71], v[28:31], v[140:143]
    ds_read_b64_tr_b16 v[94:95], v14 offset:2304
    v_mfma_f32_16x16x32_bf16 v[144:147], v[68:71], v[32:35], v[144:147]
    ds_read_b128 v[56:59], v11 offset:6144
    v_mfma_f32_16x16x32_bf16 v[148:151], v[68:71], v[36:39], v[148:151]
    ds_read_b64_tr_b16 v[96:97], v15 offset:2048
    v_mfma_f32_16x16x32_bf16 v[152:155], v[68:71], v[40:43], v[152:155]
    ds_read_b64_tr_b16 v[98:99], v15 offset:2304
    v_mfma_f32_16x16x32_bf16 v[156:159], v[72:75], v[28:31], v[156:159]
    ds_read_b64_tr_b16 v[100:101], v16 offset:2048
    v_mfma_f32_16x16x32_bf16 v[160:163], v[72:75], v[32:35], v[160:163]
    ds_read_b64_tr_b16 v[102:103], v16 offset:2304
    v_mfma_f32_16x16x32_bf16 v[164:167], v[72:75], v[36:39], v[164:167]
    ds_read_b64_tr_b16 v[104:105], v17 offset:2048
    v_mfma_f32_16x16x32_bf16 v[168:171], v[72:75], v[40:43], v[168:171]
    ds_read_b64_tr_b16 v[106:107], v17 offset:2304
    v_mfma_f32_16x16x32_bf16 v[172:175], v[76:79], v[28:31], v[172:175]
    v_mfma_f32_16x16x32_bf16 v[176:179], v[76:79], v[32:35], v[176:179]
    v_mfma_f32_16x16x32_bf16 v[180:183], v[76:79], v[36:39], v[180:183]
    v_mfma_f32_16x16x32_bf16 v[184:187], v[76:79], v[40:43], v[184:187]
    v_mfma_f32_16x16x32_bf16 v[188:191], v[80:83], v[28:31], v[188:191]
    v_mfma_f32_16x16x32_bf16 v[192:195], v[80:83], v[32:35], v[192:195]
    v_mfma_f32_16x16x32_bf16 v[196:199], v[80:83], v[36:39], v[196:199]
    v_mfma_f32_16x16x32_bf16 v[200:203], v[80:83], v[40:43], v[200:203]
    v_mfma_f32_16x16x32_bf16 v[204:207], v[64:67], v[212:215], v[204:207]
    v_mfma_f32_16x16x32_bf16 v[208:211], v[80:83], v[212:215], v[208:211]
    s_cmp_eq_u32 s48, s94
    s_cbranch_scc1 L_pub_21
L_pubb_22:
    s_cmp_eq_u32 s48, s95
    s_cbranch_scc1 L_stg_23
L_stgb_24:
    s_waitcnt lgkmcnt(0)
    s_sub_u32 s48, s48, 1
    s_cmp_lg_u32 s48, 0
    s_cbranch_scc1 L_cloop_13
    s_branch L_cdone_16
L_cloop_14:
    s_barrier
    v_add_u32 v10, s42, v2
    v_add_u32 v11, s42, v3
    v_add_u32 v12, s42, v4
    v_add_u32 v13, s42, v5
    v_add_u32 v14, s42, v6
    v_add_u32 v15, s42, v7
    v_add_u32 v16, s42, v8
    v_add_u32 v17, s42, v9
    s_add_u32 s42, s42, 45056
    s_cmp_ge_u32 s42, 135168
    s_cselect_b32 s42, 0, s42
    v_mfma_f32_16x16x32_bf16 v[108:111], v[84:87], v[44:47], v[108:111]
    ds_read_b128 v[28:31], v10 offset:0
    v_mfma_f32_16x16x32_bf16 v[112:115], v[84:87], v[48:51], v[112:115]
    ds_read_b64_tr_b16 v[60:61], v12 offset:0
    v_mfma_f32_16x16x32_bf16 v[116:119], v[84:87], v[52:55], v[116:119]
    ds_read_b64_tr_b16 v[62:63], v12 offset:256
    v_mfma_f32_16x16x32_bf16 v[120:123], v[84:87], v[56:59], v[120:123]
    ds_read_b128 v[32:35], v10 offset:2048
    v_mfma_f32_16x16x32_bf16 v[124:127], v[88:91], v[44:47], v[124:127]
    ds_read_b64_tr_b16 v[64:65], v13 offset:0
    v_mfma_f32_16x16x32_bf16 v[128:131], v[88:91], v[48:51], v[128:131]
    ds_read_b64_tr_b16 v[66:67], v13 offset:256
    v_mfma_f32_16x16x32_bf16 v[132:135], v[88:91], v[52:55], v[132:135]
    ds_read_b128 v[36:39], v10 offset:4096
    v_mfma_f32_16x16x32_bf16 v[136:139], v[88:91], v[56:59], v[136:139]
    ds_read_b64_tr_b16 v[68:69], v14 offset:0
    v_mfma_f32_16x16x32_bf16 v[140:143], v[92:95], v[44:47], v[140:143]
    ds_read_b64_tr_b16 v[70:71], v14 offset:256
    v_mfma_f32_16x16x32_bf16 v[144:147], v[92:95], v[48:51], v[144:147]
    ds_read_b128 v[40:43], v10 offset:6144
    v_mfma_f32_16x16x32_bf16 v[148:151], v[92:95], v[52:55], v[148:151]
    ds_read_b64_tr_b16 v[72:73], v15 offset:0
    v_mfma_f32_16x16x32_bf16 v[152:155], v[92:95], v[56:59], v[152:155]
    ds_read_b64_tr_b16 v[74:75], v15 offset:256
    v_mfma_f32_16x16x32_bf16 v[156:159], v[96:99], v[44:47], v[156:159]
    ds_read_b64_tr_b16 v[76:77], v16 offset:0
    v_mfma_f32_16x16x32_bf16 v[160:163], v[96:99], v[48:51], v[160:163]
    ds_read_b64_tr_b16 v[78:79], v16 offset:256
    v_mfma_f32_16x16x32_bf16 v[164:167], v[96:99], v[52:55], v[164:167]
    ds_read_b64_tr_b16 v[80:81], v17 offset:0
    v_mfma_f32_16x16x32_bf16 v[168:171], v[96:99], v[56:59], v[168:171]
    ds_read_b64_tr_b16 v[82:83], v17 offset:256
    v_mfma_f32_16x16x32_bf16 v[172:175], v[100:103], v[44:47], v[172:175]
    v_mfma_f32_16x16x32_bf16 v[176:179], v[100:103], v[48:51], v[176:179]
    v_mfma_f32_16x16x32_bf16 v[180:183], v[100:103], v[52:55], v[180:183]
    v_mfma_f32_16x16x32_bf16 v[184:187], v[100:103], v[56:59], v[184:187]
    v_mfma_f32_16x16x32_bf16 v[188:191], v[104:107], v[44:47], v[188:191]
    v_mfma_f32_16x16x32_bf16 v[192:195], v[104:107], v[48:51], v[192:195]
    v_mfma_f32_16x16x32_bf16 v[196:199], v[104:107], v[52:55], v[196:199]
    v_mfma_f32_16x16x32_bf16 v[200:203], v[104:107], v[56:59], v[200:203]
    v_mfma_f32_16x16x32_bf16 v[204:207], v[92:95], v[212:215], v[204:207]
    s_waitcnt lgkmcnt(0)
    v_mfma_f32_16x16x32_bf16 v[108:111], v[60:63], v[28:31], v[108:111]
    ds_read_b128 v[44:47], v11 offset:0
    v_mfma_f32_16x16x32_bf16 v[112:115], v[60:63], v[32:35], v[112:115]
    ds_read_b64_tr_b16 v[84:85], v12 offset:2048
    v_mfma_f32_16x16x32_bf16 v[116:119], v[60:63], v[36:39], v[116:119]
    ds_read_b64_tr_b16 v[86:87], v12 offset:2304
    v_mfma_f32_16x16x32_bf16 v[120:123], v[60:63], v[40:43], v[120:123]
    ds_read_b128 v[48:51], v11 offset:2048
    v_mfma_f32_16x16x32_bf16 v[124:127], v[64:67], v[28:31], v[124:127]
    ds_read_b64_tr_b16 v[88:89], v13 offset:2048
    v_mfma_f32_16x16x32_bf16 v[128:131], v[64:67], v[32:35], v[128:131]
    ds_read_b64_tr_b16 v[90:91], v13 offset:2304
    v_mfma_f32_16x16x32_bf16 v[132:135], v[64:67], v[36:39], v[132:135]
    ds_read_b128 v[52:55], v11 offset:4096
    v_mfma_f32_16x16x32_bf16 v[136:139], v[64:67], v[40:43], v[136:139]
    ds_read_b64_tr_b16 v[92:93], v14 offset:2048
    v_mfma_f32_16x16x32_bf16 v[140:143], v[68:71], v[28:31], v[140:143]
    ds_read_b64_tr_b16 v[94:95], v14 offset:2304
    v_mfma_f32_16x16x32_bf16 v[144:147], v[68:71], v[32:35], v[144:147]
    ds_read_b128 v[56:59], v11 offset:6144
    v_mfma_f32_16x16x32_bf16 v[148:151], v[68:71], v[36:39], v[148:151]
    ds_read_b64_tr_b16 v[96:97], v15 offset:2048
    v_mfma_f32_16x16x32_bf16 v[152:155], v[68:71], v[40:43], v[152:155]
    ds_read_b64_tr_b16 v[98:99], v15 offset:2304
    v_mfma_f32_16x16x32_bf16 v[156:159], v[72:75], v[28:31], v[156:159]
    ds_read_b64_tr_b16 v[100:101], v16 offset:2048
    v_mfma_f32_16x16x32_bf16 v[160:163], v[72:75], v[32:35], v[160:163]
    ds_read_b64_tr_b16 v[102:103], v16 offset:2304
    v_mfma_f32_16x16x32_bf16 v[164:167], v[72:75], v[36:39], v[164:167]
    ds_read_b64_tr_b16 v[104:105], v17 offset:2048
    v_mfma_f32_16x16x32_bf16 v[168:171], v[72:75], v[40:43], v[168:171]
    ds_read_b64_tr_b16 v[106:107], v17 offset:2304
    v_mfma_f32_16x16x32_bf16 v[172:175], v[76:79], v[28:31], v[172:175]
    v_mfma_f32_16x16x32_bf16 v[176:179], v[76:79], v[32:35], v[176:179]
    v_mfma_f32_16x16x32_bf16 v[180:183], v[76:79], v[36:39], v[180:183]
    v_mfma_f32_16x16x32_bf16 v[184:187], v[76:79], v[40:43], v[184:187]
    v_mfma_f32_16x16x32_bf16 v[188:191], v[80:83], v[28:31], v[188:191]
    v_mfma_f32_16x16x32_bf16 v[192:195], v[80:83], v[32:35], v[192:195]
    v_mfma_f32_16x16x32_bf16 v[196:199], v[80:83], v[36:39], v[196:199]
    v_mfma_f32_16x16x32_bf16 v[200:203], v[80:83], v[40:43], v[200:203]
    v_mfma_f32_16x16x32_bf16 v[204:207], v[68:71], v[212:215], v[204:207]
    s_cmp_eq_u32 s48, s94
    s_cbranch_scc1 L_pub_25
L_pubb_26:
    s_cmp_eq_u32 s48, s95
    s_cbranch_scc1 L_stg_27
L_stgb_28:
    s_waitcnt lgkmcnt(0)
    s_sub_u32 s48, s48, 1
    s_cmp_lg_u32 s48, 0
    s_cbranch_scc1 L_cloop_14
    s_branch L_cdone_16
L_cloop_15:
    s_barrier
    v_add_u32 v10, s42, v2
    v_add_u32 v11, s42, v3
    v_add_u32 v12, s42, v4
    v_add_u32 v13, s42, v5
    v_add_u32 v14, s42, v6
    v_add_u32 v15, s42, v7
    v_add_u32 v16, s42, v8
    v_add_u32 v17, s42, v9
    s_add_u32 s42, s42, 45056
    s_cmp_ge_u32 s42, 135168
    s_cselect_b32 s42, 0, s42
    v_mfma_f32_16x16x32_bf16 v[108:111], v[84:87], v[44:47], v[108:111]
    ds_read_b128 v[28:31], v10 offset:0
    v_mfma_f32_16x16x32_bf16 v[112:115], v[84:87], v[48:51], v[112:115]
    ds_read_b64_tr_b16 v[60:61], v12 offset:0
    v_mfma_f32_16x16x32_bf16 v[116:119], v[84:87], v[52:55], v[116:119]
    ds_read_b64_tr_b16 v[62:63], v12 offset:256
    v_mfma_f32_16x16x32_bf16 v[120:123], v[84:87], v[56:59], v[120:123]
    ds_read_b128 v[32:35], v10 offset:2048
    v_mfma_f32_16x16x32_bf16 v[124:127], v[88:91], v[44:47], v[124:127]
    ds_read_b64_tr_b16 v[64:65], v13 offset:0
    v_mfma_f32_16x16x32_bf16 v[128:131], v[88:91], v[48:51], v[128:131]
    ds_read_b64_tr_b16 v[66:67], v13 offset:256
    v_mfma_f32_16x16x32_bf16 v[132:135], v[88:91], v[52:55], v[132:135]
    ds_read_b128 v[36:39], v10 offset:4096
    v_mfma_f32_16x16x32_bf16 v[136:139], v[88:91], v[56:59], v[136:139]
    ds_read_b64_tr_b16 v[68:69], v14 offset:0
    v_mfma_f32_16x16x32_bf16 v[140:143], v[92:95], v[44:47], v[140:143]
    ds_read_b64_tr_b16 v[70:71], v14 offset:256
    v_mfma_f32_16x16x32_bf16 v[144:147], v[92:95], v[48:51], v[144:147]
    ds_read_b128 v[40:43], v10 offset:6144
    v_mfma_f32_16x16x32_bf16 v[148:151], v[92:95], v[52:55], v[148:151]
    ds_read_b64_tr_b16 v[72:73], v15 offset:0
    v_mfma_f32_16x16x32_bf16 v[152:155], v[92:95], v[56:59], v[152:155]
    ds_read_b64_tr_b16 v[74:75], v15 offset:256
    v_mfma_f32_16x16x32_bf16 v[156:159], v[96:99], v[44:47], v[156:159]
    ds_read_b64_tr_b16 v[76:77], v16 offset:0
    v_mfma_f32_16x16x32_bf16 v[160:163], v[96:99], v[48:51], v[160:163]
    ds_read_b64_tr_b16 v[78:79], v16 offset:256
    v_mfma_f32_16x16x32_bf16 v[164:167], v[96:99], v[52:55], v[164:167]
    ds_read_b64_tr_b16 v[80:81], v17 offset:0
    v_mfma_f32_16x16x32_bf16 v[168:171], v[96:99], v[56:59], v[168:171]
    ds_read_b64_tr_b16 v[82:83], v17 offset:256
    v_mfma_f32_16x16x32_bf16 v[172:175], v[100:103], v[44:47], v[172:175]
    v_mfma_f32_16x16x32_bf16 v[176:179], v[100:103], v[48:51], v[176:179]
    v_mfma_f32_16x16x32_bf16 v[180:183], v[100:103], v[52:55], v[180:183]
    v_mfma_f32_16x16x32_bf16 v[184:187], v[100:103], v[56:59], v[184:187]
    v_mfma_f32_16x16x32_bf16 v[188:191], v[104:107], v[44:47], v[188:191]
    v_mfma_f32_16x16x32_bf16 v[192:195], v[104:107], v[48:51], v[192:195]
    v_mfma_f32_16x16x32_bf16 v[196:199], v[104:107], v[52:55], v[196:199]
    v_mfma_f32_16x16x32_bf16 v[200:203], v[104:107], v[56:59], v[200:203]
    v_mfma_f32_16x16x32_bf16 v[204:207], v[96:99], v[212:215], v[204:207]
    s_waitcnt lgkmcnt(0)
    v_mfma_f32_16x16x32_bf16 v[108:111], v[60:63], v[28:31], v[108:111]
    ds_read_b128 v[44:47], v11 offset:0
    v_mfma_f32_16x16x32_bf16 v[112:115], v[60:63], v[32:35], v[112:115]
    ds_read_b64_tr_b16 v[84:85], v12 offset:2048
    v_mfma_f32_16x16x32_bf16 v[116:119], v[60:63], v[36:39], v[116:119]
    ds_read_b64_tr_b16 v[86:87], v12 offset:2304
    v_mfma_f32_16x16x32_bf16 v[120:123], v[60:63], v[40:43], v[120:123]
    ds_read_b128 v[48:51], v11 offset:2048
    v_mfma_f32_16x16x32_bf16 v[124:127], v[64:67], v[28:31], v[124:127]
    ds_read_b64_tr_b16 v[88:89], v13 offset:2048
    v_mfma_f32_16x16x32_bf16 v[128:131], v[64:67], v[32:35], v[128:131]
    ds_read_b64_tr_b16 v[90:91], v13 offset:2304
    v_mfma_f32_16x16x32_bf16 v[132:135], v[64:67], v[36:39], v[132:135]
    ds_read_b128 v[52:55], v11 offset:4096
    v_mfma_f32_16x16x32_bf16 v[136:139], v[64:67], v[40:43], v[136:139]
    ds_read_b64_tr_b16 v[92:93], v14 offset:2048
    v_mfma_f32_16x16x32_bf16 v[140:143], v[68:71], v[28:31], v[140:143]
    ds_read_b64_tr_b16 v[94:95], v14 offset:2304
    v_mfma_f32_16x16x32_bf16 v[144:147], v[68:71], v[32:35], v[144:147]
    ds_read_b128 v[56:59], v11 offset:6144
    v_mfma_f32_16x16x32_bf16 v[148:151], v[68:71], v[36:39], v[148:151]
    ds_read_b64_tr_b16 v[96:97], v15 offset:2048
    v_mfma_f32_16x16x32_bf16 v[152:155], v[68:71], v[40:43], v[152:155]
    ds_read_b64_tr_b16 v[98:99], v15 offset:2304
    v_mfma_f32_16x16x32_bf16 v[156:159], v[72:75], v[28:31], v[156:159]
    ds_read_b64_tr_b16 v[100:101], v16 offset:2048
    v_mfma_f32_16x16x32_bf16 v[160:163], v[72:75], v[32:35], v[160:163]
    ds_read_b64_tr_b16 v[102:103], v16 offset:2304
    v_mfma_f32_16x16x32_bf16 v[164:167], v[72:75], v[36:39], v[164:167]
    ds_read_b64_tr_b16 v[104:105], v17 offset:2048
    v_mfma_f32_16x16x32_bf16 v[168:171], v[72:75], v[40:43], v[168:171]
    ds_read_b64_tr_b16 v[106:107], v17 offset:2304
    v_mfma_f32_16x16x32_bf16 v[172:175], v[76:79], v[28:31], v[172:175]
    v_mfma_f32_16x16x32_bf16 v[176:179], v[76:79], v[32:35], v[176:179]
    v_mfma_f32_16x16x32_bf16 v[180:183], v[76:79], v[36:39], v[180:183]
    v_mfma_f32_16x16x32_bf16 v[184:187], v[76:79], v[40:43], v[184:187]
    v_mfma_f32_16x16x32_bf16 v[188:191], v[80:83], v[28:31], v[188:191]
    v_mfma_f32_16x16x32_bf16 v[192:195], v[80:83], v[32:35], v[192:195]
    v_mfma_f32_16x16x32_bf16 v[196:199], v[80:83], v[36:39], v[196:199]
    v_mfma_f32_16x16x32_bf16 v[200:203], v[80:83], v[40:43], v[200:203]
    v_mfma_f32_16x16x32_bf16 v[204:207], v[72:75], v[212:215], v[204:207]
    s_cmp_eq_u32 s48, s94
    s_cbranch_scc1 L_pub_29
L_pubb_30:
    s_cmp_eq_u32 s48, s95
    s_cbranch_scc1 L_stg_31
L_stgb_32:
    s_waitcnt lgkmcnt(0)
    s_sub_u32 s48, s48, 1
    s_cmp_lg_u32 s48, 0
    s_cbranch_scc1 L_cloop_15
    s_branch L_cdone_16
L_pub_17:
    s_cmp_lg_u32 s48, 15
    s_cbranch_scc1 L_ev_33
    buffer_load_dword v232, v221, s[88:91], s40 offen
    s_add_u32 s40, s40, s41
    s_mov_b32 s94, 14
    s_branch L_pubb_18
L_ev_33:
    s_cmp_lg_u32 s48, 14
    s_cbranch_scc1 L_ev_34
    s_cmp_lt_u32 s2, 224
    s_cbranch_scc1 L_e0_35
    s_waitcnt vmcnt(0)
    v_readfirstlane_b32 s3, v236
    s_nop 3
    s_lshr_b32 s46, s3, 16
    s_cmp_lg_u32 s46, 127
    s_cbranch_scc1 L_e0_35
    s_bfe_u32 s3, s3, 0x10006
    s_add_u32 s3, s3, 2
    s_load_dwordx2 s[52:53], s[0:1], 72
    s_waitcnt lgkmcnt(0)
    s_and_b32 s53, s53, 0xffff
    s_movk_i32 s54, 256
    s_mov_b32 s55, 0x00020000
    v_mov_b32 v238, s3
    v_mov_b32 v239, 0
    s_mov_b64 exec, 1
    buffer_atomic_cmpswap v[238:239], off, s[52:55], 0 sc1
    s_mov_b64 exec, -1
L_e0_35:
    s_mov_b32 s94, 12
    s_branch L_pubb_18
L_ev_34:
    s_cmp_lg_u32 s48, 11
    s_cbranch_scc1 L_ev_36
    buffer_load_dword v232, v221, s[88:91], s40 offen
    s_add_u32 s40, s40, s41
    s_mov_b32 s94, 9
    s_branch L_pubb_18
L_ev_36:
    s_cmp_lg_u32 s48, 9
    s_cbranch_scc1 L_ev_37
    buffer_load_dword v232, v220, s[84:87], s92 offen
    s_add_u32 s92, s92, 512
    s_mov_b32 s94, 7
    s_branch L_pubb_18
L_ev_37:
    s_cmp_lg_u32 s48, 7
    s_cbranch_scc1 L_ev_38
    buffer_load_dword v232, v221, s[88:91], s40 offen
    s_add_u32 s40, s40, s41
    s_mov_b32 s94, 5
    s_branch L_pubb_18
L_ev_38:
    s_cmp_lg_u32 s48, 5
    s_cbranch_scc1 L_ev_39
    s_load_dwordx2 s[52:53], s[0:1], 72
    s_waitcnt lgkmcnt(0)
    s_and_b32 s53, s53, 0xffff
    s_movk_i32 s54, 256
    s_mov_b32 s55, 0x00020000
    s_mov_b64 exec, 1
    buffer_load_dwordx2 v[236:237], off, s[52:55], 0 sc0 sc1
    s_mov_b64 exec, -1
    s_mov_b32 s94, 2
    s_branch L_pubb_18
L_ev_39:
    s_cmp_lg_u32 s48, 2
    s_cbranch_scc1 L_ev_40
    s_waitcnt vmcnt(0)
    v_readfirstlane_b32 s3, v236
    v_readfirstlane_b32 s46, v237
    s_nop 3
    s_cmp_lg_u32 s3, 0
    s_cbranch_scc1 L_e2_41
    s_lshr_b32 s47, s46, 17
    s_and_b32 s46, s46, 0xffff
    s_cmp_gt_u32 s46, s47
    s_cselect_b32 s46, 3, 2
    s_load_dwordx2 s[52:53], s[0:1], 72
    s_waitcnt lgkmcnt(0)
    s_and_b32 s53, s53, 0xffff
    s_movk_i32 s54, 256
    s_mov_b32 s55, 0x00020000
    v_mov_b32 v238, s46
    v_mov_b32 v239, 0
    s_mov_b64 exec, 1
    buffer_atomic_cmpswap v[238:239], off, s[52:55], 0 sc0 sc1
    s_mov_b64 exec, -1
    s_waitcnt vmcnt(0)
    v_readfirstlane_b32 s3, v238
    s_nop 3
    s_cmp_eq_u32 s3, 0
    s_cselect_b32 s3, s46, s3
L_e2_41:
    s_and_b32 s3, s3, 1
    s_lshl_b32 s3, s3, 13
    v_mov_b32 v238, 150144
    v_mov_b32 v239, s3
    ds_write_b32 v238, v239
    s_mov_b32 s94, 0
    s_branch L_pubb_18
L_ev_40:
    s_mov_b32 s94, 11
    s_cmp_lg_u32 s45, 1
    s_cbranch_scc1 L_pubb_18
    s_memrealtime s[22:23]
    v_and_b32 v19, 1, v1
    v_lshlrev_b32 v18, 3, v19
    v_add_u32 v18, 149888, v18
    ds_read_b64 v[216:217], v18
    s_lshl_b32 s3, s29, 3
    s_add_u32 s3, s3, s98
    s_add_u32 s3, s3, 0
    s_lshl_b32 s3, s3, 4
    v_lshlrev_b32 v18, 4, v19
    s_waitcnt lgkmcnt(0)
    v_mov_b32 v218, s22
    v_mov_b32 v219, s23
    s_mov_b64 exec, 3
    buffer_store_dwordx4 v[216:219], v18, s[36:39], s3 offen sc0 sc1
    s_mov_b64 exec, -1
    s_branch L_pubb_18
L_stg_19:
    s_load_dwordx2 s[52:53], s[0:1], 32
    s_load_dwordx2 s[56:57], s[0:1], 48
    s_and_b32 s46, s99, 15
    s_lshr_b32 s3, s99, 4
    s_mul_i32 s3, s3, 7
    s_lshr_b32 s3, s3, 1
    s_add_u32 s3, s3, s30
    s_lshl_b32 s3, s3, 7
    s_mul_i32 s46, s46, 458752
    s_add_u32 s3, s3, s46
    v_mul_u32_u24 v18, 7168, v1
    v_lshlrev_b32 v19, 10, v1
    s_mul_i32 s46, s99, 28672
    s_waitcnt lgkmcnt(0)
    s_and_b32 s53, s53, 0xffff
    s_mov_b32 s54, 7340032
    s_mov_b32 s55, 0x00020000
    buffer_load_dword v232, v18, s[52:55], s3 offen
    s_mov_b32 s52, s56
    s_and_b32 s53, s57, 0xffff
    s_cmp_le_u32 s30, 0
    s_cselect_b32 exec_lo, 0xfffffff, 0
    s_mov_b32 exec_hi, 0
    buffer_load_dword v232, v19, s[52:55], s46 offen offset:384
    s_mov_b64 exec, -1
    s_branch L_stgb_20
L_pub_21:
    s_cmp_lg_u32 s48, 15
    s_cbranch_scc1 L_ev_42
    buffer_load_dword v232, v221, s[88:91], s40 offen
    s_add_u32 s40, s40, s41
    s_mov_b32 s94, 14
    s_branch L_pubb_22
L_ev_42:
    s_cmp_lg_u32 s48, 14
    s_cbranch_scc1 L_ev_43
    s_cmp_lt_u32 s2, 224
    s_cbranch_scc1 L_e0_44
    s_waitcnt vmcnt(0)
    v_readfirstlane_b32 s3, v236
    s_nop 3
    s_lshr_b32 s46, s3, 16
    s_cmp_lg_u32 s46, 127
    s_cbranch_scc1 L_e0_44
    s_bfe_u32 s3, s3, 0x10006
    s_add_u32 s3, s3, 2
    s_load_dwordx2 s[52:53], s[0:1], 72
    s_waitcnt lgkmcnt(0)
    s_and_b32 s53, s53, 0xffff
    s_movk_i32 s54, 256
    s_mov_b32 s55, 0x00020000
    v_mov_b32 v238, s3
    v_mov_b32 v239, 0
    s_mov_b64 exec, 1
    buffer_atomic_cmpswap v[238:239], off, s[52:55], 0 sc1
    s_mov_b64 exec, -1
L_e0_44:
    s_mov_b32 s94, 12
    s_branch L_pubb_22
L_ev_43:
    s_cmp_lg_u32 s48, 11
    s_cbranch_scc1 L_ev_45
    buffer_load_dword v232, v221, s[88:91], s40 offen
    s_add_u32 s40, s40, s41
    s_mov_b32 s94, 9
    s_branch L_pubb_22
L_ev_45:
    s_cmp_lg_u32 s48, 9
    s_cbranch_scc1 L_ev_46
    buffer_load_dword v232, v220, s[84:87], s92 offen
    s_add_u32 s92, s92, 512
    s_mov_b32 s94, 7
    s_branch L_pubb_22
L_ev_46:
    s_cmp_lg_u32 s48, 7
    s_cbranch_scc1 L_ev_47
    buffer_load_dword v232, v221, s[88:91], s40 offen
    s_add_u32 s40, s40, s41
    s_mov_b32 s94, 5
    s_branch L_pubb_22
L_ev_47:
    s_cmp_lg_u32 s48, 5
    s_cbranch_scc1 L_ev_48
    s_mov_b32 s94, 2
    s_branch L_pubb_22
L_ev_48:
    s_cmp_lg_u32 s48, 2
    s_cbranch_scc1 L_ev_49
    s_mov_b32 s94, 0
    s_branch L_pubb_22
L_ev_49:
    s_mov_b32 s94, 11
    s_cmp_lg_u32 s45, 1
    s_cbranch_scc1 L_pubb_22
    s_memrealtime s[22:23]
    v_and_b32 v19, 1, v1
    v_lshlrev_b32 v18, 3, v19
    v_add_u32 v18, 149904, v18
    ds_read_b64 v[216:217], v18
    s_lshl_b32 s3, s29, 3
    s_add_u32 s3, s3, s98
    s_add_u32 s3, s3, 2
    s_lshl_b32 s3, s3, 4
    v_lshlrev_b32 v18, 4, v19
    s_waitcnt lgkmcnt(0)
    v_mov_b32 v218, s22
    v_mov_b32 v219, s23
    s_mov_b64 exec, 3
    buffer_store_dwordx4 v[216:219], v18, s[36:39], s3 offen sc0 sc1
    s_mov_b64 exec, -1
    s_branch L_pubb_22
L_stg_23:
    s_load_dwordx2 s[52:53], s[0:1], 32
    s_load_dwordx2 s[56:57], s[0:1], 48
    s_and_b32 s46, s99, 15
    s_lshr_b32 s3, s99, 4
    s_mul_i32 s3, s3, 7
    s_lshr_b32 s3, s3, 1
    s_add_u32 s3, s3, s30
    s_lshl_b32 s3, s3, 7
    s_mul_i32 s46, s46, 458752
    s_add_u32 s3, s3, s46
    v_mul_u32_u24 v18, 7168, v1
    v_lshlrev_b32 v19, 10, v1
    s_mul_i32 s46, s99, 28672
    s_waitcnt lgkmcnt(0)
    s_and_b32 s53, s53, 0xffff
    s_mov_b32 s54, 7340032
    s_mov_b32 s55, 0x00020000
    buffer_load_dword v232, v18, s[52:55], s3 offen
    s_mov_b32 s52, s56
    s_and_b32 s53, s57, 0xffff
    s_cmp_le_u32 s30, 0
    s_cselect_b32 exec_lo, 0xfffffff, 0
    s_mov_b32 exec_hi, 0
    buffer_load_dword v232, v19, s[52:55], s46 offen offset:384
    s_mov_b64 exec, -1
    s_branch L_stgb_24
L_pub_25:
    s_cmp_lg_u32 s48, 15
    s_cbranch_scc1 L_ev_50
    buffer_load_dword v232, v221, s[88:91], s40 offen
    s_add_u32 s40, s40, s41
    s_mov_b32 s94, 14
    s_branch L_pubb_26
L_ev_50:
    s_cmp_lg_u32 s48, 14
    s_cbranch_scc1 L_ev_51
    s_cmp_lt_u32 s2, 224
    s_cbranch_scc1 L_e0_52
    s_waitcnt vmcnt(0)
    v_readfirstlane_b32 s3, v236
    s_nop 3
    s_lshr_b32 s46, s3, 16
    s_cmp_lg_u32 s46, 127
    s_cbranch_scc1 L_e0_52
    s_bfe_u32 s3, s3, 0x10006
    s_add_u32 s3, s3, 2
    s_load_dwordx2 s[52:53], s[0:1], 72
    s_waitcnt lgkmcnt(0)
    s_and_b32 s53, s53, 0xffff
    s_movk_i32 s54, 256
    s_mov_b32 s55, 0x00020000
    v_mov_b32 v238, s3
    v_mov_b32 v239, 0
    s_mov_b64 exec, 1
    buffer_atomic_cmpswap v[238:239], off, s[52:55], 0 sc1
    s_mov_b64 exec, -1
L_e0_52:
    s_mov_b32 s94, 12
    s_branch L_pubb_26
L_ev_51:
    s_cmp_lg_u32 s48, 11
    s_cbranch_scc1 L_ev_53
    buffer_load_dword v232, v221, s[88:91], s40 offen
    s_add_u32 s40, s40, s41
    s_mov_b32 s94, 9
    s_branch L_pubb_26
L_ev_53:
    s_cmp_lg_u32 s48, 9
    s_cbranch_scc1 L_ev_54
    buffer_load_dword v232, v220, s[84:87], s92 offen
    s_add_u32 s92, s92, 512
    s_mov_b32 s94, 7
    s_branch L_pubb_26
L_ev_54:
    s_cmp_lg_u32 s48, 7
    s_cbranch_scc1 L_ev_55
    buffer_load_dword v232, v221, s[88:91], s40 offen
    s_add_u32 s40, s40, s41
    s_mov_b32 s94, 5
    s_branch L_pubb_26
L_ev_55:
    s_cmp_lg_u32 s48, 5
    s_cbranch_scc1 L_ev_56
    s_mov_b32 s94, 2
    s_branch L_pubb_26
L_ev_56:
    s_cmp_lg_u32 s48, 2
    s_cbranch_scc1 L_ev_57
    s_mov_b32 s94, 0
    s_branch L_pubb_26
L_ev_57:
    s_mov_b32 s94, 11
    s_cmp_lg_u32 s45, 1
    s_cbranch_scc1 L_pubb_26
    s_memrealtime s[22:23]
    v_and_b32 v19, 1, v1
    v_lshlrev_b32 v18, 3, v19
    v_add_u32 v18, 149920, v18
    ds_read_b64 v[216:217], v18
    s_lshl_b32 s3, s29, 3
    s_add_u32 s3, s3, s98
    s_add_u32 s3, s3, 4
    s_lshl_b32 s3, s3, 4
    v_lshlrev_b32 v18, 4, v19
    s_waitcnt lgkmcnt(0)
    v_mov_b32 v218, s22
    v_mov_b32 v219, s23
    s_mov_b64 exec, 3
    buffer_store_dwordx4 v[216:219], v18, s[36:39], s3 offen sc0 sc1
    s_mov_b64 exec, -1
    s_branch L_pubb_26
L_stg_27:
    s_load_dwordx2 s[52:53], s[0:1], 32
    s_load_dwordx2 s[56:57], s[0:1], 48
    s_and_b32 s46, s99, 15
    s_lshr_b32 s3, s99, 4
    s_mul_i32 s3, s3, 7
    s_lshr_b32 s3, s3, 1
    s_add_u32 s3, s3, s30
    s_lshl_b32 s3, s3, 7
    s_mul_i32 s46, s46, 458752
    s_add_u32 s3, s3, s46
    v_mul_u32_u24 v18, 7168, v1
    v_lshlrev_b32 v19, 10, v1
    s_mul_i32 s46, s99, 28672
    s_waitcnt lgkmcnt(0)
    s_and_b32 s53, s53, 0xffff
    s_mov_b32 s54, 7340032
    s_mov_b32 s55, 0x00020000
    buffer_load_dword v232, v18, s[52:55], s3 offen
    s_mov_b32 s52, s56
    s_and_b32 s53, s57, 0xffff
    s_cmp_le_u32 s30, 0
    s_cselect_b32 exec_lo, 0xfffffff, 0
    s_mov_b32 exec_hi, 0
    buffer_load_dword v232, v19, s[52:55], s46 offen offset:384
    s_mov_b64 exec, -1
    s_branch L_stgb_28
L_pub_29:
    s_cmp_lg_u32 s48, 15
    s_cbranch_scc1 L_ev_58
    buffer_load_dword v232, v221, s[88:91], s40 offen
    s_add_u32 s40, s40, s41
    s_mov_b32 s94, 14
    s_branch L_pubb_30
L_ev_58:
    s_cmp_lg_u32 s48, 14
    s_cbranch_scc1 L_ev_59
    s_cmp_lt_u32 s2, 224
    s_cbranch_scc1 L_e0_60
    s_waitcnt vmcnt(0)
    v_readfirstlane_b32 s3, v236
    s_nop 3
    s_lshr_b32 s46, s3, 16
    s_cmp_lg_u32 s46, 127
    s_cbranch_scc1 L_e0_60
    s_bfe_u32 s3, s3, 0x10006
    s_add_u32 s3, s3, 2
    s_load_dwordx2 s[52:53], s[0:1], 72
    s_waitcnt lgkmcnt(0)
    s_and_b32 s53, s53, 0xffff
    s_movk_i32 s54, 256
    s_mov_b32 s55, 0x00020000
    v_mov_b32 v238, s3
    v_mov_b32 v239, 0
    s_mov_b64 exec, 1
    buffer_atomic_cmpswap v[238:239], off, s[52:55], 0 sc1
    s_mov_b64 exec, -1
L_e0_60:
    s_mov_b32 s94, 12
    s_branch L_pubb_30
L_ev_59:
    s_cmp_lg_u32 s48, 11
    s_cbranch_scc1 L_ev_61
    buffer_load_dword v232, v221, s[88:91], s40 offen
    s_add_u32 s40, s40, s41
    s_mov_b32 s94, 9
    s_branch L_pubb_30
L_ev_61:
    s_cmp_lg_u32 s48, 9
    s_cbranch_scc1 L_ev_62
    buffer_load_dword v232, v220, s[84:87], s92 offen
    s_add_u32 s92, s92, 512
    s_mov_b32 s94, 7
    s_branch L_pubb_30
L_ev_62:
    s_cmp_lg_u32 s48, 7
    s_cbranch_scc1 L_ev_63
    buffer_load_dword v232, v221, s[88:91], s40 offen
    s_add_u32 s40, s40, s41
    s_mov_b32 s94, 5
    s_branch L_pubb_30
L_ev_63:
    s_cmp_lg_u32 s48, 5
    s_cbranch_scc1 L_ev_64
    s_mov_b32 s94, 2
    s_branch L_pubb_30
L_ev_64:
    s_cmp_lg_u32 s48, 2
    s_cbranch_scc1 L_ev_65
    s_mov_b32 s94, 0
    s_branch L_pubb_30
L_ev_65:
    s_mov_b32 s94, 11
    s_cmp_lg_u32 s45, 1
    s_cbranch_scc1 L_pubb_30
    s_memrealtime s[22:23]
    v_and_b32 v19, 1, v1
    v_lshlrev_b32 v18, 3, v19
    v_add_u32 v18, 149936, v18
    ds_read_b64 v[216:217], v18
    s_lshl_b32 s3, s29, 3
    s_add_u32 s3, s3, s98
    s_add_u32 s3, s3, 6
    s_lshl_b32 s3, s3, 4
    v_lshlrev_b32 v18, 4, v19
    s_waitcnt lgkmcnt(0)
    v_mov_b32 v218, s22
    v_mov_b32 v219, s23
    s_mov_b64 exec, 3
    buffer_store_dwordx4 v[216:219], v18, s[36:39], s3 offen sc0 sc1
    s_mov_b64 exec, -1
    s_branch L_pubb_30
L_stg_31:
    s_load_dwordx2 s[52:53], s[0:1], 32
    s_load_dwordx2 s[56:57], s[0:1], 48
    s_and_b32 s46, s99, 15
    s_lshr_b32 s3, s99, 4
    s_mul_i32 s3, s3, 7
    s_lshr_b32 s3, s3, 1
    s_add_u32 s3, s3, s30
    s_lshl_b32 s3, s3, 7
    s_mul_i32 s46, s46, 458752
    s_add_u32 s3, s3, s46
    v_mul_u32_u24 v18, 7168, v1
    v_lshlrev_b32 v19, 10, v1
    s_mul_i32 s46, s99, 28672
    s_waitcnt lgkmcnt(0)
    s_and_b32 s53, s53, 0xffff
    s_mov_b32 s54, 7340032
    s_mov_b32 s55, 0x00020000
    buffer_load_dword v232, v18, s[52:55], s3 offen
    s_mov_b32 s52, s56
    s_and_b32 s53, s57, 0xffff
    s_cmp_le_u32 s30, 0
    s_cselect_b32 exec_lo, 0xfffffff, 0
    s_mov_b32 exec_hi, 0
    buffer_load_dword v232, v19, s[52:55], s46 offen offset:384
    s_mov_b64 exec, -1
    s_branch L_stgb_32
L_cdone_16:
    v_mov_b32 v238, 150144
    ds_read_b32 v238, v238
    s_waitcnt lgkmcnt(0)
    v_readfirstlane_b32 s3, v238
    s_nop 3
    v_writelane_b32 v255, s3, 20
    s_cmp_lg_u32 s30, 0
    s_cbranch_scc1 L_csn_67
    v_mfma_f32_16x16x32_bf16 v[204:207], v[84:87], v[212:215], v[204:207]
    v_mfma_f32_16x16x32_bf16 v[208:211], v[100:103], v[212:215], v[208:211]
    s_branch L_cs_66
L_csn_67:
    s_cmp_lg_u32 s30, 1
    s_cbranch_scc1 L_csn_68
    v_mfma_f32_16x16x32_bf16 v[204:207], v[88:91], v[212:215], v[204:207]
    v_mfma_f32_16x16x32_bf16 v[208:211], v[104:107], v[212:215], v[208:211]
    s_branch L_cs_66
L_csn_68:
    s_cmp_lg_u32 s30, 2
    s_cbranch_scc1 L_csn_69
    v_mfma_f32_16x16x32_bf16 v[204:207], v[92:95], v[212:215], v[204:207]
    s_branch L_cs_66
L_csn_69:
    v_mfma_f32_16x16x32_bf16 v[204:207], v[96:99], v[212:215], v[204:207]
L_cs_66:
    v_mfma_f32_16x16x32_bf16 v[108:111], v[84:87], v[44:47], v[108:111]
    v_mfma_f32_16x16x32_bf16 v[112:115], v[84:87], v[48:51], v[112:115]
    v_mfma_f32_16x16x32_bf16 v[116:119], v[84:87], v[52:55], v[116:119]
    v_mfma_f32_16x16x32_bf16 v[120:123], v[84:87], v[56:59], v[120:123]
    v_mfma_f32_16x16x32_bf16 v[124:127], v[88:91], v[44:47], v[124:127]
    v_mfma_f32_16x16x32_bf16 v[128:131], v[88:91], v[48:51], v[128:131]
    v_mfma_f32_16x16x32_bf16 v[132:135], v[88:91], v[52:55], v[132:135]
    v_mfma_f32_16x16x32_bf16 v[136:139], v[88:91], v[56:59], v[136:139]
    v_mfma_f32_16x16x32_bf16 v[140:143], v[92:95], v[44:47], v[140:143]
    v_mfma_f32_16x16x32_bf16 v[144:147], v[92:95], v[48:51], v[144:147]
    v_mfma_f32_16x16x32_bf16 v[148:151], v[92:95], v[52:55], v[148:151]
    v_mfma_f32_16x16x32_bf16 v[152:155], v[92:95], v[56:59], v[152:155]
    v_mfma_f32_16x16x32_bf16 v[156:159], v[96:99], v[44:47], v[156:159]
    v_mfma_f32_16x16x32_bf16 v[160:163], v[96:99], v[48:51], v[160:163]
    v_mfma_f32_16x16x32_bf16 v[164:167], v[96:99], v[52:55], v[164:167]
    v_mfma_f32_16x16x32_bf16 v[168:171], v[96:99], v[56:59], v[168:171]
    v_mfma_f32_16x16x32_bf16 v[172:175], v[100:103], v[44:47], v[172:175]
    v_mfma_f32_16x16x32_bf16 v[176:179], v[100:103], v[48:51], v[176:179]
    v_mfma_f32_16x16x32_bf16 v[180:183], v[100:103], v[52:55], v[180:183]
    v_mfma_f32_16x16x32_bf16 v[184:187], v[100:103], v[56:59], v[184:187]
    v_mfma_f32_16x16x32_bf16 v[188:191], v[104:107], v[44:47], v[188:191]
    v_mfma_f32_16x16x32_bf16 v[192:195], v[104:107], v[48:51], v[192:195]
    v_mfma_f32_16x16x32_bf16 v[196:199], v[104:107], v[52:55], v[196:199]
    v_mfma_f32_16x16x32_bf16 v[200:203], v[104:107], v[56:59], v[200:203]
    v_lshrrev_b32 v18, 4, v1
    v_lshlrev_b32 v18, 4, v18
    s_lshl_b32 s3, s30, 6
    s_add_u32 s3, s3, 149504
    v_add_u32 v19, s3, v18
    s_mov_b32 exec_lo, 0x00010001
    s_mov_b32 exec_hi, 0x00010001
    ds_write_b128 v19, v[204:207]
    s_cmp_ge_u32 s30, 2
    s_cbranch_scc1 L_cs2_71
    ds_write_b128 v19, v[208:211] offset:256
L_cs2_71:
    s_mov_b64 exec, -1
    v_add_u32 v18, 149504, v18
    v_mov_b32 v19, 149952
    s_waitcnt lgkmcnt(0)
    s_barrier
    ds_read_b32 v20, v19
    ds_read_b128 v[44:47], v18 offset:0
    ds_read_b128 v[48:51], v18 offset:64
    ds_read_b128 v[52:55], v18 offset:128
    ds_read_b128 v[56:59], v18 offset:192
    ds_read_b128 v[60:63], v18 offset:256
    ds_read_b128 v[64:67], v18 offset:320
    s_waitcnt lgkmcnt(0)
    v_readfirstlane_b32 s3, v20
    s_nop 3
    s_cmp_eq_u32 s3, 1
    s_cbranch_scc1 L_stok_72
    s_mov_b32 s101, 1
    s_lshl_b32 s46, s49, 5
    s_add_u32 s47, s46, s98
    s_mov_b32 s52, 16
L_ls_73:
    v_lshlrev_b32 v92, 5, v1
    s_lshl_b32 s3, s47, 11
    buffer_load_dwordx4 v[76:79], v92, s[4:7], s3 offen offset:0
    buffer_load_dwordx4 v[80:83], v92, s[4:7], s3 offen offset:16
    buffer_load_dwordx4 v[84:87], v92, s[4:7], s3 offen offset:2048
    buffer_load_dwordx4 v[88:91], v92, s[4:7], s3 offen offset:2064
    s_waitcnt vmcnt(0)
    v_mov_b32 v100, 0x3f803f80
    v_mov_b32 v92, 0
    v_mov_b32 v93, 0
    v_mov_b32 v94, 0
    v_mov_b32 v95, 0
    v_dot2_f32_bf16 v92, v76, v100, v92
    v_dot2_f32_bf16 v93, v76, v76, v93
    v_dot2_f32_bf16 v92, v77, v100, v92
    v_dot2_f32_bf16 v93, v77, v77, v93
    v_dot2_f32_bf16 v92, v78, v100, v92
    v_dot2_f32_bf16 v93, v78, v78, v93
    v_dot2_f32_bf16 v92, v79, v100, v92
    v_dot2_f32_bf16 v93, v79, v79, v93
    v_dot2_f32_bf16 v92, v80, v100, v92
    v_dot2_f32_bf16 v93, v80, v80, v93
    v_dot2_f32_bf16 v92, v81, v100, v92
    v_dot2_f32_bf16 v93, v81, v81, v93
    v_dot2_f32_bf16 v92, v82, v100, v92
    v_dot2_f32_bf16 v93, v82, v82, v93
    v_dot2_f32_bf16 v92, v83, v100, v92
    v_dot2_f32_bf16 v93, v83, v83, v93
    v_dot2_f32_bf16 v94, v84, v100, v94
    v_dot2_f32_bf16 v95, v84, v84, v95
    v_dot2_f32_bf16 v94, v85, v100, v94
    v_dot2_f32_bf16 v95, v85, v85, v95
    v_dot2_f32_bf16 v94, v86, v100, v94
    v_dot2_f32_bf16 v95, v86, v86, v95
    v_dot2_f32_bf16 v94, v87, v100, v94
    v_dot2_f32_bf16 v95, v87, v87, v95
    v_dot2_f32_bf16 v94, v88, v100, v94
    v_dot2_f32_bf16 v95, v88, v88, v95
    v_dot2_f32_bf16 v94, v89, v100, v94
    v_dot2_f32_bf16 v95, v89, v89, v95
    v_dot2_f32_bf16 v94, v90, v100, v94
    v_dot2_f32_bf16 v95, v90, v90, v95
    v_dot2_f32_bf16 v94, v91, v100, v94
    v_dot2_f32_bf16 v95, v91, v91, v95
    s_nop 3
    v_add_f32_dpp v96, v92, v92 quad_perm:[1,0,3,2] row_mask:0xf bank_mask:0xf
    v_add_f32_dpp v97, v93, v93 quad_perm:[1,0,3,2] row_mask:0xf bank_mask:0xf
    v_add_f32_dpp v98, v94, v94 quad_perm:[1,0,3,2] row_mask:0xf bank_mask:0xf
    v_add_f32_dpp v99, v95, v95 quad_perm:[1,0,3,2] row_mask:0xf bank_mask:0xf
    s_nop 1
    v_add_f32_dpp v92, v96, v96 quad_perm:[2,3,0,1] row_mask:0xf bank_mask:0xf
    v_add_f32_dpp v93, v97, v97 quad_perm:[2,3,0,1] row_mask:0xf bank_mask:0xf
    v_add_f32_dpp v94, v98, v98 quad_perm:[2,3,0,1] row_mask:0xf bank_mask:0xf
    v_add_f32_dpp v95, v99, v99 quad_perm:[2,3,0,1] row_mask:0xf bank_mask:0xf
    s_nop 1
    v_add_f32_dpp v96, v92, v92 row_half_mirror row_mask:0xf bank_mask:0xf
    v_add_f32_dpp v97, v93, v93 row_half_mirror row_mask:0xf bank_mask:0xf
    v_add_f32_dpp v98, v94, v94 row_half_mirror row_mask:0xf bank_mask:0xf
    v_add_f32_dpp v99, v95, v95 row_half_mirror row_mask:0xf bank_mask:0xf
    s_nop 1
    v_add_f32_dpp v92, v96, v96 row_mirror row_mask:0xf bank_mask:0xf
    v_add_f32_dpp v93, v97, v97 row_mirror row_mask:0xf bank_mask:0xf
    v_add_f32_dpp v94, v98, v98 row_mirror row_mask:0xf bank_mask:0xf
    v_add_f32_dpp v95, v99, v99 row_mirror row_mask:0xf bank_mask:0xf
    s_nop 1
    v_xor_b32 v101, 16, v1
    v_lshlrev_b32 v101, 2, v101
    ds_bpermute_b32 v96, v101, v92
    ds_bpermute_b32 v97, v101, v93
    ds_bpermute_b32 v98, v101, v94
    ds_bpermute_b32 v99, v101, v95
    s_waitcnt lgkmcnt(0)
    v_add_f32 v92, v92, v96
    v_add_f32 v93, v93, v97
    v_add_f32 v94, v94, v98
    v_add_f32 v95, v95, v99
    v_xor_b32 v101, 32, v1
    v_lshlrev_b32 v101, 2, v101
    ds_bpermute_b32 v96, v101, v92
    ds_bpermute_b32 v97, v101, v93
    ds_bpermute_b32 v98, v101, v94
    ds_bpermute_b32 v99, v101, v95
    s_waitcnt lgkmcnt(0)
    v_add_f32 v92, v92, v96
    v_add_f32 v93, v93, v97
    v_add_f32 v94, v94, v98
    v_add_f32 v95, v95, v99
    v_mul_f32 v92, 0x3a800000, v92
    v_mul_f32 v93, 0x3a800000, v93
    v_fma_f32 v93, -v92, v92, v93
    v_max_f32 v93, 0, v93
    v_add_f32 v93, 0x3727c5ac, v93
    v_rsq_f32 v93, v93
    s_nop 0
    v_mul_f32 v96, v92, v93
    v_mov_b32 v92, v93
    v_sub_f32 v93, 0, v96
    v_mul_f32 v94, 0x3a800000, v94
    v_mul_f32 v95, 0x3a800000, v95
    v_fma_f32 v95, -v94, v94, v95
    v_max_f32 v95, 0, v95
    v_add_f32 v95, 0x3727c5ac, v95
    v_rsq_f32 v95, v95
    s_nop 0
    v_mul_f32 v96, v94, v95
    v_mov_b32 v94, v95
    v_sub_f32 v95, 0, v96
    s_lshl_b32 s3, s46, 3
    s_add_u32 s3, s3, 147456
    v_mov_b32 v101, s3
    ds_write_b128 v101, v[92:95]
    s_add_u32 s46, s46, 2
    s_add_u32 s47, s47, 2
    s_sub_u32 s52, s52, 1
    s_cmp_lg_u32 s52, 0
    s_cbranch_scc1 L_ls_73
    s_waitcnt lgkmcnt(0)
    s_barrier
L_stok_72:
    v_and_b32 v20, 15, v1
    s_lshl_b32 s3, s30, 6
    v_add_u32 v20, s3, v20
    v_lshlrev_b32 v18, 3, v20
    v_add_u32 v18, 147456, v18
    ds_read_b64 v[28:29], v18 offset:0
    ds_read_b64 v[30:31], v18 offset:128
    ds_read_b64 v[32:33], v18 offset:256
    ds_read_b64 v[34:35], v18 offset:384
    v_lshlrev_b32 v24, 4, v1
    v_lshrrev_b32 v21, 4, v1
    v_lshlrev_b32 v21, 6, v21
    v_xor_b32 v25, v24, v21
    s_lshl_b32 s3, s30, 12
    s_add_u32 s46, s3, s100
    v_add_u32 v22, s46, v24
    v_add_u32 v23, s46, v25
    s_lshr_b32 s46, s98, 3
    s_add_u32 s46, s46, s29
    s_lshl_b32 s46, s46, 15
    s_add_u32 s46, s46, s3
    s_lshr_b32 s47, s46, 9
    s_xor_b32 s47, s47, s46
    s_bfe_u32 s47, s47, 0x1000d
    s_mul_i32 s47, s47, 4202496
    s_xor_b32 s46, s46, s47
    s_lshr_b32 s47, s46, 8
    s_and_b32 s47, s47, 0x2000
    s_xor_b32 s46, s46, s47
    v_readlane_b32 s47, v255, 20
    s_nop 0
    s_xor_b32 s46, s46, s47
    s_add_u32 s47, s46, 16384
    s_mov_b32 s52, 0x3e8293ee
    s_waitcnt lgkmcnt(0)
    v_pk_mul_f32 v[68:69], v[52:53], v[28:29] op_sel:[0,1] op_sel_hi:[1,1]
    v_pk_mul_f32 v[70:71], v[54:55], v[28:29] op_sel:[0,1] op_sel_hi:[1,1]
    v_pk_mul_f32 v[72:73], v[56:57], v[28:29] op_sel:[0,1] op_sel_hi:[1,1]
    v_pk_mul_f32 v[74:75], v[58:59], v[28:29] op_sel:[0,1] op_sel_hi:[1,1]
    v_pk_fma_f32 v[140:141], v[140:141], v[28:29], v[68:69] op_sel:[0,0,0] op_sel_hi:[1,0,1]
    v_pk_fma_f32 v[142:143], v[142:143], v[28:29], v[70:71] op_sel:[0,0,0] op_sel_hi:[1,0,1]
    v_pk_fma_f32 v[156:157], v[156:157], v[28:29], v[72:73] op_sel:[0,0,0] op_sel_hi:[1,0,1]
    v_pk_fma_f32 v[158:159], v[158:159], v[28:29], v[74:75] op_sel:[0,0,0] op_sel_hi:[1,0,1]
    v_cvt_pk_bf16_f32 v140, v140, v141
    v_cvt_pk_bf16_f32 v141, v142, v143
    v_cvt_pk_bf16_f32 v142, v156, v157
    v_cvt_pk_bf16_f32 v143, v158, v159
    buffer_store_dwordx4 v[140:143], v24, s[16:19], s46 offen offset:0 sc0 sc1
    ds_write_b128 v22, v[140:143] offset:16384
    v_pk_mul_f32 v[76:77], v[52:53], v[30:31] op_sel:[0,1] op_sel_hi:[1,1]
    v_pk_mul_f32 v[78:79], v[54:55], v[30:31] op_sel:[0,1] op_sel_hi:[1,1]
    v_pk_mul_f32 v[80:81], v[56:57], v[30:31] op_sel:[0,1] op_sel_hi:[1,1]
    v_pk_mul_f32 v[82:83], v[58:59], v[30:31] op_sel:[0,1] op_sel_hi:[1,1]
    v_pk_fma_f32 v[144:145], v[144:145], v[30:31], v[76:77] op_sel:[0,0,0] op_sel_hi:[1,0,1]
    v_pk_fma_f32 v[146:147], v[146:147], v[30:31], v[78:79] op_sel:[0,0,0] op_sel_hi:[1,0,1]
    v_pk_fma_f32 v[160:161], v[160:161], v[30:31], v[80:81] op_sel:[0,0,0] op_sel_hi:[1,0,1]
    v_pk_fma_f32 v[162:163], v[162:163], v[30:31], v[82:83] op_sel:[0,0,0] op_sel_hi:[1,0,1]
    v_cvt_pk_bf16_f32 v144, v144, v145
    v_cvt_pk_bf16_f32 v145, v146, v147
    v_cvt_pk_bf16_f32 v146, v160, v161
    v_cvt_pk_bf16_f32 v147, v162, v163
    buffer_store_dwordx4 v[144:147], v24, s[16:19], s46 offen offset:1024 sc0 sc1
    ds_write_b128 v22, v[144:147] offset:17408
    v_pk_mul_f32 v[68:69], v[52:53], v[32:33] op_sel:[0,1] op_sel_hi:[1,1]
    v_pk_mul_f32 v[70:71], v[54:55], v[32:33] op_sel:[0,1] op_sel_hi:[1,1]
    v_pk_mul_f32 v[72:73], v[56:57], v[32:33] op_sel:[0,1] op_sel_hi:[1,1]
    v_pk_mul_f32 v[74:75], v[58:59], v[32:33] op_sel:[0,1] op_sel_hi:[1,1]
    v_pk_fma_f32 v[148:149], v[148:149], v[32:33], v[68:69] op_sel:[0,0,0] op_sel_hi:[1,0,1]
    v_pk_fma_f32 v[150:151], v[150:151], v[32:33], v[70:71] op_sel:[0,0,0] op_sel_hi:[1,0,1]
    v_pk_fma_f32 v[164:165], v[164:165], v[32:33], v[72:73] op_sel:[0,0,0] op_sel_hi:[1,0,1]
    v_pk_fma_f32 v[166:167], v[166:167], v[32:33], v[74:75] op_sel:[0,0,0] op_sel_hi:[1,0,1]
    v_cvt_pk_bf16_f32 v148, v148, v149
    v_cvt_pk_bf16_f32 v149, v150, v151
    v_cvt_pk_bf16_f32 v150, v164, v165
    v_cvt_pk_bf16_f32 v151, v166, v167
    buffer_store_dwordx4 v[148:151], v24, s[16:19], s46 offen offset:2048 sc0 sc1
    ds_write_b128 v22, v[148:151] offset:18432
    v_pk_mul_f32 v[76:77], v[52:53], v[34:35] op_sel:[0,1] op_sel_hi:[1,1]
    v_pk_mul_f32 v[78:79], v[54:55], v[34:35] op_sel:[0,1] op_sel_hi:[1,1]
    v_pk_mul_f32 v[80:81], v[56:57], v[34:35] op_sel:[0,1] op_sel_hi:[1,1]
    v_pk_mul_f32 v[82:83], v[58:59], v[34:35] op_sel:[0,1] op_sel_hi:[1,1]
    v_pk_fma_f32 v[152:153], v[152:153], v[34:35], v[76:77] op_sel:[0,0,0] op_sel_hi:[1,0,1]
    v_pk_fma_f32 v[154:155], v[154:155], v[34:35], v[78:79] op_sel:[0,0,0] op_sel_hi:[1,0,1]
    v_pk_fma_f32 v[168:169], v[168:169], v[34:35], v[80:81] op_sel:[0,0,0] op_sel_hi:[1,0,1]
    v_pk_fma_f32 v[170:171], v[170:171], v[34:35], v[82:83] op_sel:[0,0,0] op_sel_hi:[1,0,1]
    v_cvt_pk_bf16_f32 v152, v152, v153
    v_cvt_pk_bf16_f32 v153, v154, v155
    v_cvt_pk_bf16_f32 v154, v168, v169
    v_cvt_pk_bf16_f32 v155, v170, v171
    buffer_store_dwordx4 v[152:155], v24, s[16:19], s46 offen offset:3072 sc0 sc1
    ds_write_b128 v22, v[152:155] offset:19456
    v_pk_mul_f32 v[68:69], v[60:61], v[28:29] op_sel:[0,1] op_sel_hi:[1,1]
    v_pk_mul_f32 v[70:71], v[62:63], v[28:29] op_sel:[0,1] op_sel_hi:[1,1]
    v_pk_mul_f32 v[72:73], v[64:65], v[28:29] op_sel:[0,1] op_sel_hi:[1,1]
    v_pk_mul_f32 v[74:75], v[66:67], v[28:29] op_sel:[0,1] op_sel_hi:[1,1]
    v_pk_fma_f32 v[172:173], v[172:173], v[28:29], v[68:69] op_sel:[0,0,0] op_sel_hi:[1,0,1]
    v_pk_fma_f32 v[174:175], v[174:175], v[28:29], v[70:71] op_sel:[0,0,0] op_sel_hi:[1,0,1]
    v_pk_fma_f32 v[188:189], v[188:189], v[28:29], v[72:73] op_sel:[0,0,0] op_sel_hi:[1,0,1]
    v_pk_fma_f32 v[190:191], v[190:191], v[28:29], v[74:75] op_sel:[0,0,0] op_sel_hi:[1,0,1]
    v_cvt_pk_bf16_f32 v172, v172, v173
    v_cvt_pk_bf16_f32 v173, v174, v175
    v_cvt_pk_bf16_f32 v174, v188, v189
    v_cvt_pk_bf16_f32 v175, v190, v191
    buffer_store_dwordx4 v[172:175], v25, s[16:19], s47 offen offset:0 sc0 sc1
    ds_write_b128 v23, v[172:175] offset:32768
    v_pk_mul_f32 v[76:77], v[60:61], v[30:31] op_sel:[0,1] op_sel_hi:[1,1]
    v_pk_mul_f32 v[78:79], v[62:63], v[30:31] op_sel:[0,1] op_sel_hi:[1,1]
    v_pk_mul_f32 v[80:81], v[64:65], v[30:31] op_sel:[0,1] op_sel_hi:[1,1]
    v_pk_mul_f32 v[82:83], v[66:67], v[30:31] op_sel:[0,1] op_sel_hi:[1,1]
    v_pk_fma_f32 v[176:177], v[176:177], v[30:31], v[76:77] op_sel:[0,0,0] op_sel_hi:[1,0,1]
    v_pk_fma_f32 v[178:179], v[178:179], v[30:31], v[78:79] op_sel:[0,0,0] op_sel_hi:[1,0,1]
    v_pk_fma_f32 v[192:193], v[192:193], v[30:31], v[80:81] op_sel:[0,0,0] op_sel_hi:[1,0,1]
    v_pk_fma_f32 v[194:195], v[194:195], v[30:31], v[82:83] op_sel:[0,0,0] op_sel_hi:[1,0,1]
    v_cvt_pk_bf16_f32 v176, v176, v177
    v_cvt_pk_bf16_f32 v177, v178, v179
    v_cvt_pk_bf16_f32 v178, v192, v193
    v_cvt_pk_bf16_f32 v179, v194, v195
    buffer_store_dwordx4 v[176:179], v25, s[16:19], s47 offen offset:1024 sc0 sc1
    ds_write_b128 v23, v[176:179] offset:33792
    v_pk_mul_f32 v[68:69], v[60:61], v[32:33] op_sel:[0,1] op_sel_hi:[1,1]
    v_pk_mul_f32 v[70:71], v[62:63], v[32:33] op_sel:[0,1] op_sel_hi:[1,1]
    v_pk_mul_f32 v[72:73], v[64:65], v[32:33] op_sel:[0,1] op_sel_hi:[1,1]
    v_pk_mul_f32 v[74:75], v[66:67], v[32:33] op_sel:[0,1] op_sel_hi:[1,1]
    v_pk_fma_f32 v[180:181], v[180:181], v[32:33], v[68:69] op_sel:[0,0,0] op_sel_hi:[1,0,1]
    v_pk_fma_f32 v[182:183], v[182:183], v[32:33], v[70:71] op_sel:[0,0,0] op_sel_hi:[1,0,1]
    v_pk_fma_f32 v[196:197], v[196:197], v[32:33], v[72:73] op_sel:[0,0,0] op_sel_hi:[1,0,1]
    v_pk_fma_f32 v[198:199], v[198:199], v[32:33], v[74:75] op_sel:[0,0,0] op_sel_hi:[1,0,1]
    v_cvt_pk_bf16_f32 v180, v180, v181
    v_cvt_pk_bf16_f32 v181, v182, v183
    v_cvt_pk_bf16_f32 v182, v196, v197
    v_cvt_pk_bf16_f32 v183, v198, v199
    buffer_store_dwordx4 v[180:183], v25, s[16:19], s47 offen offset:2048 sc0 sc1
    ds_write_b128 v23, v[180:183] offset:34816
    v_pk_mul_f32 v[76:77], v[60:61], v[34:35] op_sel:[0,1] op_sel_hi:[1,1]
    v_pk_mul_f32 v[78:79], v[62:63], v[34:35] op_sel:[0,1] op_sel_hi:[1,1]
    v_pk_mul_f32 v[80:81], v[64:65], v[34:35] op_sel:[0,1] op_sel_hi:[1,1]
    v_pk_mul_f32 v[82:83], v[66:67], v[34:35] op_sel:[0,1] op_sel_hi:[1,1]
    v_pk_fma_f32 v[184:185], v[184:185], v[34:35], v[76:77] op_sel:[0,0,0] op_sel_hi:[1,0,1]
    v_pk_fma_f32 v[186:187], v[186:187], v[34:35], v[78:79] op_sel:[0,0,0] op_sel_hi:[1,0,1]
    v_pk_fma_f32 v[200:201], v[200:201], v[34:35], v[80:81] op_sel:[0,0,0] op_sel_hi:[1,0,1]
    v_pk_fma_f32 v[202:203], v[202:203], v[34:35], v[82:83] op_sel:[0,0,0] op_sel_hi:[1,0,1]
    v_cvt_pk_bf16_f32 v184, v184, v185
    v_cvt_pk_bf16_f32 v185, v186, v187
    v_cvt_pk_bf16_f32 v186, v200, v201
    v_cvt_pk_bf16_f32 v187, v202, v203
    buffer_store_dwordx4 v[184:187], v25, s[16:19], s47 offen offset:3072 sc0 sc1
    ds_write_b128 v23, v[184:187] offset:35840
    v_mul_f32 v28, s52, v28
    v_mul_f32 v29, s52, v29
    v_mul_f32 v30, s52, v30
    v_mul_f32 v31, s52, v31
    v_mul_f32 v32, s52, v32
    v_mul_f32 v33, s52, v33
    v_mul_f32 v34, s52, v34
    v_mul_f32 v35, s52, v35
    v_pk_mul_f32 v[68:69], v[44:45], v[28:29] op_sel:[0,1] op_sel_hi:[1,1]
    v_pk_mul_f32 v[70:71], v[46:47], v[28:29] op_sel:[0,1] op_sel_hi:[1,1]
    v_pk_mul_f32 v[72:73], v[48:49], v[28:29] op_sel:[0,1] op_sel_hi:[1,1]
    v_pk_mul_f32 v[74:75], v[50:51], v[28:29] op_sel:[0,1] op_sel_hi:[1,1]
    v_pk_fma_f32 v[108:109], v[108:109], v[28:29], v[68:69] op_sel:[0,0,0] op_sel_hi:[1,0,1]
    v_pk_fma_f32 v[110:111], v[110:111], v[28:29], v[70:71] op_sel:[0,0,0] op_sel_hi:[1,0,1]
    v_pk_fma_f32 v[124:125], v[124:125], v[28:29], v[72:73] op_sel:[0,0,0] op_sel_hi:[1,0,1]
    v_pk_fma_f32 v[126:127], v[126:127], v[28:29], v[74:75] op_sel:[0,0,0] op_sel_hi:[1,0,1]
    v_cvt_pk_bf16_f32 v108, v108, v109
    v_cvt_pk_bf16_f32 v109, v110, v111
    v_cvt_pk_bf16_f32 v110, v124, v125
    v_cvt_pk_bf16_f32 v111, v126, v127
    ds_write_b128 v22, v[108:111] offset:0
    v_pk_mul_f32 v[76:77], v[44:45], v[30:31] op_sel:[0,1] op_sel_hi:[1,1]
    v_pk_mul_f32 v[78:79], v[46:47], v[30:31] op_sel:[0,1] op_sel_hi:[1,1]
    v_pk_mul_f32 v[80:81], v[48:49], v[30:31] op_sel:[0,1] op_sel_hi:[1,1]
    v_pk_mul_f32 v[82:83], v[50:51], v[30:31] op_sel:[0,1] op_sel_hi:[1,1]
    v_pk_fma_f32 v[112:113], v[112:113], v[30:31], v[76:77] op_sel:[0,0,0] op_sel_hi:[1,0,1]
    v_pk_fma_f32 v[114:115], v[114:115], v[30:31], v[78:79] op_sel:[0,0,0] op_sel_hi:[1,0,1]
    v_pk_fma_f32 v[128:129], v[128:129], v[30:31], v[80:81] op_sel:[0,0,0] op_sel_hi:[1,0,1]
    v_pk_fma_f32 v[130:131], v[130:131], v[30:31], v[82:83] op_sel:[0,0,0] op_sel_hi:[1,0,1]
    v_cvt_pk_bf16_f32 v112, v112, v113
    v_cvt_pk_bf16_f32 v113, v114, v115
    v_cvt_pk_bf16_f32 v114, v128, v129
    v_cvt_pk_bf16_f32 v115, v130, v131
    ds_write_b128 v22, v[112:115] offset:1024
    v_pk_mul_f32 v[68:69], v[44:45], v[32:33] op_sel:[0,1] op_sel_hi:[1,1]
    v_pk_mul_f32 v[70:71], v[46:47], v[32:33] op_sel:[0,1] op_sel_hi:[1,1]
    v_pk_mul_f32 v[72:73], v[48:49], v[32:33] op_sel:[0,1] op_sel_hi:[1,1]
    v_pk_mul_f32 v[74:75], v[50:51], v[32:33] op_sel:[0,1] op_sel_hi:[1,1]
    v_pk_fma_f32 v[116:117], v[116:117], v[32:33], v[68:69] op_sel:[0,0,0] op_sel_hi:[1,0,1]
    v_pk_fma_f32 v[118:119], v[118:119], v[32:33], v[70:71] op_sel:[0,0,0] op_sel_hi:[1,0,1]
    v_pk_fma_f32 v[132:133], v[132:133], v[32:33], v[72:73] op_sel:[0,0,0] op_sel_hi:[1,0,1]
    v_pk_fma_f32 v[134:135], v[134:135], v[32:33], v[74:75] op_sel:[0,0,0] op_sel_hi:[1,0,1]
    v_cvt_pk_bf16_f32 v116, v116, v117
    v_cvt_pk_bf16_f32 v117, v118, v119
    v_cvt_pk_bf16_f32 v118, v132, v133
    v_cvt_pk_bf16_f32 v119, v134, v135
    ds_write_b128 v22, v[116:119] offset:2048
    v_pk_mul_f32 v[76:77], v[44:45], v[34:35] op_sel:[0,1] op_sel_hi:[1,1]
    v_pk_mul_f32 v[78:79], v[46:47], v[34:35] op_sel:[0,1] op_sel_hi:[1,1]
    v_pk_mul_f32 v[80:81], v[48:49], v[34:35] op_sel:[0,1] op_sel_hi:[1,1]
    v_pk_mul_f32 v[82:83], v[50:51], v[34:35] op_sel:[0,1] op_sel_hi:[1,1]
    v_pk_fma_f32 v[120:121], v[120:121], v[34:35], v[76:77] op_sel:[0,0,0] op_sel_hi:[1,0,1]
    v_pk_fma_f32 v[122:123], v[122:123], v[34:35], v[78:79] op_sel:[0,0,0] op_sel_hi:[1,0,1]
    v_pk_fma_f32 v[136:137], v[136:137], v[34:35], v[80:81] op_sel:[0,0,0] op_sel_hi:[1,0,1]
    v_pk_fma_f32 v[138:139], v[138:139], v[34:35], v[82:83] op_sel:[0,0,0] op_sel_hi:[1,0,1]
    v_cvt_pk_bf16_f32 v120, v120, v121
    v_cvt_pk_bf16_f32 v121, v122, v123
    v_cvt_pk_bf16_f32 v122, v136, v137
    v_cvt_pk_bf16_f32 v123, v138, v139
    ds_write_b128 v22, v[120:123] offset:3072
    s_waitcnt lgkmcnt(0)
    s_barrier
    s_branch L_att_3
L_loader_2:
    s_setprio 2
    s_load_dwordx2 s[94:95], s[0:1], 32
    s_load_dwordx2 s[96:97], s[0:1], 16
    s_lshl_b32 s3, s30, 6
    v_lshrrev_b32 v18, 3, v1
    v_add_u32 v18, s3, v18
    v_add_u32 v19, 0, v18
    v_lshrrev_b32 v20, 1, v19
    v_and_b32 v20, 7, v20
    v_and_b32 v21, 7, v1
    v_xor_b32 v20, v20, v21
    v_add_u32 v19, s98, v19
    v_mul_u32_u24 v19, 2048, v19
    v_lshl_add_u32 v2, v20, 4, v19
    v_add_u32 v19, 8, v18
    v_lshrrev_b32 v20, 1, v19
    v_and_b32 v20, 7, v20
    v_and_b32 v21, 7, v1
    v_xor_b32 v20, v20, v21
    v_add_u32 v19, s98, v19
    v_mul_u32_u24 v19, 2048, v19
    v_lshl_add_u32 v3, v20, 4, v19
    v_add_u32 v19, 16, v18
    v_lshrrev_b32 v20, 1, v19
    v_and_b32 v20, 7, v20
    v_and_b32 v21, 7, v1
    v_xor_b32 v20, v20, v21
    v_add_u32 v19, s98, v19
    v_mul_u32_u24 v19, 2048, v19
    v_lshl_add_u32 v4, v20, 4, v19
    v_add_u32 v19, 24, v18
    v_lshrrev_b32 v20, 1, v19
    v_and_b32 v20, 7, v20
    v_and_b32 v21, 7, v1
    v_xor_b32 v20, v20, v21
    v_add_u32 v19, s98, v19
    v_mul_u32_u24 v19, 2048, v19
    v_lshl_add_u32 v5, v20, 4, v19
    v_add_u32 v19, 32, v18
    v_lshrrev_b32 v20, 1, v19
    v_and_b32 v20, 7, v20
    v_and_b32 v21, 7, v1
    v_xor_b32 v20, v20, v21
    v_add_u32 v19, s98, v19
    v_mul_u32_u24 v19, 2048, v19
    v_lshl_add_u32 v6, v20, 4, v19
    v_add_u32 v19, 40, v18
    v_lshrrev_b32 v20, 1, v19
    v_and_b32 v20, 7, v20
    v_and_b32 v21, 7, v1
    v_xor_b32 v20, v20, v21
    v_add_u32 v19, s98, v19
    v_mul_u32_u24 v19, 2048, v19
    v_lshl_add_u32 v7, v20, 4, v19
    v_add_u32 v19, 48, v18
    v_lshrrev_b32 v20, 1, v19
    v_and_b32 v20, 7, v20
    v_and_b32 v21, 7, v1
    v_xor_b32 v20, v20, v21
    v_add_u32 v19, s98, v19
    v_mul_u32_u24 v19, 2048, v19
    v_lshl_add_u32 v8, v20, 4, v19
    v_add_u32 v19, 56, v18
    v_lshrrev_b32 v20, 1, v19
    v_and_b32 v20, 7, v20
    v_and_b32 v21, 7, v1
    v_xor_b32 v20, v20, v21
    v_add_u32 v19, s98, v19
    v_mul_u32_u24 v19, 2048, v19
    v_lshl_add_u32 v9, v20, 4, v19
    s_lshl_b32 s3, s29, 6
    s_mul_i32 s46, s30, 3
    s_add_u32 s46, s46, 0
    s_lshr_b32 s47, s46, 2
    s_and_b32 s46, s46, 3
    s_lshl_b32 s46, s46, 4
    s_lshl_b32 s47, s47, 11
    s_add_u32 s47, s47, s3
    v_lshrrev_b32 v18, 2, v1
    v_add_u32 v18, s46, v18
    v_and_b32 v19, 3, v1
    v_bfe_u32 v20, v18, 3, 1
    v_lshlrev_b32 v20, 1, v20
    v_xor_b32 v19, v19, v20
    v_mul_u32_u24 v18, 6144, v18
    v_lshl_add_u32 v18, v19, 4, v18
    v_add_u32 v10, s47, v18
    s_mul_i32 s46, s30, 3
    s_add_u32 s46, s46, 1
    s_lshr_b32 s47, s46, 2
    s_and_b32 s46, s46, 3
    s_lshl_b32 s46, s46, 4
    s_lshl_b32 s47, s47, 11
    s_add_u32 s47, s47, s3
    v_lshrrev_b32 v18, 2, v1
    v_add_u32 v18, s46, v18
    v_and_b32 v19, 3, v1
    v_bfe_u32 v20, v18, 3, 1
    v_lshlrev_b32 v20, 1, v20
    v_xor_b32 v19, v19, v20
    v_mul_u32_u24 v18, 6144, v18
    v_lshl_add_u32 v18, v19, 4, v18
    v_add_u32 v11, s47, v18
    s_mul_i32 s46, s30, 3
    s_add_u32 s46, s46, 2
    s_lshr_b32 s47, s46, 2
    s_and_b32 s46, s46, 3
    s_lshl_b32 s46, s46, 4
    s_lshl_b32 s47, s47, 11
    s_add_u32 s47, s47, s3
    v_lshrrev_b32 v18, 2, v1
    v_add_u32 v18, s46, v18
    v_and_b32 v19, 3, v1
    v_bfe_u32 v20, v18, 3, 1
    v_lshlrev_b32 v20, 1, v20
    v_xor_b32 v19, v19, v20
    v_mul_u32_u24 v18, 6144, v18
    v_lshl_add_u32 v18, v19, 4, v18
    v_add_u32 v12, s47, v18
    s_mul_i32 s31, s30, 8192
    s_mul_i32 s32, s30, 3072
    s_add_u32 s32, s32, 32768
    s_waitcnt lgkmcnt(0)
    s_mov_b32 s4, s58
    s_mov_b32 s5, s59
    s_and_b32 s5, s5, 0xffff
    s_mov_b32 s6, 4194304
    s_mov_b32 s7, 0x00020000
    s_mov_b32 s8, s26
    s_mov_b32 s9, s27
    s_and_b32 s9, s9, 0xffff
    s_mov_b32 s10, 6291456
    s_mov_b32 s11, 0x00020000
    s_add_u32 s12, s24, 12582912
    s_addc_u32 s13, s25, 0
    s_and_b32 s13, s13, 0xffff
    s_mov_b32 s14, 4194304
    s_mov_b32 s15, 0x00020000
    s_add_u32 s16, s24, 4194304
    s_addc_u32 s17, s25, 0
    s_and_b32 s17, s17, 0xffff
    s_mov_b32 s18, 8388608
    s_mov_b32 s19, 0x00020000
    s_add_u32 s20, s34, 0x1000000
    s_addc_u32 s21, s35, 0
    s_add_u32 s36, s24, 3145728
    s_addc_u32 s37, s25, 0
    s_and_b32 s37, s37, 0xffff
    s_mov_b32 s38, 131072
    s_mov_b32 s39, 0x00020000
    v_mov_b32 v218, 0
    v_mov_b32 v219, 0
    v_mov_b32 v240, 0
    v_writelane_b32 v255, s34, 1
    v_writelane_b32 v255, s35, 2
    s_lshl_b32 s46, s29, 3
    s_add_u32 s46, s46, s98
    s_lshl_b32 s47, s30, 1
    s_add_u32 s47, s47, s46
    s_mov_b32 s55, s47
L_lpass_74:
    s_mov_b32 s40, 0
    s_mov_b32 s41, 0
    s_mov_b32 s43, 0
    s_mov_b32 s53, 0
    s_cmp_lg_u32 s45, 1
    s_cbranch_scc1 L_l2p_75
    s_add_u32 s33, s43, s31
    s_add_u32 m0, s33, 0
    s_nop 0
    buffer_load_dwordx4 v2, s[4:7], s40 offen lds
    s_add_u32 m0, s33, 1024
    s_nop 0
    buffer_load_dwordx4 v3, s[4:7], s40 offen lds
    s_add_u32 m0, s33, 2048
    s_nop 0
    buffer_load_dwordx4 v4, s[4:7], s40 offen lds
    s_add_u32 m0, s33, 3072
    s_nop 0
    buffer_load_dwordx4 v5, s[4:7], s40 offen lds
    s_add_u32 m0, s33, 4096
    s_nop 0
    buffer_load_dwordx4 v6, s[4:7], s40 offen lds
    s_add_u32 m0, s33, 5120
    s_nop 0
    buffer_load_dwordx4 v7, s[4:7], s40 offen lds
    s_add_u32 m0, s33, 6144
    s_nop 0
    buffer_load_dwordx4 v8, s[4:7], s40 offen lds
    s_add_u32 m0, s33, 7168
    s_nop 0
    buffer_load_dwordx4 v9, s[4:7], s40 offen lds
    s_add_u32 s33, s43, s32
    s_add_u32 m0, s33, 0
    s_nop 0
    buffer_load_dwordx4 v10, s[8:11], s41 offen lds
    s_add_u32 m0, s33, 1024
    s_nop 0
    buffer_load_dwordx4 v11, s[8:11], s41 offen lds
    s_add_u32 m0, s33, 2048
    s_nop 0
    buffer_load_dwordx4 v12, s[8:11], s41 offen lds
    s_add_u32 s40, s40, 128
    s_add_u32 s41, s41, 393216
    s_add_u32 s43, s43, 45056
    s_cmp_ge_u32 s43, 135168
    s_cselect_b32 s43, 0, s43
    s_add_u32 s33, s43, s31
    s_add_u32 m0, s33, 0
    s_nop 0
    buffer_load_dwordx4 v2, s[4:7], s40 offen lds
    s_add_u32 m0, s33, 1024
    s_nop 0
    buffer_load_dwordx4 v3, s[4:7], s40 offen lds
    s_add_u32 m0, s33, 2048
    s_nop 0
    buffer_load_dwordx4 v4, s[4:7], s40 offen lds
    s_add_u32 m0, s33, 3072
    s_nop 0
    buffer_load_dwordx4 v5, s[4:7], s40 offen lds
    s_add_u32 m0, s33, 4096
    s_nop 0
    buffer_load_dwordx4 v6, s[4:7], s40 offen lds
    s_add_u32 m0, s33, 5120
    s_nop 0
    buffer_load_dwordx4 v7, s[4:7], s40 offen lds
    s_add_u32 m0, s33, 6144
    s_nop 0
    buffer_load_dwordx4 v8, s[4:7], s40 offen lds
    s_add_u32 m0, s33, 7168
    s_nop 0
    buffer_load_dwordx4 v9, s[4:7], s40 offen lds
    s_add_u32 s33, s43, s32
    s_add_u32 m0, s33, 0
    s_nop 0
    buffer_load_dwordx4 v10, s[8:11], s41 offen lds
    s_add_u32 m0, s33, 1024
    s_nop 0
    buffer_load_dwordx4 v11, s[8:11], s41 offen lds
    s_add_u32 m0, s33, 2048
    s_nop 0
    buffer_load_dwordx4 v12, s[8:11], s41 offen lds
    s_add_u32 s40, s40, 128
    s_add_u32 s41, s41, 393216
    s_add_u32 s43, s43, 45056
    s_cmp_ge_u32 s43, 135168
    s_cselect_b32 s43, 0, s43
    v_lshlrev_b32 v56, 5, v1
    s_lshl_b32 s3, s55, 11
    buffer_load_dwordx4 v[40:43], v56, s[4:7], s3 offen offset:0
    buffer_load_dwordx4 v[44:47], v56, s[4:7], s3 offen offset:16
    buffer_load_dwordx4 v[48:51], v56, s[4:7], s3 offen offset:2048
    buffer_load_dwordx4 v[52:55], v56, s[4:7], s3 offen offset:2064
    s_lshl_b32 s92, s99, 2
    s_add_u32 s92, s92, s30
    s_mov_b32 s76, s94
    s_mov_b32 s77, s95
    s_and_b32 s77, s77, 0xffff
    s_mov_b32 s78, 7340032
    s_mov_b32 s79, 0x00020000
    s_load_dwordx2 s[88:89], s[0:1], 16
    s_mov_b32 s90, 2097152
    s_mov_b32 s91, 0x00020000
    v_lshrrev_b32 v18, 3, v1
    v_and_b32 v19, 7, v1
    v_lshlrev_b32 v19, 4, v19
    v_lshl_add_u32 v219, v18, 11, v19
    s_lshr_b32 s3, s92, 6
    s_lshl_b32 s3, s3, 7
    s_and_b32 s46, s92, 63
    s_mul_i32 s46, s46, 114688
    s_add_u32 s3, s3, s46
    v_add_u32 v219, s3, v219
    s_and_b32 s93, s99, 15
    s_lshr_b32 s3, s99, 4
    s_mul_i32 s3, s3, 7
    s_lshr_b32 s3, s3, 1
    s_add_u32 s84, s3, s30
    v_mul_u32_u24 v18, 7168, v18
    v_add_u32 v218, v18, v19
    s_mul_i32 s3, s93, 458752
    s_lshl_b32 s46, s84, 7
    s_add_u32 s3, s3, s46
    v_add_u32 v218, s3, v218
    s_waitcnt vmcnt(15)
    s_barrier
    s_add_u32 s33, s43, s31
    s_add_u32 m0, s33, 0
    s_nop 0
    buffer_load_dwordx4 v2, s[4:7], s40 offen lds
    s_add_u32 m0, s33, 1024
    s_nop 0
    buffer_load_dwordx4 v3, s[4:7], s40 offen lds
    s_add_u32 m0, s33, 2048
    s_nop 0
    buffer_load_dwordx4 v4, s[4:7], s40 offen lds
    s_add_u32 m0, s33, 3072
    s_nop 0
    buffer_load_dwordx4 v5, s[4:7], s40 offen lds
    s_add_u32 m0, s33, 4096
    s_nop 0
    buffer_load_dwordx4 v6, s[4:7], s40 offen lds
    s_add_u32 m0, s33, 5120
    s_nop 0
    buffer_load_dwordx4 v7, s[4:7], s40 offen lds
    s_add_u32 m0, s33, 6144
    s_nop 0
    buffer_load_dwordx4 v8, s[4:7], s40 offen lds
    s_add_u32 m0, s33, 7168
    s_nop 0
    buffer_load_dwordx4 v9, s[4:7], s40 offen lds
    s_add_u32 s33, s43, s32
    s_add_u32 m0, s33, 0
    s_nop 0
    buffer_load_dwordx4 v10, s[8:11], s41 offen lds
    s_add_u32 m0, s33, 1024
    s_nop 0
    buffer_load_dwordx4 v11, s[8:11], s41 offen lds
    s_add_u32 m0, s33, 2048
    s_nop 0
    buffer_load_dwordx4 v12, s[8:11], s41 offen lds
    s_add_u32 s40, s40, 128
    s_add_u32 s41, s41, 393216
    s_add_u32 s43, s43, 45056
    s_cmp_ge_u32 s43, 135168
    s_cselect_b32 s43, 0, s43
    s_waitcnt vmcnt(15)
    s_barrier
    s_add_u32 s33, s43, s31
    s_add_u32 m0, s33, 0
    s_nop 0
    buffer_load_dwordx4 v2, s[4:7], s40 offen lds
    s_add_u32 m0, s33, 1024
    s_nop 0
    buffer_load_dwordx4 v3, s[4:7], s40 offen lds
    s_add_u32 m0, s33, 2048
    s_nop 0
    buffer_load_dwordx4 v4, s[4:7], s40 offen lds
    s_add_u32 m0, s33, 3072
    s_nop 0
    buffer_load_dwordx4 v5, s[4:7], s40 offen lds
    s_add_u32 m0, s33, 4096
    s_nop 0
    buffer_load_dwordx4 v6, s[4:7], s40 offen lds
    s_add_u32 m0, s33, 5120
    s_nop 0
    buffer_load_dwordx4 v7, s[4:7], s40 offen lds
    s_add_u32 m0, s33, 6144
    s_nop 0
    buffer_load_dwordx4 v8, s[4:7], s40 offen lds
    s_add_u32 m0, s33, 7168
    s_nop 0
    buffer_load_dwordx4 v9, s[4:7], s40 offen lds
    s_add_u32 s33, s43, s32
    s_add_u32 m0, s33, 0
    s_nop 0
    buffer_load_dwordx4 v10, s[8:11], s41 offen lds
    s_add_u32 m0, s33, 1024
    s_nop 0
    buffer_load_dwordx4 v11, s[8:11], s41 offen lds
    s_add_u32 m0, s33, 2048
    s_nop 0
    buffer_load_dwordx4 v12, s[8:11], s41 offen lds
    s_add_u32 s40, s40, 128
    s_add_u32 s41, s41, 393216
    s_add_u32 s43, s43, 45056
    s_cmp_ge_u32 s43, 135168
    s_cselect_b32 s43, 0, s43
    s_waitcnt vmcnt(22)
    v_mov_b32 v64, 0x3f803f80
    v_mov_b32 v56, 0
    v_mov_b32 v57, 0
    v_mov_b32 v58, 0
    v_mov_b32 v59, 0
    v_dot2_f32_bf16 v56, v40, v64, v56
    v_dot2_f32_bf16 v57, v40, v40, v57
    v_dot2_f32_bf16 v56, v41, v64, v56
    v_dot2_f32_bf16 v57, v41, v41, v57
    v_dot2_f32_bf16 v56, v42, v64, v56
    v_dot2_f32_bf16 v57, v42, v42, v57
    v_dot2_f32_bf16 v56, v43, v64, v56
    v_dot2_f32_bf16 v57, v43, v43, v57
    v_dot2_f32_bf16 v56, v44, v64, v56
    v_dot2_f32_bf16 v57, v44, v44, v57
    v_dot2_f32_bf16 v56, v45, v64, v56
    v_dot2_f32_bf16 v57, v45, v45, v57
    v_dot2_f32_bf16 v56, v46, v64, v56
    v_dot2_f32_bf16 v57, v46, v46, v57
    v_dot2_f32_bf16 v56, v47, v64, v56
    v_dot2_f32_bf16 v57, v47, v47, v57
    v_dot2_f32_bf16 v58, v48, v64, v58
    v_dot2_f32_bf16 v59, v48, v48, v59
    v_dot2_f32_bf16 v58, v49, v64, v58
    v_dot2_f32_bf16 v59, v49, v49, v59
    v_dot2_f32_bf16 v58, v50, v64, v58
    v_dot2_f32_bf16 v59, v50, v50, v59
    v_dot2_f32_bf16 v58, v51, v64, v58
    v_dot2_f32_bf16 v59, v51, v51, v59
    v_dot2_f32_bf16 v58, v52, v64, v58
    v_dot2_f32_bf16 v59, v52, v52, v59
    v_dot2_f32_bf16 v58, v53, v64, v58
    v_dot2_f32_bf16 v59, v53, v53, v59
    v_dot2_f32_bf16 v58, v54, v64, v58
    v_dot2_f32_bf16 v59, v54, v54, v59
    v_dot2_f32_bf16 v58, v55, v64, v58
    v_dot2_f32_bf16 v59, v55, v55, v59
    s_nop 3
    v_add_f32_dpp v60, v56, v56 quad_perm:[1,0,3,2] row_mask:0xf bank_mask:0xf
    v_add_f32_dpp v61, v57, v57 quad_perm:[1,0,3,2] row_mask:0xf bank_mask:0xf
    v_add_f32_dpp v62, v58, v58 quad_perm:[1,0,3,2] row_mask:0xf bank_mask:0xf
    v_add_f32_dpp v63, v59, v59 quad_perm:[1,0,3,2] row_mask:0xf bank_mask:0xf
    s_nop 1
    v_add_f32_dpp v56, v60, v60 quad_perm:[2,3,0,1] row_mask:0xf bank_mask:0xf
    v_add_f32_dpp v57, v61, v61 quad_perm:[2,3,0,1] row_mask:0xf bank_mask:0xf
    v_add_f32_dpp v58, v62, v62 quad_perm:[2,3,0,1] row_mask:0xf bank_mask:0xf
    v_add_f32_dpp v59, v63, v63 quad_perm:[2,3,0,1] row_mask:0xf bank_mask:0xf
    s_nop 1
    v_add_f32_dpp v60, v56, v56 row_half_mirror row_mask:0xf bank_mask:0xf
    v_add_f32_dpp v61, v57, v57 row_half_mirror row_mask:0xf bank_mask:0xf
    v_add_f32_dpp v62, v58, v58 row_half_mirror row_mask:0xf bank_mask:0xf
    v_add_f32_dpp v63, v59, v59 row_half_mirror row_mask:0xf bank_mask:0xf
    s_nop 1
    v_add_f32_dpp v56, v60, v60 row_mirror row_mask:0xf bank_mask:0xf
    v_add_f32_dpp v57, v61, v61 row_mirror row_mask:0xf bank_mask:0xf
    v_add_f32_dpp v58, v62, v62 row_mirror row_mask:0xf bank_mask:0xf
    v_add_f32_dpp v59, v63, v63 row_mirror row_mask:0xf bank_mask:0xf
    s_nop 1
    v_xor_b32 v65, 16, v1
    v_lshlrev_b32 v65, 2, v65
    ds_bpermute_b32 v60, v65, v56
    ds_bpermute_b32 v61, v65, v57
    ds_bpermute_b32 v62, v65, v58
    ds_bpermute_b32 v63, v65, v59
    s_waitcnt lgkmcnt(0)
    v_add_f32 v56, v56, v60
    v_add_f32 v57, v57, v61
    v_add_f32 v58, v58, v62
    v_add_f32 v59, v59, v63
    v_xor_b32 v65, 32, v1
    v_lshlrev_b32 v65, 2, v65
    ds_bpermute_b32 v60, v65, v56
    ds_bpermute_b32 v61, v65, v57
    ds_bpermute_b32 v62, v65, v58
    ds_bpermute_b32 v63, v65, v59
    s_waitcnt lgkmcnt(0)
    v_add_f32 v56, v56, v60
    v_add_f32 v57, v57, v61
    v_add_f32 v58, v58, v62
    v_add_f32 v59, v59, v63
    v_mul_f32 v56, 0x3a800000, v56
    v_mul_f32 v57, 0x3a800000, v57
    v_fma_f32 v57, -v56, v56, v57
    v_max_f32 v57, 0, v57
    v_add_f32 v57, 0x3727c5ac, v57
    v_rsq_f32 v57, v57
    s_nop 0
    v_mul_f32 v60, v56, v57
    v_mov_b32 v56, v57
    v_sub_f32 v57, 0, v60
    v_mul_f32 v58, 0x3a800000, v58
    v_mul_f32 v59, 0x3a800000, v59
    v_fma_f32 v59, -v58, v58, v59
    v_max_f32 v59, 0, v59
    v_add_f32 v59, 0x3727c5ac, v59
    v_rsq_f32 v59, v59
    s_nop 0
    v_mul_f32 v60, v58, v59
    v_mov_b32 v58, v59
    v_sub_f32 v59, 0, v60
    s_lshl_b32 s3, s30, 4
    s_add_u32 s3, s3, 149888
    v_mov_b32 v65, s3
    ds_write_b128 v65, v[56:59]
    s_waitcnt lgkmcnt(0)
    s_waitcnt vmcnt(11)
    s_barrier
    s_add_u32 s33, s43, s31
    s_add_u32 m0, s33, 0
    s_nop 0
    buffer_load_dwordx4 v2, s[4:7], s40 offen lds
    s_add_u32 m0, s33, 1024
    s_nop 0
    buffer_load_dwordx4 v3, s[4:7], s40 offen lds
    s_add_u32 m0, s33, 2048
    s_nop 0
    buffer_load_dwordx4 v4, s[4:7], s40 offen lds
    s_add_u32 m0, s33, 3072
    s_nop 0
    buffer_load_dwordx4 v5, s[4:7], s40 offen lds
    s_add_u32 m0, s33, 4096
    s_nop 0
    buffer_load_dwordx4 v6, s[4:7], s40 offen lds
    s_add_u32 m0, s33, 5120
    s_nop 0
    buffer_load_dwordx4 v7, s[4:7], s40 offen lds
    s_add_u32 m0, s33, 6144
    s_nop 0
    buffer_load_dwordx4 v8, s[4:7], s40 offen lds
    s_add_u32 m0, s33, 7168
    s_nop 0
    buffer_load_dwordx4 v9, s[4:7], s40 offen lds
    s_add_u32 s33, s43, s32
    s_add_u32 m0, s33, 0
    s_nop 0
    buffer_load_dwordx4 v10, s[8:11], s41 offen lds
    s_add_u32 m0, s33, 1024
    s_nop 0
    buffer_load_dwordx4 v11, s[8:11], s41 offen lds
    s_add_u32 m0, s33, 2048
    s_nop 0
    buffer_load_dwordx4 v12, s[8:11], s41 offen lds
    s_add_u32 s40, s40, 128
    s_add_u32 s41, s41, 393216
    s_add_u32 s43, s43, 45056
    s_cmp_ge_u32 s43, 135168
    s_cselect_b32 s43, 0, s43
    s_waitcnt vmcnt(11)
    s_barrier
    s_add_u32 s33, s43, s31
    s_add_u32 m0, s33, 0
    s_nop 0
    buffer_load_dwordx4 v2, s[4:7], s40 offen lds
    s_add_u32 m0, s33, 1024
    s_nop 0
    buffer_load_dwordx4 v3, s[4:7], s40 offen lds
    s_add_u32 m0, s33, 2048
    s_nop 0
    buffer_load_dwordx4 v4, s[4:7], s40 offen lds
    s_add_u32 m0, s33, 3072
    s_nop 0
    buffer_load_dwordx4 v5, s[4:7], s40 offen lds
    s_add_u32 m0, s33, 4096
    s_nop 0
    buffer_load_dwordx4 v6, s[4:7], s40 offen lds
    s_add_u32 m0, s33, 5120
    s_nop 0
    buffer_load_dwordx4 v7, s[4:7], s40 offen lds
    s_add_u32 m0, s33, 6144
    s_nop 0
    buffer_load_dwordx4 v8, s[4:7], s40 offen lds
    s_add_u32 m0, s33, 7168
    s_nop 0
    buffer_load_dwordx4 v9, s[4:7], s40 offen lds
    s_add_u32 s33, s43, s32
    s_add_u32 m0, s33, 0
    s_nop 0
    buffer_load_dwordx4 v10, s[8:11], s41 offen lds
    s_add_u32 m0, s33, 1024
    s_nop 0
    buffer_load_dwordx4 v11, s[8:11], s41 offen lds
    s_add_u32 m0, s33, 2048
    s_nop 0
    buffer_load_dwordx4 v12, s[8:11], s41 offen lds
    s_add_u32 s40, s40, 128
    s_add_u32 s41, s41, 393216
    s_add_u32 s43, s43, 45056
    s_cmp_ge_u32 s43, 135168
    s_cselect_b32 s43, 0, s43
    s_waitcnt vmcnt(11)
    s_barrier
    s_add_u32 s33, s43, s31
    s_add_u32 m0, s33, 0
    s_nop 0
    buffer_load_dwordx4 v2, s[4:7], s40 offen lds
    s_add_u32 m0, s33, 1024
    s_nop 0
    buffer_load_dwordx4 v3, s[4:7], s40 offen lds
    s_add_u32 m0, s33, 2048
    s_nop 0
    buffer_load_dwordx4 v4, s[4:7], s40 offen lds
    s_add_u32 m0, s33, 3072
    s_nop 0
    buffer_load_dwordx4 v5, s[4:7], s40 offen lds
    s_add_u32 m0, s33, 4096
    s_nop 0
    buffer_load_dwordx4 v6, s[4:7], s40 offen lds
    s_add_u32 m0, s33, 5120
    s_nop 0
    buffer_load_dwordx4 v7, s[4:7], s40 offen lds
    s_add_u32 m0, s33, 6144
    s_nop 0
    buffer_load_dwordx4 v8, s[4:7], s40 offen lds
    s_add_u32 m0, s33, 7168
    s_nop 0
    buffer_load_dwordx4 v9, s[4:7], s40 offen lds
    s_add_u32 s33, s43, s32
    s_add_u32 m0, s33, 0
    s_nop 0
    buffer_load_dwordx4 v10, s[8:11], s41 offen lds
    s_add_u32 m0, s33, 1024
    s_nop 0
    buffer_load_dwordx4 v11, s[8:11], s41 offen lds
    s_add_u32 m0, s33, 2048
    s_nop 0
    buffer_load_dwordx4 v12, s[8:11], s41 offen lds
    s_add_u32 s40, s40, 128
    s_add_u32 s41, s41, 393216
    s_add_u32 s43, s43, 45056
    s_cmp_ge_u32 s43, 135168
    s_cselect_b32 s43, 0, s43
    s_waitcnt vmcnt(11)
    s_barrier
    s_add_u32 s33, s43, s31
    s_add_u32 m0, s33, 0
    s_nop 0
    buffer_load_dwordx4 v2, s[4:7], s40 offen lds
    s_add_u32 m0, s33, 1024
    s_nop 0
    buffer_load_dwordx4 v3, s[4:7], s40 offen lds
    s_add_u32 m0, s33, 2048
    s_nop 0
    buffer_load_dwordx4 v4, s[4:7], s40 offen lds
    s_add_u32 m0, s33, 3072
    s_nop 0
    buffer_load_dwordx4 v5, s[4:7], s40 offen lds
    s_add_u32 m0, s33, 4096
    s_nop 0
    buffer_load_dwordx4 v6, s[4:7], s40 offen lds
    s_add_u32 m0, s33, 5120
    s_nop 0
    buffer_load_dwordx4 v7, s[4:7], s40 offen lds
    s_add_u32 m0, s33, 6144
    s_nop 0
    buffer_load_dwordx4 v8, s[4:7], s40 offen lds
    s_add_u32 m0, s33, 7168
    s_nop 0
    buffer_load_dwordx4 v9, s[4:7], s40 offen lds
    s_add_u32 s33, s43, s32
    s_add_u32 m0, s33, 0
    s_nop 0
    buffer_load_dwordx4 v10, s[8:11], s41 offen lds
    s_add_u32 m0, s33, 1024
    s_nop 0
    buffer_load_dwordx4 v11, s[8:11], s41 offen lds
    s_add_u32 m0, s33, 2048
    s_nop 0
    buffer_load_dwordx4 v12, s[8:11], s41 offen lds
    s_add_u32 s40, s40, 128
    s_add_u32 s41, s41, 393216
    s_add_u32 s43, s43, 45056
    s_cmp_ge_u32 s43, 135168
    s_cselect_b32 s43, 0, s43
    s_waitcnt vmcnt(11)
    s_barrier
    s_add_u32 s33, s43, s31
    s_add_u32 m0, s33, 0
    s_nop 0
    buffer_load_dwordx4 v2, s[4:7], s40 offen lds
    s_add_u32 m0, s33, 1024
    s_nop 0
    buffer_load_dwordx4 v3, s[4:7], s40 offen lds
    s_add_u32 m0, s33, 2048
    s_nop 0
    buffer_load_dwordx4 v4, s[4:7], s40 offen lds
    s_add_u32 m0, s33, 3072
    s_nop 0
    buffer_load_dwordx4 v5, s[4:7], s40 offen lds
    s_add_u32 m0, s33, 4096
    s_nop 0
    buffer_load_dwordx4 v6, s[4:7], s40 offen lds
    s_add_u32 m0, s33, 5120
    s_nop 0
    buffer_load_dwordx4 v7, s[4:7], s40 offen lds
    s_add_u32 m0, s33, 6144
    s_nop 0
    buffer_load_dwordx4 v8, s[4:7], s40 offen lds
    s_add_u32 m0, s33, 7168
    s_nop 0
    buffer_load_dwordx4 v9, s[4:7], s40 offen lds
    s_add_u32 s33, s43, s32
    s_add_u32 m0, s33, 0
    s_nop 0
    buffer_load_dwordx4 v10, s[8:11], s41 offen lds
    s_add_u32 m0, s33, 1024
    s_nop 0
    buffer_load_dwordx4 v11, s[8:11], s41 offen lds
    s_add_u32 m0, s33, 2048
    s_nop 0
    buffer_load_dwordx4 v12, s[8:11], s41 offen lds
    s_add_u32 s40, s40, 128
    s_add_u32 s41, s41, 393216
    s_add_u32 s43, s43, 45056
    s_cmp_ge_u32 s43, 135168
    s_cselect_b32 s43, 0, s43
    s_waitcnt vmcnt(11)
    s_barrier
    s_add_u32 s33, s43, s31
    s_add_u32 m0, s33, 0
    s_nop 0
    buffer_load_dwordx4 v2, s[4:7], s40 offen lds
    s_add_u32 m0, s33, 1024
    s_nop 0
    buffer_load_dwordx4 v3, s[4:7], s40 offen lds
    s_add_u32 m0, s33, 2048
    s_nop 0
    buffer_load_dwordx4 v4, s[4:7], s40 offen lds
    s_add_u32 m0, s33, 3072
    s_nop 0
    buffer_load_dwordx4 v5, s[4:7], s40 offen lds
    s_add_u32 m0, s33, 4096
    s_nop 0
    buffer_load_dwordx4 v6, s[4:7], s40 offen lds
    s_add_u32 m0, s33, 5120
    s_nop 0
    buffer_load_dwordx4 v7, s[4:7], s40 offen lds
    s_add_u32 m0, s33, 6144
    s_nop 0
    buffer_load_dwordx4 v8, s[4:7], s40 offen lds
    s_add_u32 m0, s33, 7168
    s_nop 0
    buffer_load_dwordx4 v9, s[4:7], s40 offen lds
    s_add_u32 s33, s43, s32
    s_add_u32 m0, s33, 0
    s_nop 0
    buffer_load_dwordx4 v10, s[8:11], s41 offen lds
    s_add_u32 m0, s33, 1024
    s_nop 0
    buffer_load_dwordx4 v11, s[8:11], s41 offen lds
    s_add_u32 m0, s33, 2048
    s_nop 0
    buffer_load_dwordx4 v12, s[8:11], s41 offen lds
    s_add_u32 s40, s40, 128
    s_add_u32 s41, s41, 393216
    s_add_u32 s43, s43, 45056
    s_cmp_ge_u32 s43, 135168
    s_cselect_b32 s43, 0, s43
    s_waitcnt vmcnt(11)
    s_barrier
    s_add_u32 s33, s43, s31
    s_add_u32 m0, s33, 0
    s_nop 0
    buffer_load_dwordx4 v2, s[4:7], s40 offen lds
    s_add_u32 m0, s33, 1024
    s_nop 0
    buffer_load_dwordx4 v3, s[4:7], s40 offen lds
    s_add_u32 m0, s33, 2048
    s_nop 0
    buffer_load_dwordx4 v4, s[4:7], s40 offen lds
    s_add_u32 m0, s33, 3072
    s_nop 0
    buffer_load_dwordx4 v5, s[4:7], s40 offen lds
    s_add_u32 m0, s33, 4096
    s_nop 0
    buffer_load_dwordx4 v6, s[4:7], s40 offen lds
    s_add_u32 m0, s33, 5120
    s_nop 0
    buffer_load_dwordx4 v7, s[4:7], s40 offen lds
    s_add_u32 m0, s33, 6144
    s_nop 0
    buffer_load_dwordx4 v8, s[4:7], s40 offen lds
    s_add_u32 m0, s33, 7168
    s_nop 0
    buffer_load_dwordx4 v9, s[4:7], s40 offen lds
    s_add_u32 s33, s43, s32
    s_add_u32 m0, s33, 0
    s_nop 0
    buffer_load_dwordx4 v10, s[8:11], s41 offen lds
    s_add_u32 m0, s33, 1024
    s_nop 0
    buffer_load_dwordx4 v11, s[8:11], s41 offen lds
    s_add_u32 m0, s33, 2048
    s_nop 0
    buffer_load_dwordx4 v12, s[8:11], s41 offen lds
    s_add_u32 s40, s40, 128
    s_add_u32 s41, s41, 393216
    s_add_u32 s43, s43, 45056
    s_cmp_ge_u32 s43, 135168
    s_cselect_b32 s43, 0, s43
    s_waitcnt vmcnt(11)
    s_barrier
    s_add_u32 s33, s43, s31
    s_add_u32 m0, s33, 0
    s_nop 0
    buffer_load_dwordx4 v2, s[4:7], s40 offen lds
    s_add_u32 m0, s33, 1024
    s_nop 0
    buffer_load_dwordx4 v3, s[4:7], s40 offen lds
    s_add_u32 m0, s33, 2048
    s_nop 0
    buffer_load_dwordx4 v4, s[4:7], s40 offen lds
    s_add_u32 m0, s33, 3072
    s_nop 0
    buffer_load_dwordx4 v5, s[4:7], s40 offen lds
    s_add_u32 m0, s33, 4096
    s_nop 0
    buffer_load_dwordx4 v6, s[4:7], s40 offen lds
    s_add_u32 m0, s33, 5120
    s_nop 0
    buffer_load_dwordx4 v7, s[4:7], s40 offen lds
    s_add_u32 m0, s33, 6144
    s_nop 0
    buffer_load_dwordx4 v8, s[4:7], s40 offen lds
    s_add_u32 m0, s33, 7168
    s_nop 0
    buffer_load_dwordx4 v9, s[4:7], s40 offen lds
    s_add_u32 s33, s43, s32
    s_add_u32 m0, s33, 0
    s_nop 0
    buffer_load_dwordx4 v10, s[8:11], s41 offen lds
    s_add_u32 m0, s33, 1024
    s_nop 0
    buffer_load_dwordx4 v11, s[8:11], s41 offen lds
    s_add_u32 m0, s33, 2048
    s_nop 0
    buffer_load_dwordx4 v12, s[8:11], s41 offen lds
    s_add_u32 s40, s40, 128
    s_add_u32 s41, s41, 393216
    s_add_u32 s43, s43, 45056
    s_cmp_ge_u32 s43, 135168
    s_cselect_b32 s43, 0, s43
    s_waitcnt vmcnt(11)
    s_barrier
    s_add_u32 s33, s43, s31
    s_add_u32 m0, s33, 0
    s_nop 0
    buffer_load_dwordx4 v2, s[4:7], s40 offen lds
    s_add_u32 m0, s33, 1024
    s_nop 0
    buffer_load_dwordx4 v3, s[4:7], s40 offen lds
    s_add_u32 m0, s33, 2048
    s_nop 0
    buffer_load_dwordx4 v4, s[4:7], s40 offen lds
    s_add_u32 m0, s33, 3072
    s_nop 0
    buffer_load_dwordx4 v5, s[4:7], s40 offen lds
    s_add_u32 m0, s33, 4096
    s_nop 0
    buffer_load_dwordx4 v6, s[4:7], s40 offen lds
    s_add_u32 m0, s33, 5120
    s_nop 0
    buffer_load_dwordx4 v7, s[4:7], s40 offen lds
    s_add_u32 m0, s33, 6144
    s_nop 0
    buffer_load_dwordx4 v8, s[4:7], s40 offen lds
    s_add_u32 m0, s33, 7168
    s_nop 0
    buffer_load_dwordx4 v9, s[4:7], s40 offen lds
    s_add_u32 s33, s43, s32
    s_add_u32 m0, s33, 0
    s_nop 0
    buffer_load_dwordx4 v10, s[8:11], s41 offen lds
    s_add_u32 m0, s33, 1024
    s_nop 0
    buffer_load_dwordx4 v11, s[8:11], s41 offen lds
    s_add_u32 m0, s33, 2048
    s_nop 0
    buffer_load_dwordx4 v12, s[8:11], s41 offen lds
    s_add_u32 s40, s40, 128
    s_add_u32 s41, s41, 393216
    s_add_u32 s43, s43, 45056
    s_cmp_ge_u32 s43, 135168
    s_cselect_b32 s43, 0, s43
    s_waitcnt vmcnt(11)
    s_barrier
    s_add_u32 s33, s43, s31
    s_add_u32 m0, s33, 0
    s_nop 0
    buffer_load_dwordx4 v2, s[4:7], s40 offen lds
    s_add_u32 m0, s33, 1024
    s_nop 0
    buffer_load_dwordx4 v3, s[4:7], s40 offen lds
    s_add_u32 m0, s33, 2048
    s_nop 0
    buffer_load_dwordx4 v4, s[4:7], s40 offen lds
    s_add_u32 m0, s33, 3072
    s_nop 0
    buffer_load_dwordx4 v5, s[4:7], s40 offen lds
    s_add_u32 m0, s33, 4096
    s_nop 0
    buffer_load_dwordx4 v6, s[4:7], s40 offen lds
    s_add_u32 m0, s33, 5120
    s_nop 0
    buffer_load_dwordx4 v7, s[4:7], s40 offen lds
    s_add_u32 m0, s33, 6144
    s_nop 0
    buffer_load_dwordx4 v8, s[4:7], s40 offen lds
    s_add_u32 m0, s33, 7168
    s_nop 0
    buffer_load_dwordx4 v9, s[4:7], s40 offen lds
    s_add_u32 s33, s43, s32
    s_add_u32 m0, s33, 0
    s_nop 0
    buffer_load_dwordx4 v10, s[8:11], s41 offen lds
    s_add_u32 m0, s33, 1024
    s_nop 0
    buffer_load_dwordx4 v11, s[8:11], s41 offen lds
    s_add_u32 m0, s33, 2048
    s_nop 0
    buffer_load_dwordx4 v12, s[8:11], s41 offen lds
    s_add_u32 s40, s40, 128
    s_add_u32 s41, s41, 393216
    s_add_u32 s43, s43, 45056
    s_cmp_ge_u32 s43, 135168
    s_cselect_b32 s43, 0, s43
    s_waitcnt vmcnt(11)
    s_barrier
    s_cmp_lg_u32 s30, 0
    s_cbranch_scc1 L_l1_77
    v_lshlrev_b32 v18, 4, v1
    s_lshl_b32 s3, s28, 12
    buffer_load_dwordx4 v[72:75], v18, s[36:39], s3 offen offset:0 sc0 sc1
    buffer_load_dwordx4 v[76:79], v18, s[36:39], s3 offen offset:1024 sc0 sc1
    buffer_load_dwordx4 v[80:83], v18, s[36:39], s3 offen offset:2048 sc0 sc1
    buffer_load_dwordx4 v[84:87], v18, s[36:39], s3 offen offset:3072 sc0 sc1
L_l1_77:
    s_add_u32 s33, s43, s31
    s_add_u32 m0, s33, 0
    s_nop 0
    buffer_load_dwordx4 v2, s[4:7], s40 offen lds
    s_add_u32 m0, s33, 1024
    s_nop 0
    buffer_load_dwordx4 v3, s[4:7], s40 offen lds
    s_add_u32 m0, s33, 2048
    s_nop 0
    buffer_load_dwordx4 v4, s[4:7], s40 offen lds
    s_add_u32 m0, s33, 3072
    s_nop 0
    buffer_load_dwordx4 v5, s[4:7], s40 offen lds
    s_add_u32 m0, s33, 4096
    s_nop 0
    buffer_load_dwordx4 v6, s[4:7], s40 offen lds
    s_add_u32 m0, s33, 5120
    s_nop 0
    buffer_load_dwordx4 v7, s[4:7], s40 offen lds
    s_add_u32 m0, s33, 6144
    s_nop 0
    buffer_load_dwordx4 v8, s[4:7], s40 offen lds
    s_add_u32 m0, s33, 7168
    s_nop 0
    buffer_load_dwordx4 v9, s[4:7], s40 offen lds
    s_add_u32 s33, s43, s32
    s_add_u32 m0, s33, 0
    s_nop 0
    buffer_load_dwordx4 v10, s[8:11], s41 offen lds
    s_add_u32 m0, s33, 1024
    s_nop 0
    buffer_load_dwordx4 v11, s[8:11], s41 offen lds
    s_add_u32 m0, s33, 2048
    s_nop 0
    buffer_load_dwordx4 v12, s[8:11], s41 offen lds
    s_add_u32 s40, s40, 128
    s_add_u32 s41, s41, 393216
    s_add_u32 s43, s43, 45056
    s_cmp_ge_u32 s43, 135168
    s_cselect_b32 s43, 0, s43
    s_waitcnt vmcnt(11)
    s_barrier
    s_cmp_lg_u32 s30, 0
    s_cbranch_scc1 L_l2_78
    s_mov_b64 s[54:55], exec
    v_cmp_lt_u64 vcc, s[34:35], v[74:75]
    v_cmp_gt_u64 s[56:57], s[20:21], v[74:75]
    s_nop 3
    s_and_b64 s[54:55], s[54:55], vcc
    s_and_b64 s[54:55], s[54:55], s[56:57]
    v_cmp_lt_u64 vcc, s[34:35], v[78:79]
    v_cmp_gt_u64 s[56:57], s[20:21], v[78:79]
    s_nop 3
    s_and_b64 s[54:55], s[54:55], vcc
    s_and_b64 s[54:55], s[54:55], s[56:57]
    v_cmp_lt_u64 vcc, s[34:35], v[82:83]
    v_cmp_gt_u64 s[56:57], s[20:21], v[82:83]
    s_nop 3
    s_and_b64 s[54:55], s[54:55], vcc
    s_and_b64 s[54:55], s[54:55], s[56:57]
    v_cmp_lt_u64 vcc, s[34:35], v[86:87]
    v_cmp_gt_u64 s[56:57], s[20:21], v[86:87]
    s_nop 3
    s_and_b64 s[54:55], s[54:55], vcc
    s_and_b64 s[54:55], s[54:55], s[56:57]
    s_cmp_lg_u64 s[54:55], exec
    s_cbranch_scc1 L_l2_78
    s_mov_b32 s53, 1
    v_lshlrev_b32 v18, 3, v1
    v_add_u32 v18, 147456, v18
    ds_write_b64 v18, v[72:73] offset:0
    ds_write_b64 v18, v[76:77] offset:512
    ds_write_b64 v18, v[80:81] offset:1024
    ds_write_b64 v18, v[84:85] offset:1536
    s_waitcnt lgkmcnt(0)
L_l2_78:
    s_add_u32 s33, s43, s31
    s_add_u32 m0, s33, 0
    s_nop 0
    buffer_load_dwordx4 v2, s[4:7], s40 offen lds
    s_add_u32 m0, s33, 1024
    s_nop 0
    buffer_load_dwordx4 v3, s[4:7], s40 offen lds
    s_add_u32 m0, s33, 2048
    s_nop 0
    buffer_load_dwordx4 v4, s[4:7], s40 offen lds
    s_add_u32 m0, s33, 3072
    s_nop 0
    buffer_load_dwordx4 v5, s[4:7], s40 offen lds
    s_add_u32 m0, s33, 4096
    s_nop 0
    buffer_load_dwordx4 v6, s[4:7], s40 offen lds
    s_add_u32 m0, s33, 5120
    s_nop 0
    buffer_load_dwordx4 v7, s[4:7], s40 offen lds
    s_add_u32 m0, s33, 6144
    s_nop 0
    buffer_load_dwordx4 v8, s[4:7], s40 offen lds
    s_add_u32 m0, s33, 7168
    s_nop 0
    buffer_load_dwordx4 v9, s[4:7], s40 offen lds
    s_add_u32 s33, s43, s32
    s_add_u32 m0, s33, 0
    s_nop 0
    buffer_load_dwordx4 v10, s[8:11], s41 offen lds
    s_add_u32 m0, s33, 1024
    s_nop 0
    buffer_load_dwordx4 v11, s[8:11], s41 offen lds
    s_add_u32 m0, s33, 2048
    s_nop 0
    buffer_load_dwordx4 v12, s[8:11], s41 offen lds
    s_add_u32 s40, s40, 128
    s_add_u32 s41, s41, 393216
    s_add_u32 s43, s43, 45056
    s_cmp_ge_u32 s43, 135168
    s_cselect_b32 s43, 0, s43
    s_waitcnt vmcnt(11)
    s_barrier
    s_waitcnt vmcnt(0)
    s_barrier
    v_mov_b32 v18, 150144
    ds_read_b32 v18, v18
    s_waitcnt lgkmcnt(0)
    v_readfirstlane_b32 s3, v18
    s_nop 3
    v_writelane_b32 v255, s3, 20
    s_mov_b32 s3, 0
    buffer_load_dwordx4 v[164:167], v218, s[76:79], s3 offen
    s_mov_b32 s3, 57344
    buffer_load_dwordx4 v[168:171], v218, s[76:79], s3 offen
    s_mov_b32 s3, 114688
    buffer_load_dwordx4 v[172:175], v218, s[76:79], s3 offen
    s_mov_b32 s3, 172032
    buffer_load_dwordx4 v[176:179], v218, s[76:79], s3 offen
    s_mov_b32 s3, 229376
    buffer_load_dwordx4 v[180:183], v218, s[76:79], s3 offen
    s_mov_b32 s3, 286720
    buffer_load_dwordx4 v[184:187], v218, s[76:79], s3 offen
    s_mov_b32 s3, 344064
    buffer_load_dwordx4 v[188:191], v218, s[76:79], s3 offen
    s_mov_b32 s3, 401408
    buffer_load_dwordx4 v[192:195], v218, s[76:79], s3 offen
    v_lshrrev_b32 v18, 3, v1
    v_and_b32 v19, 7, v1
    v_lshlrev_b32 v19, 4, v19
    v_lshl_add_u32 v219, v18, 10, v19
    s_lshl_b32 s3, s92, 11
    v_lshl_add_u32 v20, v18, 11, v19
    s_lshl_b32 s3, s92, 14
    s_and_b32 s89, s89, 0xffff
    s_cmp_eq_u32 s28, 0
    s_cselect_b64 exec, -1, 0
    buffer_load_dwordx4 v[232:235], v20, s[88:91], s3 offen offset:384
    buffer_load_dwordx4 v[244:247], v20, s[88:91], s3 offen offset:1408
    s_mov_b64 exec, -1
    v_lshl_add_u32 v219, v18, 8, v19
    s_branch L_lend_76
L_l2p_75:
    s_add_u32 s33, s43, s31
    s_add_u32 m0, s33, 0
    s_nop 0
    buffer_load_dwordx4 v2, s[4:7], s40 offen lds
    s_add_u32 m0, s33, 1024
    s_nop 0
    buffer_load_dwordx4 v3, s[4:7], s40 offen lds
    s_add_u32 m0, s33, 2048
    s_nop 0
    buffer_load_dwordx4 v4, s[4:7], s40 offen lds
    s_add_u32 m0, s33, 3072
    s_nop 0
    buffer_load_dwordx4 v5, s[4:7], s40 offen lds
    s_add_u32 m0, s33, 4096
    s_nop 0
    buffer_load_dwordx4 v6, s[4:7], s40 offen lds
    s_add_u32 m0, s33, 5120
    s_nop 0
    buffer_load_dwordx4 v7, s[4:7], s40 offen lds
    s_add_u32 m0, s33, 6144
    s_nop 0
    buffer_load_dwordx4 v8, s[4:7], s40 offen lds
    s_add_u32 m0, s33, 7168
    s_nop 0
    buffer_load_dwordx4 v9, s[4:7], s40 offen lds
    s_add_u32 s33, s43, s32
    s_add_u32 m0, s33, 0
    s_nop 0
    buffer_load_dwordx4 v10, s[8:11], s41 offen lds
    s_add_u32 m0, s33, 1024
    s_nop 0
    buffer_load_dwordx4 v11, s[8:11], s41 offen lds
    s_add_u32 m0, s33, 2048
    s_nop 0
    buffer_load_dwordx4 v12, s[8:11], s41 offen lds
    s_add_u32 s40, s40, 128
    s_add_u32 s41, s41, 393216
    s_add_u32 s43, s43, 45056
    s_cmp_ge_u32 s43, 135168
    s_cselect_b32 s43, 0, s43
    s_add_u32 s33, s43, s31
    s_add_u32 m0, s33, 0
    s_nop 0
    buffer_load_dwordx4 v2, s[4:7], s40 offen lds
    s_add_u32 m0, s33, 1024
    s_nop 0
    buffer_load_dwordx4 v3, s[4:7], s40 offen lds
    s_add_u32 m0, s33, 2048
    s_nop 0
    buffer_load_dwordx4 v4, s[4:7], s40 offen lds
    s_add_u32 m0, s33, 3072
    s_nop 0
    buffer_load_dwordx4 v5, s[4:7], s40 offen lds
    s_add_u32 m0, s33, 4096
    s_nop 0
    buffer_load_dwordx4 v6, s[4:7], s40 offen lds
    s_add_u32 m0, s33, 5120
    s_nop 0
    buffer_load_dwordx4 v7, s[4:7], s40 offen lds
    s_add_u32 m0, s33, 6144
    s_nop 0
    buffer_load_dwordx4 v8, s[4:7], s40 offen lds
    s_add_u32 m0, s33, 7168
    s_nop 0
    buffer_load_dwordx4 v9, s[4:7], s40 offen lds
    s_add_u32 s33, s43, s32
    s_add_u32 m0, s33, 0
    s_nop 0
    buffer_load_dwordx4 v10, s[8:11], s41 offen lds
    s_add_u32 m0, s33, 1024
    s_nop 0
    buffer_load_dwordx4 v11, s[8:11], s41 offen lds
    s_add_u32 m0, s33, 2048
    s_nop 0
    buffer_load_dwordx4 v12, s[8:11], s41 offen lds
    s_add_u32 s40, s40, 128
    s_add_u32 s41, s41, 393216
    s_add_u32 s43, s43, 45056
    s_cmp_ge_u32 s43, 135168
    s_cselect_b32 s43, 0, s43
    s_mov_b32 s48, 14
L_lloop_79:
    s_waitcnt vmcnt(11)
    s_barrier
    s_add_u32 s33, s43, s31
    s_add_u32 m0, s33, 0
    s_nop 0
    buffer_load_dwordx4 v2, s[4:7], s40 offen lds
    s_add_u32 m0, s33, 1024
    s_nop 0
    buffer_load_dwordx4 v3, s[4:7], s40 offen lds
    s_add_u32 m0, s33, 2048
    s_nop 0
    buffer_load_dwordx4 v4, s[4:7], s40 offen lds
    s_add_u32 m0, s33, 3072
    s_nop 0
    buffer_load_dwordx4 v5, s[4:7], s40 offen lds
    s_add_u32 m0, s33, 4096
    s_nop 0
    buffer_load_dwordx4 v6, s[4:7], s40 offen lds
    s_add_u32 m0, s33, 5120
    s_nop 0
    buffer_load_dwordx4 v7, s[4:7], s40 offen lds
    s_add_u32 m0, s33, 6144
    s_nop 0
    buffer_load_dwordx4 v8, s[4:7], s40 offen lds
    s_add_u32 m0, s33, 7168
    s_nop 0
    buffer_load_dwordx4 v9, s[4:7], s40 offen lds
    s_add_u32 s33, s43, s32
    s_add_u32 m0, s33, 0
    s_nop 0
    buffer_load_dwordx4 v10, s[8:11], s41 offen lds
    s_add_u32 m0, s33, 1024
    s_nop 0
    buffer_load_dwordx4 v11, s[8:11], s41 offen lds
    s_add_u32 m0, s33, 2048
    s_nop 0
    buffer_load_dwordx4 v12, s[8:11], s41 offen lds
    s_add_u32 s40, s40, 128
    s_add_u32 s41, s41, 393216
    s_add_u32 s43, s43, 45056
    s_cmp_ge_u32 s43, 135168
    s_cselect_b32 s43, 0, s43
    s_sub_u32 s48, s48, 1
    s_cmp_lg_u32 s48, 0
    s_cbranch_scc1 L_lloop_79
    s_waitcnt vmcnt(11)
    s_barrier
    s_waitcnt vmcnt(0)
    s_barrier
L_lend_76:
    v_mov_b32 v19, 149952
    s_cmp_lg_u32 s30, 0
    s_cbranch_scc1 L_l4_80
    v_mov_b32 v18, s53
    ds_write_b32 v19, v18
    v_mov_b32 v72, 0
    v_mov_b32 v73, 0
    v_mov_b32 v74, 0
    v_mov_b32 v75, 0
    ds_write_b128 v19, v[72:75] offset:64
    s_waitcnt lgkmcnt(0)
L_l4_80:
    s_barrier
    ds_read_b32 v20, v19
    s_waitcnt lgkmcnt(0)
    v_readfirstlane_b32 s3, v20
    s_nop 3
    s_cmp_eq_u32 s3, 1
    s_cbranch_scc1 L_stok_81
    s_mov_b32 s101, 1
    s_lshl_b32 s46, s49, 5
    s_add_u32 s47, s46, s98
    s_mov_b32 s52, 16
L_ls_82:
    v_lshlrev_b32 v56, 5, v1
    s_lshl_b32 s3, s47, 11
    buffer_load_dwordx4 v[40:43], v56, s[4:7], s3 offen offset:0
    buffer_load_dwordx4 v[44:47], v56, s[4:7], s3 offen offset:16
    buffer_load_dwordx4 v[48:51], v56, s[4:7], s3 offen offset:2048
    buffer_load_dwordx4 v[52:55], v56, s[4:7], s3 offen offset:2064
    s_waitcnt vmcnt(0)
    v_mov_b32 v64, 0x3f803f80
    v_mov_b32 v56, 0
    v_mov_b32 v57, 0
    v_mov_b32 v58, 0
    v_mov_b32 v59, 0
    v_dot2_f32_bf16 v56, v40, v64, v56
    v_dot2_f32_bf16 v57, v40, v40, v57
    v_dot2_f32_bf16 v56, v41, v64, v56
    v_dot2_f32_bf16 v57, v41, v41, v57
    v_dot2_f32_bf16 v56, v42, v64, v56
    v_dot2_f32_bf16 v57, v42, v42, v57
    v_dot2_f32_bf16 v56, v43, v64, v56
    v_dot2_f32_bf16 v57, v43, v43, v57
    v_dot2_f32_bf16 v56, v44, v64, v56
    v_dot2_f32_bf16 v57, v44, v44, v57
    v_dot2_f32_bf16 v56, v45, v64, v56
    v_dot2_f32_bf16 v57, v45, v45, v57
    v_dot2_f32_bf16 v56, v46, v64, v56
    v_dot2_f32_bf16 v57, v46, v46, v57
    v_dot2_f32_bf16 v56, v47, v64, v56
    v_dot2_f32_bf16 v57, v47, v47, v57
    v_dot2_f32_bf16 v58, v48, v64, v58
    v_dot2_f32_bf16 v59, v48, v48, v59
    v_dot2_f32_bf16 v58, v49, v64, v58
    v_dot2_f32_bf16 v59, v49, v49, v59
    v_dot2_f32_bf16 v58, v50, v64, v58
    v_dot2_f32_bf16 v59, v50, v50, v59
    v_dot2_f32_bf16 v58, v51, v64, v58
    v_dot2_f32_bf16 v59, v51, v51, v59
    v_dot2_f32_bf16 v58, v52, v64, v58
    v_dot2_f32_bf16 v59, v52, v52, v59
    v_dot2_f32_bf16 v58, v53, v64, v58
    v_dot2_f32_bf16 v59, v53, v53, v59
    v_dot2_f32_bf16 v58, v54, v64, v58
    v_dot2_f32_bf16 v59, v54, v54, v59
    v_dot2_f32_bf16 v58, v55, v64, v58
    v_dot2_f32_bf16 v59, v55, v55, v59
    s_nop 3
    v_add_f32_dpp v60, v56, v56 quad_perm:[1,0,3,2] row_mask:0xf bank_mask:0xf
    v_add_f32_dpp v61, v57, v57 quad_perm:[1,0,3,2] row_mask:0xf bank_mask:0xf
    v_add_f32_dpp v62, v58, v58 quad_perm:[1,0,3,2] row_mask:0xf bank_mask:0xf
    v_add_f32_dpp v63, v59, v59 quad_perm:[1,0,3,2] row_mask:0xf bank_mask:0xf
    s_nop 1
    v_add_f32_dpp v56, v60, v60 quad_perm:[2,3,0,1] row_mask:0xf bank_mask:0xf
    v_add_f32_dpp v57, v61, v61 quad_perm:[2,3,0,1] row_mask:0xf bank_mask:0xf
    v_add_f32_dpp v58, v62, v62 quad_perm:[2,3,0,1] row_mask:0xf bank_mask:0xf
    v_add_f32_dpp v59, v63, v63 quad_perm:[2,3,0,1] row_mask:0xf bank_mask:0xf
    s_nop 1
    v_add_f32_dpp v60, v56, v56 row_half_mirror row_mask:0xf bank_mask:0xf
    v_add_f32_dpp v61, v57, v57 row_half_mirror row_mask:0xf bank_mask:0xf
    v_add_f32_dpp v62, v58, v58 row_half_mirror row_mask:0xf bank_mask:0xf
    v_add_f32_dpp v63, v59, v59 row_half_mirror row_mask:0xf bank_mask:0xf
    s_nop 1
    v_add_f32_dpp v56, v60, v60 row_mirror row_mask:0xf bank_mask:0xf
    v_add_f32_dpp v57, v61, v61 row_mirror row_mask:0xf bank_mask:0xf
    v_add_f32_dpp v58, v62, v62 row_mirror row_mask:0xf bank_mask:0xf
    v_add_f32_dpp v59, v63, v63 row_mirror row_mask:0xf bank_mask:0xf
    s_nop 1
    v_xor_b32 v65, 16, v1
    v_lshlrev_b32 v65, 2, v65
    ds_bpermute_b32 v60, v65, v56
    ds_bpermute_b32 v61, v65, v57
    ds_bpermute_b32 v62, v65, v58
    ds_bpermute_b32 v63, v65, v59
    s_waitcnt lgkmcnt(0)
    v_add_f32 v56, v56, v60
    v_add_f32 v57, v57, v61
    v_add_f32 v58, v58, v62
    v_add_f32 v59, v59, v63
    v_xor_b32 v65, 32, v1
    v_lshlrev_b32 v65, 2, v65
    ds_bpermute_b32 v60, v65, v56
    ds_bpermute_b32 v61, v65, v57
    ds_bpermute_b32 v62, v65, v58
    ds_bpermute_b32 v63, v65, v59
    s_waitcnt lgkmcnt(0)
    v_add_f32 v56, v56, v60
    v_add_f32 v57, v57, v61
    v_add_f32 v58, v58, v62
    v_add_f32 v59, v59, v63
    v_mul_f32 v56, 0x3a800000, v56
    v_mul_f32 v57, 0x3a800000, v57
    v_fma_f32 v57, -v56, v56, v57
    v_max_f32 v57, 0, v57
    v_add_f32 v57, 0x3727c5ac, v57
    v_rsq_f32 v57, v57
    s_nop 0
    v_mul_f32 v60, v56, v57
    v_mov_b32 v56, v57
    v_sub_f32 v57, 0, v60
    v_mul_f32 v58, 0x3a800000, v58
    v_mul_f32 v59, 0x3a800000, v59
    v_fma_f32 v59, -v58, v58, v59
    v_max_f32 v59, 0, v59
    v_add_f32 v59, 0x3727c5ac, v59
    v_rsq_f32 v59, v59
    s_nop 0
    v_mul_f32 v60, v58, v59
    v_mov_b32 v58, v59
    v_sub_f32 v59, 0, v60
    s_lshl_b32 s3, s46, 3
    s_add_u32 s3, s3, 147456
    v_mov_b32 v65, s3
    ds_write_b128 v65, v[56:59]
    s_add_u32 s46, s46, 2
    s_add_u32 s47, s47, 2
    s_sub_u32 s52, s52, 1
    s_cmp_lg_u32 s52, 0
    s_cbranch_scc1 L_ls_82
    s_waitcnt lgkmcnt(0)
    s_barrier
L_stok_81:
    s_barrier
L_att_3:
    s_setprio 0
    s_sub_u32 s3, 11, s49
    s_cmp_lt_u32 s49, 4
    s_cselect_b32 s44, s49, s3
    v_and_b32 v8, 31, v1
    v_lshrrev_b32 v9, 5, v1
    v_lshlrev_b32 v12, 4, v1
    v_xor_b32 v10, 32, v1
    v_lshlrev_b32 v10, 2, v10
    v_mov_b32 v11, 0xf149f2ca
    v_mov_b32 v216, 0
    v_and_b32 v13, 15, v1
    v_lshlrev_b32 v13, 4, v13
    v_lshl_add_u32 v13, v9, 8, v13
    v_bfe_u32 v15, v1, 4, 1
    v_lshl_add_u32 v13, v15, 10, v13
    s_lshl_b32 s3, s44, 11
    s_add_u32 s46, s3, 100352
    v_add_u32 v2, s46, v13
    v_add_u32 v3, 512, v2
    s_add_u32 s46, s3, 65536
    v_add_u32 v5, s46, v13
    v_add_u32 v6, 512, v5
    s_add_u32 s46, s3, 98304
    v_add_u32 v13, s46, v13
    v_bfe_u32 v14, v1, 2, 2
    v_lshl_add_u32 v14, v9, 2, v14
    v_lshlrev_b32 v14, 4, v14
    v_lshl_add_u32 v14, v15, 3, v14
    v_and_b32 v15, 3, v1
    v_mul_u32_u24 v15, 320, v15
    v_xor_b32 v14, v14, v15
    s_add_u32 s46, s3, 116736
    v_add_u32 v4, s46, v14
    v_xor_b32 v210, 128, v4
    s_add_u32 s46, s3, 81920
    v_add_u32 v7, s46, v14
    v_xor_b32 v213, 128, v7
    s_cmp_lg_u32 s45, 1
    s_cbranch_scc1 L_reload_84
    ds_read_b128 v[224:227], v13
    ds_read_b128 v[228:231], v13 offset:512
    s_mov_b32 s33, 1
    s_mov_b32 s95, 0
    s_cmp_lt_u32 s49, 4
    s_cbranch_scc1 L_pubw_86
    s_branch L_astart_83
L_pubw_86:
    s_mov_b32 s33, 0
L_astart_83:
    v_lshlrev_b32 v13, 2, v9
    v_sub_u32 v13, v8, v13
    v_cmp_le_i32 s[52:53], 0, v13
    v_mov_b32 v16, v216
    v_cndmask_b32 v32, v11, v216, s[52:53]
    v_cndmask_b32 v48, v216, v11, s[52:53]
    v_cmp_le_i32 s[54:55], 1, v13
    v_mov_b32 v17, v216
    v_cndmask_b32 v33, v11, v216, s[54:55]
    v_cndmask_b32 v49, v216, v11, s[54:55]
    v_cmp_le_i32 s[52:53], 2, v13
    v_mov_b32 v18, v216
    v_cndmask_b32 v34, v11, v216, s[52:53]
    v_cndmask_b32 v50, v216, v11, s[52:53]
    v_cmp_le_i32 s[54:55], 3, v13
    v_mov_b32 v19, v216
    v_cndmask_b32 v35, v11, v216, s[54:55]
    v_cndmask_b32 v51, v216, v11, s[54:55]
    v_cmp_le_i32 s[52:53], 8, v13
    v_mov_b32 v20, v216
    v_cndmask_b32 v36, v11, v216, s[52:53]
    v_cndmask_b32 v52, v216, v11, s[52:53]
    v_cmp_le_i32 s[54:55], 9, v13
    v_mov_b32 v21, v216
    v_cndmask_b32 v37, v11, v216, s[54:55]
    v_cndmask_b32 v53, v216, v11, s[54:55]
    v_cmp_le_i32 s[52:53], 10, v13
    v_mov_b32 v22, v216
    v_cndmask_b32 v38, v11, v216, s[52:53]
    v_cndmask_b32 v54, v216, v11, s[52:53]
    v_cmp_le_i32 s[54:55], 11, v13
    v_mov_b32 v23, v216
    v_cndmask_b32 v39, v11, v216, s[54:55]
    v_cndmask_b32 v55, v216, v11, s[54:55]
    v_cmp_le_i32 s[52:53], 16, v13
    v_mov_b32 v24, v216
    v_cndmask_b32 v40, v11, v216, s[52:53]
    v_cndmask_b32 v56, v216, v11, s[52:53]
    v_cmp_le_i32 s[54:55], 17, v13
    v_mov_b32 v25, v216
    v_cndmask_b32 v41, v11, v216, s[54:55]
    v_cndmask_b32 v57, v216, v11, s[54:55]
    v_cmp_le_i32 s[52:53], 18, v13
    v_mov_b32 v26, v216
    v_cndmask_b32 v42, v11, v216, s[52:53]
    v_cndmask_b32 v58, v216, v11, s[52:53]
    v_cmp_le_i32 s[54:55], 19, v13
    v_mov_b32 v27, v216
    v_cndmask_b32 v43, v11, v216, s[54:55]
    v_cndmask_b32 v59, v216, v11, s[54:55]
    v_cmp_le_i32 s[52:53], 24, v13
    v_mov_b32 v28, v216
    v_cndmask_b32 v44, v11, v216, s[52:53]
    v_cndmask_b32 v60, v216, v11, s[52:53]
    v_cmp_le_i32 s[54:55], 25, v13
    v_mov_b32 v29, v216
    v_cndmask_b32 v45, v11, v216, s[54:55]
    v_cndmask_b32 v61, v216, v11, s[54:55]
    v_cmp_le_i32 s[52:53], 26, v13
    v_mov_b32 v30, v216
    v_cndmask_b32 v46, v11, v216, s[52:53]
    v_cndmask_b32 v62, v216, v11, s[52:53]
    v_cmp_le_i32 s[54:55], 27, v13
    v_mov_b32 v31, v216
    v_cndmask_b32 v47, v11, v216, s[54:55]
    v_cndmask_b32 v63, v216, v11, s[54:55]
    v_mov_b32 v144, 0
    v_mov_b32 v145, 0
    v_mov_b32 v146, 0
    v_mov_b32 v147, 0
    v_mov_b32 v148, 0
    v_mov_b32 v149, 0
    v_mov_b32 v150, 0
    v_mov_b32 v151, 0
    v_mov_b32 v152, 0
    v_mov_b32 v153, 0
    v_mov_b32 v154, 0
    v_mov_b32 v155, 0
    v_mov_b32 v156, 0
    v_mov_b32 v157, 0
    v_mov_b32 v158, 0
    v_mov_b32 v159, 0
    v_mov_b32 v160, 0
    v_mov_b32 v161, 0
    v_mov_b32 v162, 0
    v_mov_b32 v163, 0
    s_or_b32 s3, s33, s50
    s_cmp_lg_u32 s3, 0
    s_cbranch_scc1 L_kvf_87
    s_mov_b32 s33, 1
    s_memrealtime s[22:23]
    s_lshl_b32 s3, s99, 7
    s_lshr_b32 s46, s3, 1
    s_xor_b32 s46, s46, s3
    s_bfe_u32 s46, s46, 0x1000d
    s_mul_i32 s46, s46, 24576
    s_xor_b32 s3, s3, s46
    v_readlane_b32 s46, v255, 20
    s_xor_b32 s3, s3, 0x2000
    s_nop 0
    s_xor_b32 s3, s3, s46
    s_lshl_b32 s46, s49, 3
    s_add_u32 s3, s3, s46
    s_add_u32 s3, s3, 65536
    v_mov_b32 v13, 0
    s_waitcnt vmcnt(0) lgkmcnt(0)
    v_mov_b32 v200, s22
    v_mov_b32 v201, s23
    s_mov_b64 exec, 1
    buffer_store_dwordx2 v[200:201], v13, s[36:39], s3 offen sc0 sc1
    s_mov_b64 exec, -1
L_kvf_87:
    ds_read_b128 v[96:99], v2 offset:14336
    ds_read_b128 v[100:103], v3 offset:14336
    ds_read_b128 v[104:107], v2 offset:12288
    ds_read_b128 v[108:111], v3 offset:12288
    s_waitcnt lgkmcnt(2)
    v_mfma_f32_32x32x16_bf16 v[64:79], v[96:99], v[224:227], v[32:47]
    v_mfma_f32_32x32x16_bf16 v[64:79], v[100:103], v[228:231], v[64:79]
    ds_read_b64_tr_b16 v[112:113], v4 offset:14336
    ds_read_b64_tr_b16 v[114:115], v210 offset:14336
    ds_read_b64_tr_b16 v[116:117], v4 offset:15360
    ds_read_b64_tr_b16 v[118:119], v210 offset:15360
    s_waitcnt lgkmcnt(4)
    v_mfma_f32_32x32x16_bf16 v[80:95], v[104:107], v[224:227], v[16:31]
    s_nop 7
    s_nop 7
    s_nop 7
    v_exp_f32 v64, v64
    v_exp_f32 v65, v65
    v_exp_f32 v66, v66
    v_exp_f32 v67, v67
    v_mfma_f32_32x32x16_bf16 v[80:95], v[108:111], v[228:231], v[80:95]
    ds_read_b128 v[96:99], v2 offset:10240
    ds_read_b128 v[100:103], v3 offset:10240
    v_exp_f32 v68, v68
    v_exp_f32 v69, v69
    v_exp_f32 v70, v70
    v_exp_f32 v71, v71
    v_pk_add_f32 v[160:161], v[160:161], v[64:65]
    v_cvt_pk_bf16_f32 v128, v64, v65
    v_pk_add_f32 v[162:163], v[162:163], v[66:67]
    v_cvt_pk_bf16_f32 v129, v66, v67
    v_exp_f32 v72, v72
    v_exp_f32 v73, v73
    v_exp_f32 v74, v74
    v_exp_f32 v75, v75
    v_pk_add_f32 v[160:161], v[160:161], v[68:69]
    v_cvt_pk_bf16_f32 v130, v68, v69
    v_pk_add_f32 v[162:163], v[162:163], v[70:71]
    v_cvt_pk_bf16_f32 v131, v70, v71
    s_waitcnt lgkmcnt(2)
    v_mfma_f32_32x32x16_bf16 v[144:159], v[112:115], v[128:131], v[144:159]
    v_exp_f32 v76, v76
    v_exp_f32 v77, v77
    v_exp_f32 v78, v78
    v_exp_f32 v79, v79
    v_pk_add_f32 v[160:161], v[160:161], v[72:73]
    v_cvt_pk_bf16_f32 v132, v72, v73
    v_pk_add_f32 v[162:163], v[162:163], v[74:75]
    v_cvt_pk_bf16_f32 v133, v74, v75
    s_nop 0
    v_pk_add_f32 v[160:161], v[160:161], v[76:77]
    v_cvt_pk_bf16_f32 v134, v76, v77
    v_pk_add_f32 v[162:163], v[162:163], v[78:79]
    v_cvt_pk_bf16_f32 v135, v78, v79
    s_nop 1
    v_mfma_f32_32x32x16_bf16 v[144:159], v[116:119], v[132:135], v[144:159]
    s_cmp_eq_u32 s44, 0
    s_cbranch_scc1 L_p1e_88
    ds_read_b64_tr_b16 v[120:121], v4 offset:12288
    ds_read_b64_tr_b16 v[122:123], v210 offset:12288
    ds_read_b64_tr_b16 v[124:125], v4 offset:13312
    ds_read_b64_tr_b16 v[126:127], v210 offset:13312
    s_waitcnt lgkmcnt(4)
    v_mfma_f32_32x32x16_bf16 v[64:79], v[96:99], v[224:227], v[16:31]
    v_exp_f32 v80, v80
    v_exp_f32 v81, v81
    v_exp_f32 v82, v82
    v_exp_f32 v83, v83
    v_mfma_f32_32x32x16_bf16 v[64:79], v[100:103], v[228:231], v[64:79]
    ds_read_b128 v[104:107], v2 offset:8192
    ds_read_b128 v[108:111], v3 offset:8192
    v_exp_f32 v84, v84
    v_exp_f32 v85, v85
    v_exp_f32 v86, v86
    v_exp_f32 v87, v87
    v_pk_add_f32 v[160:161], v[160:161], v[80:81]
    v_cvt_pk_bf16_f32 v136, v80, v81
    v_pk_add_f32 v[162:163], v[162:163], v[82:83]
    v_cvt_pk_bf16_f32 v137, v82, v83
    v_exp_f32 v88, v88
    v_exp_f32 v89, v89
    v_exp_f32 v90, v90
    v_exp_f32 v91, v91
    v_pk_add_f32 v[160:161], v[160:161], v[84:85]
    v_cvt_pk_bf16_f32 v138, v84, v85
    v_pk_add_f32 v[162:163], v[162:163], v[86:87]
    v_cvt_pk_bf16_f32 v139, v86, v87
    s_waitcnt lgkmcnt(2)
    v_mfma_f32_32x32x16_bf16 v[144:159], v[120:123], v[136:139], v[144:159]
    v_exp_f32 v92, v92
    v_exp_f32 v93, v93
    v_exp_f32 v94, v94
    v_exp_f32 v95, v95
    v_pk_add_f32 v[160:161], v[160:161], v[88:89]
    v_cvt_pk_bf16_f32 v140, v88, v89
    v_pk_add_f32 v[162:163], v[162:163], v[90:91]
    v_cvt_pk_bf16_f32 v141, v90, v91
    s_nop 0
    v_pk_add_f32 v[160:161], v[160:161], v[92:93]
    v_cvt_pk_bf16_f32 v142, v92, v93
    v_pk_add_f32 v[162:163], v[162:163], v[94:95]
    v_cvt_pk_bf16_f32 v143, v94, v95
    s_nop 1
    v_mfma_f32_32x32x16_bf16 v[144:159], v[124:127], v[140:143], v[144:159]
    s_cmp_eq_u32 s44, 1
    s_cbranch_scc1 L_p1e_88
    ds_read_b64_tr_b16 v[112:113], v4 offset:10240
    ds_read_b64_tr_b16 v[114:115], v210 offset:10240
    ds_read_b64_tr_b16 v[116:117], v4 offset:11264
    ds_read_b64_tr_b16 v[118:119], v210 offset:11264
    s_waitcnt lgkmcnt(4)
    v_mfma_f32_32x32x16_bf16 v[80:95], v[104:107], v[224:227], v[16:31]
    v_exp_f32 v64, v64
    v_exp_f32 v65, v65
    v_exp_f32 v66, v66
    v_exp_f32 v67, v67
    v_mfma_f32_32x32x16_bf16 v[80:95], v[108:111], v[228:231], v[80:95]
    ds_read_b128 v[96:99], v2 offset:6144
    ds_read_b128 v[100:103], v3 offset:6144
    v_exp_f32 v68, v68
    v_exp_f32 v69, v69
    v_exp_f32 v70, v70
    v_exp_f32 v71, v71
    v_pk_add_f32 v[160:161], v[160:161], v[64:65]
    v_cvt_pk_bf16_f32 v128, v64, v65
    v_pk_add_f32 v[162:163], v[162:163], v[66:67]
    v_cvt_pk_bf16_f32 v129, v66, v67
    v_exp_f32 v72, v72
    v_exp_f32 v73, v73
    v_exp_f32 v74, v74
    v_exp_f32 v75, v75
    v_pk_add_f32 v[160:161], v[160:161], v[68:69]
    v_cvt_pk_bf16_f32 v130, v68, v69
    v_pk_add_f32 v[162:163], v[162:163], v[70:71]
    v_cvt_pk_bf16_f32 v131, v70, v71
    s_waitcnt lgkmcnt(2)
    v_mfma_f32_32x32x16_bf16 v[144:159], v[112:115], v[128:131], v[144:159]
    v_exp_f32 v76, v76
    v_exp_f32 v77, v77
    v_exp_f32 v78, v78
    v_exp_f32 v79, v79
    v_pk_add_f32 v[160:161], v[160:161], v[72:73]
    v_cvt_pk_bf16_f32 v132, v72, v73
    v_pk_add_f32 v[162:163], v[162:163], v[74:75]
    v_cvt_pk_bf16_f32 v133, v74, v75
    s_nop 0
    v_pk_add_f32 v[160:161], v[160:161], v[76:77]
    v_cvt_pk_bf16_f32 v134, v76, v77
    v_pk_add_f32 v[162:163], v[162:163], v[78:79]
    v_cvt_pk_bf16_f32 v135, v78, v79
    s_nop 1
    v_mfma_f32_32x32x16_bf16 v[144:159], v[116:119], v[132:135], v[144:159]
    s_cmp_eq_u32 s44, 2
    s_cbranch_scc1 L_p1e_88
    ds_read_b64_tr_b16 v[120:121], v4 offset:8192
    ds_read_b64_tr_b16 v[122:123], v210 offset:8192
    ds_read_b64_tr_b16 v[124:125], v4 offset:9216
    ds_read_b64_tr_b16 v[126:127], v210 offset:9216
    s_waitcnt lgkmcnt(4)
    v_mfma_f32_32x32x16_bf16 v[64:79], v[96:99], v[224:227], v[16:31]
    v_exp_f32 v80, v80
    v_exp_f32 v81, v81
    v_exp_f32 v82, v82
    v_exp_f32 v83, v83
    v_mfma_f32_32x32x16_bf16 v[64:79], v[100:103], v[228:231], v[64:79]
    ds_read_b128 v[104:107], v2 offset:4096
    ds_read_b128 v[108:111], v3 offset:4096
    v_exp_f32 v84, v84
    v_exp_f32 v85, v85
    v_exp_f32 v86, v86
    v_exp_f32 v87, v87
    v_pk_add_f32 v[160:161], v[160:161], v[80:81]
    v_cvt_pk_bf16_f32 v136, v80, v81
    v_pk_add_f32 v[162:163], v[162:163], v[82:83]
    v_cvt_pk_bf16_f32 v137, v82, v83
    v_exp_f32 v88, v88
    v_exp_f32 v89, v89
    v_exp_f32 v90, v90
    v_exp_f32 v91, v91
    v_pk_add_f32 v[160:161], v[160:161], v[84:85]
    v_cvt_pk_bf16_f32 v138, v84, v85
    v_pk_add_f32 v[162:163], v[162:163], v[86:87]
    v_cvt_pk_bf16_f32 v139, v86, v87
    s_waitcnt lgkmcnt(2)
    v_mfma_f32_32x32x16_bf16 v[144:159], v[120:123], v[136:139], v[144:159]
    v_exp_f32 v92, v92
    v_exp_f32 v93, v93
    v_exp_f32 v94, v94
    v_exp_f32 v95, v95
    v_pk_add_f32 v[160:161], v[160:161], v[88:89]
    v_cvt_pk_bf16_f32 v140, v88, v89
    v_pk_add_f32 v[162:163], v[162:163], v[90:91]
    v_cvt_pk_bf16_f32 v141, v90, v91
    s_nop 0
    v_pk_add_f32 v[160:161], v[160:161], v[92:93]
    v_cvt_pk_bf16_f32 v142, v92, v93
    v_pk_add_f32 v[162:163], v[162:163], v[94:95]
    v_cvt_pk_bf16_f32 v143, v94, v95
    s_nop 1
    v_mfma_f32_32x32x16_bf16 v[144:159], v[124:127], v[140:143], v[144:159]
    s_cmp_eq_u32 s44, 3
    s_cbranch_scc1 L_p1e_88
    ds_read_b64_tr_b16 v[112:113], v4 offset:6144
    ds_read_b64_tr_b16 v[114:115], v210 offset:6144
    ds_read_b64_tr_b16 v[116:117], v4 offset:7168
    ds_read_b64_tr_b16 v[118:119], v210 offset:7168
    s_waitcnt lgkmcnt(4)
    v_mfma_f32_32x32x16_bf16 v[80:95], v[104:107], v[224:227], v[16:31]
    v_exp_f32 v64, v64
    v_exp_f32 v65, v65
    v_exp_f32 v66, v66
    v_exp_f32 v67, v67
    v_mfma_f32_32x32x16_bf16 v[80:95], v[108:111], v[228:231], v[80:95]
    ds_read_b128 v[96:99], v2 offset:2048
    ds_read_b128 v[100:103], v3 offset:2048
    v_exp_f32 v68, v68
    v_exp_f32 v69, v69
    v_exp_f32 v70, v70
    v_exp_f32 v71, v71
    v_pk_add_f32 v[160:161], v[160:161], v[64:65]
    v_cvt_pk_bf16_f32 v128, v64, v65
    v_pk_add_f32 v[162:163], v[162:163], v[66:67]
    v_cvt_pk_bf16_f32 v129, v66, v67
    v_exp_f32 v72, v72
    v_exp_f32 v73, v73
    v_exp_f32 v74, v74
    v_exp_f32 v75, v75
    v_pk_add_f32 v[160:161], v[160:161], v[68:69]
    v_cvt_pk_bf16_f32 v130, v68, v69
    v_pk_add_f32 v[162:163], v[162:163], v[70:71]
    v_cvt_pk_bf16_f32 v131, v70, v71
    s_waitcnt lgkmcnt(2)
    v_mfma_f32_32x32x16_bf16 v[144:159], v[112:115], v[128:131], v[144:159]
    v_exp_f32 v76, v76
    v_exp_f32 v77, v77
    v_exp_f32 v78, v78
    v_exp_f32 v79, v79
    v_pk_add_f32 v[160:161], v[160:161], v[72:73]
    v_cvt_pk_bf16_f32 v132, v72, v73
    v_pk_add_f32 v[162:163], v[162:163], v[74:75]
    v_cvt_pk_bf16_f32 v133, v74, v75
    s_nop 0
    v_pk_add_f32 v[160:161], v[160:161], v[76:77]
    v_cvt_pk_bf16_f32 v134, v76, v77
    v_pk_add_f32 v[162:163], v[162:163], v[78:79]
    v_cvt_pk_bf16_f32 v135, v78, v79
    s_nop 1
    v_mfma_f32_32x32x16_bf16 v[144:159], v[116:119], v[132:135], v[144:159]
    s_cmp_eq_u32 s44, 4
    s_cbranch_scc1 L_p1e_88
    ds_read_b64_tr_b16 v[120:121], v4 offset:4096
    ds_read_b64_tr_b16 v[122:123], v210 offset:4096
    ds_read_b64_tr_b16 v[124:125], v4 offset:5120
    ds_read_b64_tr_b16 v[126:127], v210 offset:5120
    s_waitcnt lgkmcnt(4)
    v_mfma_f32_32x32x16_bf16 v[64:79], v[96:99], v[224:227], v[16:31]
    v_exp_f32 v80, v80
    v_exp_f32 v81, v81
    v_exp_f32 v82, v82
    v_exp_f32 v83, v83
    v_mfma_f32_32x32x16_bf16 v[64:79], v[100:103], v[228:231], v[64:79]
    ds_read_b128 v[104:107], v2 offset:0
    ds_read_b128 v[108:111], v3 offset:0
    v_exp_f32 v84, v84
    v_exp_f32 v85, v85
    v_exp_f32 v86, v86
    v_exp_f32 v87, v87
    v_pk_add_f32 v[160:161], v[160:161], v[80:81]
    v_cvt_pk_bf16_f32 v136, v80, v81
    v_pk_add_f32 v[162:163], v[162:163], v[82:83]
    v_cvt_pk_bf16_f32 v137, v82, v83
    v_exp_f32 v88, v88
    v_exp_f32 v89, v89
    v_exp_f32 v90, v90
    v_exp_f32 v91, v91
    v_pk_add_f32 v[160:161], v[160:161], v[84:85]
    v_cvt_pk_bf16_f32 v138, v84, v85
    v_pk_add_f32 v[162:163], v[162:163], v[86:87]
    v_cvt_pk_bf16_f32 v139, v86, v87
    s_waitcnt lgkmcnt(2)
    v_mfma_f32_32x32x16_bf16 v[144:159], v[120:123], v[136:139], v[144:159]
    v_exp_f32 v92, v92
    v_exp_f32 v93, v93
    v_exp_f32 v94, v94
    v_exp_f32 v95, v95
    v_pk_add_f32 v[160:161], v[160:161], v[88:89]
    v_cvt_pk_bf16_f32 v140, v88, v89
    v_pk_add_f32 v[162:163], v[162:163], v[90:91]
    v_cvt_pk_bf16_f32 v141, v90, v91
    s_nop 0
    v_pk_add_f32 v[160:161], v[160:161], v[92:93]
    v_cvt_pk_bf16_f32 v142, v92, v93
    v_pk_add_f32 v[162:163], v[162:163], v[94:95]
    v_cvt_pk_bf16_f32 v143, v94, v95
    s_nop 1
    v_mfma_f32_32x32x16_bf16 v[144:159], v[124:127], v[140:143], v[144:159]
    s_cmp_eq_u32 s44, 5
    s_cbranch_scc1 L_p1e_88
    ds_read_b64_tr_b16 v[112:113], v4 offset:2048
    ds_read_b64_tr_b16 v[114:115], v210 offset:2048
    ds_read_b64_tr_b16 v[116:117], v4 offset:3072
    ds_read_b64_tr_b16 v[118:119], v210 offset:3072
    s_waitcnt lgkmcnt(4)
    v_mfma_f32_32x32x16_bf16 v[80:95], v[104:107], v[224:227], v[16:31]
    v_exp_f32 v64, v64
    v_exp_f32 v65, v65
    v_exp_f32 v66, v66
    v_exp_f32 v67, v67
    v_mfma_f32_32x32x16_bf16 v[80:95], v[108:111], v[228:231], v[80:95]
    v_exp_f32 v68, v68
    v_exp_f32 v69, v69
    v_exp_f32 v70, v70
    v_exp_f32 v71, v71
    v_pk_add_f32 v[160:161], v[160:161], v[64:65]
    v_cvt_pk_bf16_f32 v128, v64, v65
    v_pk_add_f32 v[162:163], v[162:163], v[66:67]
    v_cvt_pk_bf16_f32 v129, v66, v67
    v_exp_f32 v72, v72
    v_exp_f32 v73, v73
    v_exp_f32 v74, v74
    v_exp_f32 v75, v75
    v_pk_add_f32 v[160:161], v[160:161], v[68:69]
    v_cvt_pk_bf16_f32 v130, v68, v69
    v_pk_add_f32 v[162:163], v[162:163], v[70:71]
    v_cvt_pk_bf16_f32 v131, v70, v71
    s_waitcnt lgkmcnt(0)
    v_mfma_f32_32x32x16_bf16 v[144:159], v[112:115], v[128:131], v[144:159]
    v_exp_f32 v76, v76
    v_exp_f32 v77, v77
    v_exp_f32 v78, v78
    v_exp_f32 v79, v79
    v_pk_add_f32 v[160:161], v[160:161], v[72:73]
    v_cvt_pk_bf16_f32 v132, v72, v73
    v_pk_add_f32 v[162:163], v[162:163], v[74:75]
    v_cvt_pk_bf16_f32 v133, v74, v75
    s_nop 0
    v_pk_add_f32 v[160:161], v[160:161], v[76:77]
    v_cvt_pk_bf16_f32 v134, v76, v77
    v_pk_add_f32 v[162:163], v[162:163], v[78:79]
    v_cvt_pk_bf16_f32 v135, v78, v79
    s_nop 1
    v_mfma_f32_32x32x16_bf16 v[144:159], v[116:119], v[132:135], v[144:159]
    s_cmp_eq_u32 s44, 6
    s_cbranch_scc1 L_p1e_88
    ds_read_b64_tr_b16 v[120:121], v4 offset:0
    ds_read_b64_tr_b16 v[122:123], v210 offset:0
    ds_read_b64_tr_b16 v[124:125], v4 offset:1024
    ds_read_b64_tr_b16 v[126:127], v210 offset:1024
    v_exp_f32 v80, v80
    v_exp_f32 v81, v81
    v_exp_f32 v82, v82
    v_exp_f32 v83, v83
    v_exp_f32 v84, v84
    v_exp_f32 v85, v85
    v_exp_f32 v86, v86
    v_exp_f32 v87, v87
    v_pk_add_f32 v[160:161], v[160:161], v[80:81]
    v_cvt_pk_bf16_f32 v136, v80, v81
    v_pk_add_f32 v[162:163], v[162:163], v[82:83]
    v_cvt_pk_bf16_f32 v137, v82, v83
    v_exp_f32 v88, v88
    v_exp_f32 v89, v89
    v_exp_f32 v90, v90
    v_exp_f32 v91, v91
    v_pk_add_f32 v[160:161], v[160:161], v[84:85]
    v_cvt_pk_bf16_f32 v138, v84, v85
    v_pk_add_f32 v[162:163], v[162:163], v[86:87]
    v_cvt_pk_bf16_f32 v139, v86, v87
    s_waitcnt lgkmcnt(0)
    v_mfma_f32_32x32x16_bf16 v[144:159], v[120:123], v[136:139], v[144:159]
    v_exp_f32 v92, v92
    v_exp_f32 v93, v93
    v_exp_f32 v94, v94
    v_exp_f32 v95, v95
    v_pk_add_f32 v[160:161], v[160:161], v[88:89]
    v_cvt_pk_bf16_f32 v140, v88, v89
    v_pk_add_f32 v[162:163], v[162:163], v[90:91]
    v_cvt_pk_bf16_f32 v141, v90, v91
    s_nop 0
    v_pk_add_f32 v[160:161], v[160:161], v[92:93]
    v_cvt_pk_bf16_f32 v142, v92, v93
    v_pk_add_f32 v[162:163], v[162:163], v[94:95]
    v_cvt_pk_bf16_f32 v143, v94, v95
    s_nop 1
    v_mfma_f32_32x32x16_bf16 v[144:159], v[124:127], v[140:143], v[144:159]
L_p1e_88:
    s_waitcnt lgkmcnt(0)
    s_cmp_lg_u32 s50, 0
    s_cbranch_scc1 L_p2_89
    s_or_b32 s3, s33, s50
    s_cmp_lg_u32 s3, 0
    s_cbranch_scc1 L_kvf_90
    s_mov_b32 s33, 1
    s_memrealtime s[22:23]
    s_lshl_b32 s3, s99, 7
    s_lshr_b32 s46, s3, 1
    s_xor_b32 s46, s46, s3
    s_bfe_u32 s46, s46, 0x1000d
    s_mul_i32 s46, s46, 24576
    s_xor_b32 s3, s3, s46
    v_readlane_b32 s46, v255, 20
    s_xor_b32 s3, s3, 0x2000
    s_nop 0
    s_xor_b32 s3, s3, s46
    s_lshl_b32 s46, s49, 3
    s_add_u32 s3, s3, s46
    s_add_u32 s3, s3, 65536
    v_mov_b32 v13, 0
    s_waitcnt vmcnt(0) lgkmcnt(0)
    v_mov_b32 v200, s22
    v_mov_b32 v201, s23
    s_mov_b64 exec, 1
    buffer_store_dwordx2 v[200:201], v13, s[36:39], s3 offen sc0 sc1
    s_mov_b64 exec, -1
L_kvf_90:
    s_cmp_lt_u32 s49, 4
    s_cbranch_scc1 L_nocs_91
    s_add_u32 s88, s24, 48234496
    s_addc_u32 s89, s25, 0
    s_and_b32 s89, s89, 0xffff
    s_mov_b32 s90, 524288
    s_mov_b32 s91, 0x00020000
    s_lshl_b32 s3, s92, 8
    s_waitcnt vmcnt(0)
    s_lshl_b32 s3, s92, 11
    s_add_u32 s46, s3, 262144
    s_cmp_eq_u32 s28, 0
    s_cselect_b64 exec, -1, 0
    buffer_store_dwordx4 v[232:235], v219, s[88:91], s3 offen sc0 sc1
    buffer_store_dwordx4 v[244:247], v219, s[88:91], s46 offen sc0 sc1
    s_mov_b64 exec, -1
    v_lshlrev_b32 v64, 16, v164
    v_and_b32 v65, 0xffff0000, v164
    v_lshlrev_b32 v66, 16, v165
    v_and_b32 v67, 0xffff0000, v165
    v_lshlrev_b32 v68, 16, v166
    v_and_b32 v69, 0xffff0000, v166
    v_lshlrev_b32 v70, 16, v167
    v_and_b32 v71, 0xffff0000, v167
    v_lshlrev_b32 v72, 16, v168
    v_and_b32 v73, 0xffff0000, v168
    v_lshlrev_b32 v74, 16, v169
    v_and_b32 v75, 0xffff0000, v169
    v_lshlrev_b32 v76, 16, v170
    v_and_b32 v77, 0xffff0000, v170
    v_lshlrev_b32 v78, 16, v171
    v_and_b32 v79, 0xffff0000, v171
    v_pk_add_f32 v[64:65], v[64:65], v[72:73]
    v_pk_add_f32 v[66:67], v[66:67], v[74:75]
    v_pk_add_f32 v[68:69], v[68:69], v[76:77]
    v_pk_add_f32 v[70:71], v[70:71], v[78:79]
    v_lshlrev_b32 v72, 16, v172
    v_and_b32 v73, 0xffff0000, v172
    v_lshlrev_b32 v74, 16, v173
    v_and_b32 v75, 0xffff0000, v173
    v_lshlrev_b32 v76, 16, v174
    v_and_b32 v77, 0xffff0000, v174
    v_lshlrev_b32 v78, 16, v175
    v_and_b32 v79, 0xffff0000, v175
    v_pk_add_f32 v[64:65], v[64:65], v[72:73]
    v_pk_add_f32 v[66:67], v[66:67], v[74:75]
    v_pk_add_f32 v[68:69], v[68:69], v[76:77]
    v_pk_add_f32 v[70:71], v[70:71], v[78:79]
    v_lshlrev_b32 v72, 16, v176
    v_and_b32 v73, 0xffff0000, v176
    v_lshlrev_b32 v74, 16, v177
    v_and_b32 v75, 0xffff0000, v177
    v_lshlrev_b32 v76, 16, v178
    v_and_b32 v77, 0xffff0000, v178
    v_lshlrev_b32 v78, 16, v179
    v_and_b32 v79, 0xffff0000, v179
    v_pk_add_f32 v[64:65], v[64:65], v[72:73]
    v_pk_add_f32 v[66:67], v[66:67], v[74:75]
    v_pk_add_f32 v[68:69], v[68:69], v[76:77]
    v_pk_add_f32 v[70:71], v[70:71], v[78:79]
    v_lshlrev_b32 v72, 16, v180
    v_and_b32 v73, 0xffff0000, v180
    v_lshlrev_b32 v74, 16, v181
    v_and_b32 v75, 0xffff0000, v181
    v_lshlrev_b32 v76, 16, v182
    v_and_b32 v77, 0xffff0000, v182
    v_lshlrev_b32 v78, 16, v183
    v_and_b32 v79, 0xffff0000, v183
    v_pk_add_f32 v[64:65], v[64:65], v[72:73]
    v_pk_add_f32 v[66:67], v[66:67], v[74:75]
    v_pk_add_f32 v[68:69], v[68:69], v[76:77]
    v_pk_add_f32 v[70:71], v[70:71], v[78:79]
    v_lshlrev_b32 v72, 16, v184
    v_and_b32 v73, 0xffff0000, v184
    v_lshlrev_b32 v74, 16, v185
    v_and_b32 v75, 0xffff0000, v185
    v_lshlrev_b32 v76, 16, v186
    v_and_b32 v77, 0xffff0000, v186
    v_lshlrev_b32 v78, 16, v187
    v_and_b32 v79, 0xffff0000, v187
    v_pk_add_f32 v[64:65], v[64:65], v[72:73]
    v_pk_add_f32 v[66:67], v[66:67], v[74:75]
    v_pk_add_f32 v[68:69], v[68:69], v[76:77]
    v_pk_add_f32 v[70:71], v[70:71], v[78:79]
    v_lshlrev_b32 v72, 16, v188
    v_and_b32 v73, 0xffff0000, v188
    v_lshlrev_b32 v74, 16, v189
    v_and_b32 v75, 0xffff0000, v189
    v_lshlrev_b32 v76, 16, v190
    v_and_b32 v77, 0xffff0000, v190
    v_lshlrev_b32 v78, 16, v191
    v_and_b32 v79, 0xffff0000, v191
    v_pk_add_f32 v[64:65], v[64:65], v[72:73]
    v_pk_add_f32 v[66:67], v[66:67], v[74:75]
    v_pk_add_f32 v[68:69], v[68:69], v[76:77]
    v_pk_add_f32 v[70:71], v[70:71], v[78:79]
    v_lshlrev_b32 v72, 16, v192
    v_and_b32 v73, 0xffff0000, v192
    v_lshlrev_b32 v74, 16, v193
    v_and_b32 v75, 0xffff0000, v193
    v_lshlrev_b32 v76, 16, v194
    v_and_b32 v77, 0xffff0000, v194
    v_lshlrev_b32 v78, 16, v195
    v_and_b32 v79, 0xffff0000, v195
    v_pk_add_f32 v[64:65], v[64:65], v[72:73]
    v_pk_add_f32 v[66:67], v[66:67], v[74:75]
    v_pk_add_f32 v[68:69], v[68:69], v[76:77]
    v_pk_add_f32 v[70:71], v[70:71], v[78:79]
    s_nop 1
    v_add_f32_dpp v72, v64, v64 row_ror:8 row_mask:0xf bank_mask:0xf
    v_add_f32_dpp v73, v65, v65 row_ror:8 row_mask:0xf bank_mask:0xf
    v_add_f32_dpp v74, v66, v66 row_ror:8 row_mask:0xf bank_mask:0xf
    v_add_f32_dpp v75, v67, v67 row_ror:8 row_mask:0xf bank_mask:0xf
    v_add_f32_dpp v76, v68, v68 row_ror:8 row_mask:0xf bank_mask:0xf
    v_add_f32_dpp v77, v69, v69 row_ror:8 row_mask:0xf bank_mask:0xf
    v_add_f32_dpp v78, v70, v70 row_ror:8 row_mask:0xf bank_mask:0xf
    v_add_f32_dpp v79, v71, v71 row_ror:8 row_mask:0xf bank_mask:0xf
    v_xor_b32 v13, 16, v1
    v_lshlrev_b32 v13, 2, v13
    ds_bpermute_b32 v64, v13, v72
    ds_bpermute_b32 v65, v13, v73
    ds_bpermute_b32 v66, v13, v74
    ds_bpermute_b32 v67, v13, v75
    ds_bpermute_b32 v68, v13, v76
    ds_bpermute_b32 v69, v13, v77
    ds_bpermute_b32 v70, v13, v78
    ds_bpermute_b32 v71, v13, v79
    s_waitcnt lgkmcnt(0)
    v_add_f32 v72, v64, v72
    v_add_f32 v73, v65, v73
    v_add_f32 v74, v66, v74
    v_add_f32 v75, v67, v75
    v_add_f32 v76, v68, v76
    v_add_f32 v77, v69, v77
    v_add_f32 v78, v70, v78
    v_add_f32_e64 v79, v71, v79
    ds_bpermute_b32 v64, v10, v72
    ds_bpermute_b32 v65, v10, v73
    ds_bpermute_b32 v66, v10, v74
    ds_bpermute_b32 v67, v10, v75
    ds_bpermute_b32 v68, v10, v76
    ds_bpermute_b32 v69, v10, v77
    ds_bpermute_b32 v70, v10, v78
    ds_bpermute_b32 v71, v10, v79
    s_waitcnt lgkmcnt(0)
    v_add_f32 v64, v64, v72
    v_add_f32 v65, v65, v73
    v_add_f32 v66, v66, v74
    v_add_f32 v67, v67, v75
    v_add_f32 v68, v68, v76
    v_add_f32 v69, v69, v77
    v_add_f32 v70, v70, v78
    v_add_f32 v71, v71, v79
    s_add_u32 s76, s24, 1048576
    s_addc_u32 s77, s25, 0
    s_and_b32 s77, s77, 0xffff
    s_mov_b32 s78, 229376
    s_mov_b32 s79, 0x00020000
    s_mul_i32 s3, s93, 14336
    s_lshl_b32 s46, s84, 8
    s_add_u32 s3, s3, s46
    v_lshlrev_b32 v13, 5, v1
    s_mov_b64 exec, 0xff
    buffer_store_dwordx4 v[64:67], v13, s[76:79], s3 offen sc0 sc1
    buffer_store_dwordx4 v[68:71], v13, s[76:79], s3 offen offset:16 sc0 sc1
    s_mov_b64 exec, -1
L_nocs_91:
    s_mov_b32 s50, 1
    s_cmp_eq_u32 s28, 0
    s_cbranch_scc1 L_p2_89
    s_cmp_ge_u32 s49, 4
    s_cbranch_scc1 L_spin_95
    s_sub_u32 s46, s99, 32
    s_lshl_b32 s47, s46, 7
    s_lshr_b32 s52, s47, 1
    s_xor_b32 s52, s52, s47
    s_bfe_u32 s52, s52, 0x1000d
    s_mul_i32 s52, s52, 24576
    s_xor_b32 s47, s47, s52
    v_readlane_b32 s52, v255, 20
    s_xor_b32 s47, s47, 0x2000
    s_nop 0
    s_xor_b32 s47, s47, s52
    s_add_u32 s47, s47, 65536
    v_and_b32 v13, 3, v1
    v_lshlrev_b32 v13, 3, v13
    s_mov_b32 s52, 48
L_poll_92:
    buffer_load_dwordx2 v[200:201], v13, s[36:39], s47 offen sc0 sc1
    s_waitcnt vmcnt(0)
    v_cmp_lt_u64 vcc, s[34:35], v[200:201]
    v_cmp_gt_u64 s[54:55], s[20:21], v[200:201]
    s_nop 3
    s_and_b64 vcc, vcc, s[54:55]
    s_cmp_eq_u64 vcc, exec
    s_cbranch_scc1 L_pollok_93
    s_sub_u32 s52, s52, 1
    s_cmp_lg_u32 s52, 0
    s_cbranch_scc1 L_poll_92
    v_mov_b32 v14, 2
    s_branch L_polld_94
L_pollok_93:
    s_lshl_b32 s3, s49, 13
    s_lshl_b32 s46, s46, 15
    s_add_u32 s46, s46, s3
    s_lshr_b32 s47, s46, 9
    s_xor_b32 s47, s47, s46
    s_bfe_u32 s47, s47, 0x1000d
    s_mul_i32 s47, s47, 4202496
    s_xor_b32 s46, s46, s47
    s_lshr_b32 s47, s46, 8
    s_and_b32 s47, s47, 0x2000
    s_xor_b32 s46, s46, s47
    v_readlane_b32 s47, v255, 20
    s_nop 0
    s_xor_b32 s46, s46, s47
    s_add_u32 m0, s3, 65536
    s_nop 0
    buffer_load_dwordx4 v12, s[16:19], s46 offen sc0 sc1 lds
    s_add_u32 s46, s46, 1024
    s_add_u32 m0, s3, 66560
    s_nop 0
    buffer_load_dwordx4 v12, s[16:19], s46 offen sc0 sc1 lds
    s_add_u32 s46, s46, 1024
    s_add_u32 m0, s3, 67584
    s_nop 0
    buffer_load_dwordx4 v12, s[16:19], s46 offen sc0 sc1 lds
    s_add_u32 s46, s46, 1024
    s_add_u32 m0, s3, 68608
    s_nop 0
    buffer_load_dwordx4 v12, s[16:19], s46 offen sc0 sc1 lds
    s_add_u32 s46, s46, 1024
    s_add_u32 m0, s3, 69632
    s_nop 0
    buffer_load_dwordx4 v12, s[16:19], s46 offen sc0 sc1 lds
    s_add_u32 s46, s46, 1024
    s_add_u32 m0, s3, 70656
    s_nop 0
    buffer_load_dwordx4 v12, s[16:19], s46 offen sc0 sc1 lds
    s_add_u32 s46, s46, 1024
    s_add_u32 m0, s3, 71680
    s_nop 0
    buffer_load_dwordx4 v12, s[16:19], s46 offen sc0 sc1 lds
    s_add_u32 s46, s46, 1024
    s_add_u32 m0, s3, 72704
    s_nop 0
    buffer_load_dwordx4 v12, s[16:19], s46 offen sc0 sc1 lds
    s_add_u32 s46, s46, 1024
    v_mov_b32 v14, 1
L_polld_94:
    s_lshl_b32 s3, s49, 2
    s_add_u32 s3, s3, 150016
    v_mov_b32 v13, s3
    s_waitcnt vmcnt(0)
    ds_write_b32 v13, v14
L_spin_95:
    v_mov_b32 v13, 150016
    ds_read_b128 v[200:203], v13
    s_waitcnt lgkmcnt(0)
    v_min_u32 v14, v200, v201
    v_min3_u32 v14, v14, v202, v203
    v_max_u32 v15, v200, v201
    v_max3_u32 v15, v15, v202, v203
    s_nop 0
    v_readfirstlane_b32 s3, v14
    v_readfirstlane_b32 s46, v15
    s_nop 3
    s_cmp_eq_u32 s3, 0
    s_sleep 1
    s_cbranch_scc1 L_spin_95
    s_cmp_eq_u32 s46, 1
    s_cbranch_scc1 L_p2_89
    s_mov_b32 s45, 2
    s_sub_u32 s98, s98, 256
    s_mov_b32 s100, 49152
    s_barrier
    s_cmp_ge_u32 s49, 4
    s_cbranch_scc1 L_fl_96
    s_mov_b32 s84, s4
    s_mov_b32 s88, s4
    s_mov_b32 s85, s5
    s_mov_b32 s89, s5
    s_mov_b32 s86, s6
    s_mov_b32 s90, s6
    s_mov_b32 s87, s7
    s_mov_b32 s91, s7
    v_mov_b32 v221, 0
    v_mov_b32 v222, 0
    s_mov_b32 s40, 0
    s_mov_b32 s41, 0
    s_branch L_cpass_6
L_fl_96:
    s_setprio 2
    s_branch L_lre_97
L_reload_84:
    s_lshl_b32 s3, s49, 12
    s_lshl_b32 s46, s99, 15
    s_add_u32 s46, s46, s3
    s_lshr_b32 s47, s46, 9
    s_xor_b32 s47, s47, s46
    s_bfe_u32 s47, s47, 0x1000d
    s_mul_i32 s47, s47, 4202496
    s_xor_b32 s46, s46, s47
    s_lshr_b32 s47, s46, 8
    s_and_b32 s47, s47, 0x2000
    s_xor_b32 s46, s46, s47
    v_readlane_b32 s47, v255, 20
    s_nop 0
    s_xor_b32 s46, s46, s47
    s_add_u32 m0, s3, 114688
    s_nop 0
    buffer_load_dwordx4 v12, s[16:19], s46 offen sc0 sc1 lds
    s_add_u32 s46, s46, 1024
    s_add_u32 m0, s3, 115712
    s_nop 0
    buffer_load_dwordx4 v12, s[16:19], s46 offen sc0 sc1 lds
    s_add_u32 s46, s46, 1024
    s_add_u32 m0, s3, 116736
    s_nop 0
    buffer_load_dwordx4 v12, s[16:19], s46 offen sc0 sc1 lds
    s_add_u32 s46, s46, 1024
    s_add_u32 m0, s3, 117760
    s_nop 0
    buffer_load_dwordx4 v12, s[16:19], s46 offen sc0 sc1 lds
    s_add_u32 s46, s46, 1024
    s_waitcnt vmcnt(0)
    s_barrier
    s_branch L_astart_83
L_p2_89:
    s_cmp_ge_u32 s49, 4
    s_cbranch_scc1 L_xe_98
    s_bfe_u32 s3, s2, 0x10002
    s_lshl_b32 s3, s3, 3
    s_bfe_u32 s46, s2, 0x30005
    s_add_u32 s3, s3, s46
    s_lshl_b32 s3, s3, 2
    s_add_u32 s3, s3, s49
    s_lshl_b32 s3, s3, 16
    s_and_b32 s46, s2, 3
    s_lshl_b32 s46, s46, 9
    s_add_u32 s3, s3, s46
    s_bfe_u32 s46, s2, 0x20003
    s_lshl_b32 s46, s46, 7
    s_add_u32 s3, s3, s46
    s_add_u32 s46, s3, 32768
    v_and_b32 v13, 15, v1
    v_bfe_u32 v14, v1, 4, 1
    v_lshlrev_b32 v13, 11, v13
    v_lshl_add_u32 v13, v14, 5, v13
    v_lshrrev_b32 v14, 5, v1
    v_lshl_add_u32 v13, v14, 4, v13
    buffer_load_dwordx4 v[164:167], v13, s[4:7], s3 offen offset:0
    buffer_load_dwordx4 v[172:175], v13, s[4:7], s3 offen offset:64
    buffer_load_dwordx4 v[168:171], v13, s[4:7], s46 offen offset:0
    buffer_load_dwordx4 v[176:179], v13, s[4:7], s46 offen offset:64
L_xe_98:
    s_cmp_eq_u32 s28, 0
    s_cbranch_scc1 L_fin_85
    ds_read_b128 v[96:99], v5 offset:0
    ds_read_b128 v[100:103], v6 offset:0
    ds_read_b128 v[104:107], v5 offset:2048
    ds_read_b128 v[108:111], v6 offset:2048
    s_waitcnt lgkmcnt(2)
    v_mfma_f32_32x32x16_bf16 v[64:79], v[96:99], v[224:227], v[48:63]
    v_mfma_f32_32x32x16_bf16 v[64:79], v[100:103], v[228:231], v[64:79]
    ds_read_b64_tr_b16 v[112:113], v7 offset:0
    ds_read_b64_tr_b16 v[114:115], v213 offset:0
    ds_read_b64_tr_b16 v[116:117], v7 offset:1024
    ds_read_b64_tr_b16 v[118:119], v213 offset:1024
    s_waitcnt lgkmcnt(4)
    v_mfma_f32_32x32x16_bf16 v[80:95], v[104:107], v[224:227], v[16:31]
    s_nop 7
    s_nop 7
    s_nop 7
    v_exp_f32 v64, v64
    v_exp_f32 v65, v65
    v_exp_f32 v66, v66
    v_exp_f32 v67, v67
    v_mfma_f32_32x32x16_bf16 v[80:95], v[108:111], v[228:231], v[80:95]
    ds_read_b128 v[96:99], v5 offset:4096
    ds_read_b128 v[100:103], v6 offset:4096
    v_exp_f32 v68, v68
    v_exp_f32 v69, v69
    v_exp_f32 v70, v70
    v_exp_f32 v71, v71
    v_pk_add_f32 v[160:161], v[160:161], v[64:65]
    v_cvt_pk_bf16_f32 v128, v64, v65
    v_pk_add_f32 v[162:163], v[162:163], v[66:67]
    v_cvt_pk_bf16_f32 v129, v66, v67
    v_exp_f32 v72, v72
    v_exp_f32 v73, v73
    v_exp_f32 v74, v74
    v_exp_f32 v75, v75
    v_pk_add_f32 v[160:161], v[160:161], v[68:69]
    v_cvt_pk_bf16_f32 v130, v68, v69
    v_pk_add_f32 v[162:163], v[162:163], v[70:71]
    v_cvt_pk_bf16_f32 v131, v70, v71
    s_waitcnt lgkmcnt(2)
    v_mfma_f32_32x32x16_bf16 v[144:159], v[112:115], v[128:131], v[144:159]
    v_exp_f32 v76, v76
    v_exp_f32 v77, v77
    v_exp_f32 v78, v78
    v_exp_f32 v79, v79
    v_pk_add_f32 v[160:161], v[160:161], v[72:73]
    v_cvt_pk_bf16_f32 v132, v72, v73
    v_pk_add_f32 v[162:163], v[162:163], v[74:75]
    v_cvt_pk_bf16_f32 v133, v74, v75
    s_nop 0
    v_pk_add_f32 v[160:161], v[160:161], v[76:77]
    v_cvt_pk_bf16_f32 v134, v76, v77
    v_pk_add_f32 v[162:163], v[162:163], v[78:79]
    v_cvt_pk_bf16_f32 v135, v78, v79
    s_nop 1
    v_mfma_f32_32x32x16_bf16 v[144:159], v[116:119], v[132:135], v[144:159]
    s_cmp_eq_u32 s44, 7
    s_cbranch_scc1 L_p2e_99
    ds_read_b64_tr_b16 v[120:121], v7 offset:2048
    ds_read_b64_tr_b16 v[122:123], v213 offset:2048
    ds_read_b64_tr_b16 v[124:125], v7 offset:3072
    ds_read_b64_tr_b16 v[126:127], v213 offset:3072
    s_waitcnt lgkmcnt(4)
    v_mfma_f32_32x32x16_bf16 v[64:79], v[96:99], v[224:227], v[16:31]
    v_exp_f32 v80, v80
    v_exp_f32 v81, v81
    v_exp_f32 v82, v82
    v_exp_f32 v83, v83
    v_mfma_f32_32x32x16_bf16 v[64:79], v[100:103], v[228:231], v[64:79]
    ds_read_b128 v[104:107], v5 offset:6144
    ds_read_b128 v[108:111], v6 offset:6144
    v_exp_f32 v84, v84
    v_exp_f32 v85, v85
    v_exp_f32 v86, v86
    v_exp_f32 v87, v87
    v_pk_add_f32 v[160:161], v[160:161], v[80:81]
    v_cvt_pk_bf16_f32 v136, v80, v81
    v_pk_add_f32 v[162:163], v[162:163], v[82:83]
    v_cvt_pk_bf16_f32 v137, v82, v83
    v_exp_f32 v88, v88
    v_exp_f32 v89, v89
    v_exp_f32 v90, v90
    v_exp_f32 v91, v91
    v_pk_add_f32 v[160:161], v[160:161], v[84:85]
    v_cvt_pk_bf16_f32 v138, v84, v85
    v_pk_add_f32 v[162:163], v[162:163], v[86:87]
    v_cvt_pk_bf16_f32 v139, v86, v87
    s_waitcnt lgkmcnt(2)
    v_mfma_f32_32x32x16_bf16 v[144:159], v[120:123], v[136:139], v[144:159]
    v_exp_f32 v92, v92
    v_exp_f32 v93, v93
    v_exp_f32 v94, v94
    v_exp_f32 v95, v95
    v_pk_add_f32 v[160:161], v[160:161], v[88:89]
    v_cvt_pk_bf16_f32 v140, v88, v89
    v_pk_add_f32 v[162:163], v[162:163], v[90:91]
    v_cvt_pk_bf16_f32 v141, v90, v91
    s_nop 0
    v_pk_add_f32 v[160:161], v[160:161], v[92:93]
    v_cvt_pk_bf16_f32 v142, v92, v93
    v_pk_add_f32 v[162:163], v[162:163], v[94:95]
    v_cvt_pk_bf16_f32 v143, v94, v95
    s_nop 1
    v_mfma_f32_32x32x16_bf16 v[144:159], v[124:127], v[140:143], v[144:159]
    s_cmp_eq_u32 s44, 6
    s_cbranch_scc1 L_p2e_99
    ds_read_b64_tr_b16 v[112:113], v7 offset:4096
    ds_read_b64_tr_b16 v[114:115], v213 offset:4096
    ds_read_b64_tr_b16 v[116:117], v7 offset:5120
    ds_read_b64_tr_b16 v[118:119], v213 offset:5120
    s_waitcnt lgkmcnt(4)
    v_mfma_f32_32x32x16_bf16 v[80:95], v[104:107], v[224:227], v[16:31]
    v_exp_f32 v64, v64
    v_exp_f32 v65, v65
    v_exp_f32 v66, v66
    v_exp_f32 v67, v67
    v_mfma_f32_32x32x16_bf16 v[80:95], v[108:111], v[228:231], v[80:95]
    ds_read_b128 v[96:99], v5 offset:8192
    ds_read_b128 v[100:103], v6 offset:8192
    v_exp_f32 v68, v68
    v_exp_f32 v69, v69
    v_exp_f32 v70, v70
    v_exp_f32 v71, v71
    v_pk_add_f32 v[160:161], v[160:161], v[64:65]
    v_cvt_pk_bf16_f32 v128, v64, v65
    v_pk_add_f32 v[162:163], v[162:163], v[66:67]
    v_cvt_pk_bf16_f32 v129, v66, v67
    v_exp_f32 v72, v72
    v_exp_f32 v73, v73
    v_exp_f32 v74, v74
    v_exp_f32 v75, v75
    v_pk_add_f32 v[160:161], v[160:161], v[68:69]
    v_cvt_pk_bf16_f32 v130, v68, v69
    v_pk_add_f32 v[162:163], v[162:163], v[70:71]
    v_cvt_pk_bf16_f32 v131, v70, v71
    s_waitcnt lgkmcnt(2)
    v_mfma_f32_32x32x16_bf16 v[144:159], v[112:115], v[128:131], v[144:159]
    v_exp_f32 v76, v76
    v_exp_f32 v77, v77
    v_exp_f32 v78, v78
    v_exp_f32 v79, v79
    v_pk_add_f32 v[160:161], v[160:161], v[72:73]
    v_cvt_pk_bf16_f32 v132, v72, v73
    v_pk_add_f32 v[162:163], v[162:163], v[74:75]
    v_cvt_pk_bf16_f32 v133, v74, v75
    s_nop 0
    v_pk_add_f32 v[160:161], v[160:161], v[76:77]
    v_cvt_pk_bf16_f32 v134, v76, v77
    v_pk_add_f32 v[162:163], v[162:163], v[78:79]
    v_cvt_pk_bf16_f32 v135, v78, v79
    s_nop 1
    v_mfma_f32_32x32x16_bf16 v[144:159], v[116:119], v[132:135], v[144:159]
    s_cmp_eq_u32 s44, 5
    s_cbranch_scc1 L_p2e_99
    ds_read_b64_tr_b16 v[120:121], v7 offset:6144
    ds_read_b64_tr_b16 v[122:123], v213 offset:6144
    ds_read_b64_tr_b16 v[124:125], v7 offset:7168
    ds_read_b64_tr_b16 v[126:127], v213 offset:7168
    s_waitcnt lgkmcnt(4)
    v_mfma_f32_32x32x16_bf16 v[64:79], v[96:99], v[224:227], v[16:31]
    v_exp_f32 v80, v80
    v_exp_f32 v81, v81
    v_exp_f32 v82, v82
    v_exp_f32 v83, v83
    v_mfma_f32_32x32x16_bf16 v[64:79], v[100:103], v[228:231], v[64:79]
    ds_read_b128 v[104:107], v5 offset:10240
    ds_read_b128 v[108:111], v6 offset:10240
    v_exp_f32 v84, v84
    v_exp_f32 v85, v85
    v_exp_f32 v86, v86
    v_exp_f32 v87, v87
    v_pk_add_f32 v[160:161], v[160:161], v[80:81]
    v_cvt_pk_bf16_f32 v136, v80, v81
    v_pk_add_f32 v[162:163], v[162:163], v[82:83]
    v_cvt_pk_bf16_f32 v137, v82, v83
    v_exp_f32 v88, v88
    v_exp_f32 v89, v89
    v_exp_f32 v90, v90
    v_exp_f32 v91, v91
    v_pk_add_f32 v[160:161], v[160:161], v[84:85]
    v_cvt_pk_bf16_f32 v138, v84, v85
    v_pk_add_f32 v[162:163], v[162:163], v[86:87]
    v_cvt_pk_bf16_f32 v139, v86, v87
    s_waitcnt lgkmcnt(2)
    v_mfma_f32_32x32x16_bf16 v[144:159], v[120:123], v[136:139], v[144:159]
    v_exp_f32 v92, v92
    v_exp_f32 v93, v93
    v_exp_f32 v94, v94
    v_exp_f32 v95, v95
    v_pk_add_f32 v[160:161], v[160:161], v[88:89]
    v_cvt_pk_bf16_f32 v140, v88, v89
    v_pk_add_f32 v[162:163], v[162:163], v[90:91]
    v_cvt_pk_bf16_f32 v141, v90, v91
    s_nop 0
    v_pk_add_f32 v[160:161], v[160:161], v[92:93]
    v_cvt_pk_bf16_f32 v142, v92, v93
    v_pk_add_f32 v[162:163], v[162:163], v[94:95]
    v_cvt_pk_bf16_f32 v143, v94, v95
    s_nop 1
    v_mfma_f32_32x32x16_bf16 v[144:159], v[124:127], v[140:143], v[144:159]
    s_cmp_eq_u32 s44, 4
    s_cbranch_scc1 L_p2e_99
    ds_read_b64_tr_b16 v[112:113], v7 offset:8192
    ds_read_b64_tr_b16 v[114:115], v213 offset:8192
    ds_read_b64_tr_b16 v[116:117], v7 offset:9216
    ds_read_b64_tr_b16 v[118:119], v213 offset:9216
    s_waitcnt lgkmcnt(4)
    v_mfma_f32_32x32x16_bf16 v[80:95], v[104:107], v[224:227], v[16:31]
    v_exp_f32 v64, v64
    v_exp_f32 v65, v65
    v_exp_f32 v66, v66
    v_exp_f32 v67, v67
    v_mfma_f32_32x32x16_bf16 v[80:95], v[108:111], v[228:231], v[80:95]
    ds_read_b128 v[96:99], v5 offset:12288
    ds_read_b128 v[100:103], v6 offset:12288
    v_exp_f32 v68, v68
    v_exp_f32 v69, v69
    v_exp_f32 v70, v70
    v_exp_f32 v71, v71
    v_pk_add_f32 v[160:161], v[160:161], v[64:65]
    v_cvt_pk_bf16_f32 v128, v64, v65
    v_pk_add_f32 v[162:163], v[162:163], v[66:67]
    v_cvt_pk_bf16_f32 v129, v66, v67
    v_exp_f32 v72, v72
    v_exp_f32 v73, v73
    v_exp_f32 v74, v74
    v_exp_f32 v75, v75
    v_pk_add_f32 v[160:161], v[160:161], v[68:69]
    v_cvt_pk_bf16_f32 v130, v68, v69
    v_pk_add_f32 v[162:163], v[162:163], v[70:71]
    v_cvt_pk_bf16_f32 v131, v70, v71
    s_waitcnt lgkmcnt(2)
    v_mfma_f32_32x32x16_bf16 v[144:159], v[112:115], v[128:131], v[144:159]
    v_exp_f32 v76, v76
    v_exp_f32 v77, v77
    v_exp_f32 v78, v78
    v_exp_f32 v79, v79
    v_pk_add_f32 v[160:161], v[160:161], v[72:73]
    v_cvt_pk_bf16_f32 v132, v72, v73
    v_pk_add_f32 v[162:163], v[162:163], v[74:75]
    v_cvt_pk_bf16_f32 v133, v74, v75
    s_nop 0
    v_pk_add_f32 v[160:161], v[160:161], v[76:77]
    v_cvt_pk_bf16_f32 v134, v76, v77
    v_pk_add_f32 v[162:163], v[162:163], v[78:79]
    v_cvt_pk_bf16_f32 v135, v78, v79
    s_nop 1
    v_mfma_f32_32x32x16_bf16 v[144:159], v[116:119], v[132:135], v[144:159]
    s_cmp_eq_u32 s44, 3
    s_cbranch_scc1 L_p2e_99
    ds_read_b64_tr_b16 v[120:121], v7 offset:10240
    ds_read_b64_tr_b16 v[122:123], v213 offset:10240
    ds_read_b64_tr_b16 v[124:125], v7 offset:11264
    ds_read_b64_tr_b16 v[126:127], v213 offset:11264
    s_waitcnt lgkmcnt(4)
    v_mfma_f32_32x32x16_bf16 v[64:79], v[96:99], v[224:227], v[16:31]
    v_exp_f32 v80, v80
    v_exp_f32 v81, v81
    v_exp_f32 v82, v82
    v_exp_f32 v83, v83
    v_mfma_f32_32x32x16_bf16 v[64:79], v[100:103], v[228:231], v[64:79]
    ds_read_b128 v[104:107], v5 offset:14336
    ds_read_b128 v[108:111], v6 offset:14336
    v_exp_f32 v84, v84
    v_exp_f32 v85, v85
    v_exp_f32 v86, v86
    v_exp_f32 v87, v87
    v_pk_add_f32 v[160:161], v[160:161], v[80:81]
    v_cvt_pk_bf16_f32 v136, v80, v81
    v_pk_add_f32 v[162:163], v[162:163], v[82:83]
    v_cvt_pk_bf16_f32 v137, v82, v83
    v_exp_f32 v88, v88
    v_exp_f32 v89, v89
    v_exp_f32 v90, v90
    v_exp_f32 v91, v91
    v_pk_add_f32 v[160:161], v[160:161], v[84:85]
    v_cvt_pk_bf16_f32 v138, v84, v85
    v_pk_add_f32 v[162:163], v[162:163], v[86:87]
    v_cvt_pk_bf16_f32 v139, v86, v87
    s_waitcnt lgkmcnt(2)
    v_mfma_f32_32x32x16_bf16 v[144:159], v[120:123], v[136:139], v[144:159]
    v_exp_f32 v92, v92
    v_exp_f32 v93, v93
    v_exp_f32 v94, v94
    v_exp_f32 v95, v95
    v_pk_add_f32 v[160:161], v[160:161], v[88:89]
    v_cvt_pk_bf16_f32 v140, v88, v89
    v_pk_add_f32 v[162:163], v[162:163], v[90:91]
    v_cvt_pk_bf16_f32 v141, v90, v91
    s_nop 0
    v_pk_add_f32 v[160:161], v[160:161], v[92:93]
    v_cvt_pk_bf16_f32 v142, v92, v93
    v_pk_add_f32 v[162:163], v[162:163], v[94:95]
    v_cvt_pk_bf16_f32 v143, v94, v95
    s_nop 1
    v_mfma_f32_32x32x16_bf16 v[144:159], v[124:127], v[140:143], v[144:159]
    s_cmp_eq_u32 s44, 2
    s_cbranch_scc1 L_p2e_99
    ds_read_b64_tr_b16 v[112:113], v7 offset:12288
    ds_read_b64_tr_b16 v[114:115], v213 offset:12288
    ds_read_b64_tr_b16 v[116:117], v7 offset:13312
    ds_read_b64_tr_b16 v[118:119], v213 offset:13312
    s_waitcnt lgkmcnt(4)
    v_mfma_f32_32x32x16_bf16 v[80:95], v[104:107], v[224:227], v[16:31]
    v_exp_f32 v64, v64
    v_exp_f32 v65, v65
    v_exp_f32 v66, v66
    v_exp_f32 v67, v67
    v_mfma_f32_32x32x16_bf16 v[80:95], v[108:111], v[228:231], v[80:95]
    v_exp_f32 v68, v68
    v_exp_f32 v69, v69
    v_exp_f32 v70, v70
    v_exp_f32 v71, v71
    v_pk_add_f32 v[160:161], v[160:161], v[64:65]
    v_cvt_pk_bf16_f32 v128, v64, v65
    v_pk_add_f32 v[162:163], v[162:163], v[66:67]
    v_cvt_pk_bf16_f32 v129, v66, v67
    v_exp_f32 v72, v72
    v_exp_f32 v73, v73
    v_exp_f32 v74, v74
    v_exp_f32 v75, v75
    v_pk_add_f32 v[160:161], v[160:161], v[68:69]
    v_cvt_pk_bf16_f32 v130, v68, v69
    v_pk_add_f32 v[162:163], v[162:163], v[70:71]
    v_cvt_pk_bf16_f32 v131, v70, v71
    s_waitcnt lgkmcnt(0)
    v_mfma_f32_32x32x16_bf16 v[144:159], v[112:115], v[128:131], v[144:159]
    v_exp_f32 v76, v76
    v_exp_f32 v77, v77
    v_exp_f32 v78, v78
    v_exp_f32 v79, v79
    v_pk_add_f32 v[160:161], v[160:161], v[72:73]
    v_cvt_pk_bf16_f32 v132, v72, v73
    v_pk_add_f32 v[162:163], v[162:163], v[74:75]
    v_cvt_pk_bf16_f32 v133, v74, v75
    s_nop 0
    v_pk_add_f32 v[160:161], v[160:161], v[76:77]
    v_cvt_pk_bf16_f32 v134, v76, v77
    v_pk_add_f32 v[162:163], v[162:163], v[78:79]
    v_cvt_pk_bf16_f32 v135, v78, v79
    s_nop 1
    v_mfma_f32_32x32x16_bf16 v[144:159], v[116:119], v[132:135], v[144:159]
    s_cmp_eq_u32 s44, 1
    s_cbranch_scc1 L_p2e_99
    ds_read_b64_tr_b16 v[120:121], v7 offset:14336
    ds_read_b64_tr_b16 v[122:123], v213 offset:14336
    ds_read_b64_tr_b16 v[124:125], v7 offset:15360
    ds_read_b64_tr_b16 v[126:127], v213 offset:15360
    v_exp_f32 v80, v80
    v_exp_f32 v81, v81
    v_exp_f32 v82, v82
    v_exp_f32 v83, v83
    v_exp_f32 v84, v84
    v_exp_f32 v85, v85
    v_exp_f32 v86, v86
    v_exp_f32 v87, v87
    v_pk_add_f32 v[160:161], v[160:161], v[80:81]
    v_cvt_pk_bf16_f32 v136, v80, v81
    v_pk_add_f32 v[162:163], v[162:163], v[82:83]
    v_cvt_pk_bf16_f32 v137, v82, v83
    v_exp_f32 v88, v88
    v_exp_f32 v89, v89
    v_exp_f32 v90, v90
    v_exp_f32 v91, v91
    v_pk_add_f32 v[160:161], v[160:161], v[84:85]
    v_cvt_pk_bf16_f32 v138, v84, v85
    v_pk_add_f32 v[162:163], v[162:163], v[86:87]
    v_cvt_pk_bf16_f32 v139, v86, v87
    s_waitcnt lgkmcnt(0)
    v_mfma_f32_32x32x16_bf16 v[144:159], v[120:123], v[136:139], v[144:159]
    v_exp_f32 v92, v92
    v_exp_f32 v93, v93
    v_exp_f32 v94, v94
    v_exp_f32 v95, v95
    v_pk_add_f32 v[160:161], v[160:161], v[88:89]
    v_cvt_pk_bf16_f32 v140, v88, v89
    v_pk_add_f32 v[162:163], v[162:163], v[90:91]
    v_cvt_pk_bf16_f32 v141, v90, v91
    s_nop 0
    v_pk_add_f32 v[160:161], v[160:161], v[92:93]
    v_cvt_pk_bf16_f32 v142, v92, v93
    v_pk_add_f32 v[162:163], v[162:163], v[94:95]
    v_cvt_pk_bf16_f32 v143, v94, v95
    s_nop 1
    v_mfma_f32_32x32x16_bf16 v[144:159], v[124:127], v[140:143], v[144:159]
L_p2e_99:
    s_waitcnt lgkmcnt(0)
L_fin_85:
    v_add_f32 v160, v160, v161
    v_add_f32 v162, v162, v163
    v_add_f32 v160, v160, v162
    ds_bpermute_b32 v161, v10, v160
    s_waitcnt lgkmcnt(0)
    v_add_f32 v160, v160, v161
    s_cmp_lg_u32 s51, 0
    s_cbranch_scc1 L_out_100
    v_mov_b32 v14, 0x2b800000
    v_mov_b32 v13, 0x53800000
    v_cmp_lt_f32 s[52:53], v14, v160
    v_cmp_lt_f32 s[54:55], v160, v13
    s_nop 3
    s_and_b64 s[52:53], s[52:53], s[54:55]
    s_cmp_eq_u64 s[52:53], exec
    s_cbranch_scc1 L_out_100
    s_mov_b32 s51, 1
    v_mov_b32 v216, v11
    v_add_u32 v13, 14336, v2
    v_add_u32 v14, 14336, v3
    s_mov_b32 s52, s44
    ds_read_b128 v[96:99], v13
    ds_read_b128 v[100:103], v14
    s_waitcnt lgkmcnt(0)
    v_mfma_f32_32x32x16_bf16 v[64:79], v[96:99], v[224:227], v[32:47]
    v_mfma_f32_32x32x16_bf16 v[64:79], v[100:103], v[228:231], v[64:79]
    s_nop 7
    s_nop 7
    s_nop 7
    s_nop 0
    v_max3_f32 v216, v216, v64, v65
    v_max3_f32 v216, v216, v66, v67
    v_max3_f32 v216, v216, v68, v69
    v_max3_f32 v216, v216, v70, v71
    v_max3_f32 v216, v216, v72, v73
    v_max3_f32 v216, v216, v74, v75
    v_max3_f32 v216, v216, v76, v77
    v_max3_f32 v216, v216, v78, v79
    v_add_u32 v13, -2048, v13
    v_add_u32 v14, -2048, v14
L_mx_101:
    s_cmp_eq_u32 s52, 0
    s_cbranch_scc1 L_mxe_102
    ds_read_b128 v[96:99], v13
    ds_read_b128 v[100:103], v14
    s_waitcnt lgkmcnt(0)
    v_mfma_f32_32x32x16_bf16 v[64:79], v[96:99], v[224:227], v[16:31]
    v_mfma_f32_32x32x16_bf16 v[64:79], v[100:103], v[228:231], v[64:79]
    s_nop 7
    s_nop 7
    s_nop 7
    v_max3_f32 v216, v216, v64, v65
    v_max3_f32 v216, v216, v66, v67
    v_max3_f32 v216, v216, v68, v69
    v_max3_f32 v216, v216, v70, v71
    v_max3_f32 v216, v216, v72, v73
    v_max3_f32 v216, v216, v74, v75
    v_max3_f32 v216, v216, v76, v77
    v_max3_f32 v216, v216, v78, v79
    v_add_u32 v13, -2048, v13
    v_add_u32 v14, -2048, v14
    s_sub_u32 s52, s52, 1
    s_branch L_mx_101
L_mxe_102:
    s_cmp_eq_u32 s28, 0
    s_cbranch_scc1 L_mxd_103
    v_add_u32 v13, 0, v5
    v_add_u32 v14, 0, v6
    s_sub_u32 s52, 7, s44
    ds_read_b128 v[96:99], v13
    ds_read_b128 v[100:103], v14
    s_waitcnt lgkmcnt(0)
    v_mfma_f32_32x32x16_bf16 v[64:79], v[96:99], v[224:227], v[48:63]
    v_mfma_f32_32x32x16_bf16 v[64:79], v[100:103], v[228:231], v[64:79]
    s_nop 7
    s_nop 7
    s_nop 7
    s_nop 0
    v_max3_f32 v216, v216, v64, v65
    v_max3_f32 v216, v216, v66, v67
    v_max3_f32 v216, v216, v68, v69
    v_max3_f32 v216, v216, v70, v71
    v_max3_f32 v216, v216, v72, v73
    v_max3_f32 v216, v216, v74, v75
    v_max3_f32 v216, v216, v76, v77
    v_max3_f32 v216, v216, v78, v79
    v_add_u32 v13, 2048, v13
    v_add_u32 v14, 2048, v14
L_mx_104:
    s_cmp_eq_u32 s52, 0
    s_cbranch_scc1 L_mxe_105
    ds_read_b128 v[96:99], v13
    ds_read_b128 v[100:103], v14
    s_waitcnt lgkmcnt(0)
    v_mfma_f32_32x32x16_bf16 v[64:79], v[96:99], v[224:227], v[16:31]
    v_mfma_f32_32x32x16_bf16 v[64:79], v[100:103], v[228:231], v[64:79]
    s_nop 7
    s_nop 7
    s_nop 7
    v_max3_f32 v216, v216, v64, v65
    v_max3_f32 v216, v216, v66, v67
    v_max3_f32 v216, v216, v68, v69
    v_max3_f32 v216, v216, v70, v71
    v_max3_f32 v216, v216, v72, v73
    v_max3_f32 v216, v216, v74, v75
    v_max3_f32 v216, v216, v76, v77
    v_max3_f32 v216, v216, v78, v79
    v_add_u32 v13, 2048, v13
    v_add_u32 v14, 2048, v14
    s_sub_u32 s52, s52, 1
    s_branch L_mx_104
L_mxe_105:
L_mxd_103:
    ds_bpermute_b32 v13, v10, v216
    s_waitcnt lgkmcnt(0)
    v_max_f32 v216, v216, v13
    v_sub_f32 v216, 0, v216
    s_branch L_astart_83
L_out_100:
    v_rcp_f32 v160, v160
    s_lshl_b32 s3, s28, 1
    s_lshr_b32 s46, s44, 2
    s_add_u32 s3, s3, s46
    s_lshl_b32 s3, s3, 5
    s_add_u32 s3, s3, s29
    s_lshl_b32 s3, s3, 2
    s_and_b32 s46, s44, 3
    s_add_u32 s3, s3, s46
    s_lshl_b32 s100, s99, 7
    s_lshr_b32 s46, s100, 1
    s_xor_b32 s46, s46, s100
    s_bfe_u32 s46, s46, 0x1000d
    s_mul_i32 s46, s46, 24576
    s_xor_b32 s100, s100, s46
    v_readlane_b32 s46, v255, 20
    s_xor_b32 s100, s100, 0x2000
    s_nop 0
    s_xor_b32 s100, s100, s46
    s_lshl_b32 s3, s3, 11
    s_lshr_b32 s46, s3, 8
    s_xor_b32 s46, s46, s3
    s_bfe_u32 s46, s46, 0x1000d
    s_mul_i32 s46, s46, 2105344
    s_xor_b32 s3, s3, s46
    s_lshr_b32 s46, s3, 8
    s_and_b32 s46, s46, 0x2000
    s_xor_b32 s3, s3, s46
    v_readlane_b32 s46, v255, 20
    s_nop 0
    s_xor_b32 s3, s3, s46
    s_nop 7
    v_mul_f32 v144, v144, v160
    v_mul_f32 v145, v145, v160
    v_mul_f32 v146, v146, v160
    v_mul_f32 v147, v147, v160
    v_mul_f32 v148, v148, v160
    v_mul_f32 v149, v149, v160
    v_mul_f32 v150, v150, v160
    v_mul_f32 v151, v151, v160
    v_cvt_pk_bf16_f32 v144, v144, v145
    v_cvt_pk_bf16_f32 v145, v146, v147
    v_cvt_pk_bf16_f32 v146, v148, v149
    v_cvt_pk_bf16_f32 v147, v150, v151
    buffer_store_dwordx4 v[144:147], v12, s[12:15], s3 offen offset:0 sc0 sc1
    v_mul_f32 v152, v152, v160
    v_mul_f32 v153, v153, v160
    v_mul_f32 v154, v154, v160
    v_mul_f32 v155, v155, v160
    v_mul_f32 v156, v156, v160
    v_mul_f32 v157, v157, v160
    v_mul_f32 v158, v158, v160
    v_mul_f32 v159, v159, v160
    v_cvt_pk_bf16_f32 v152, v152, v153
    v_cvt_pk_bf16_f32 v153, v154, v155
    v_cvt_pk_bf16_f32 v154, v156, v157
    v_cvt_pk_bf16_f32 v155, v158, v159
    buffer_store_dwordx4 v[152:155], v12, s[12:15], s3 offen offset:1024 sc0 sc1
    s_memrealtime s[96:97]
    s_add_u32 s76, s24, 3407872
    s_addc_u32 s77, s25, 0
    s_and_b32 s77, s77, 0xffff
    s_mov_b32 s78, 327680
    s_mov_b32 s79, 0x00020000
    v_lshlrev_b32 v250, 4, v1
    s_waitcnt lgkmcnt(0)
    v_mov_b32 v246, s96
    v_mov_b32 v247, s97
    v_mov_b32 v248, s96
    v_mov_b32 v249, s97
    s_cmp_lg_u32 s49, 0
    s_waitcnt vmcnt(0)
    s_barrier
    s_cbranch_scc1 P_oproj
    s_mov_b64 exec, 0xff
    buffer_store_dwordx4 v[246:249], v250, s[76:79], s100 offen sc0 sc1
    s_mov_b64 exec, -1
    s_branch P_oproj
L_lre_97:
    s_lshl_b32 s3, s30, 6
    v_lshrrev_b32 v18, 3, v1
    v_add_u32 v18, s3, v18
    v_add_u32 v19, 0, v18
    v_lshrrev_b32 v20, 1, v19
    v_and_b32 v20, 7, v20
    v_and_b32 v21, 7, v1
    v_xor_b32 v20, v20, v21
    v_add_u32 v19, s98, v19
    v_mul_u32_u24 v19, 2048, v19
    v_lshl_add_u32 v2, v20, 4, v19
    v_add_u32 v19, 8, v18
    v_lshrrev_b32 v20, 1, v19
    v_and_b32 v20, 7, v20
    v_and_b32 v21, 7, v1
    v_xor_b32 v20, v20, v21
    v_add_u32 v19, s98, v19
    v_mul_u32_u24 v19, 2048, v19
    v_lshl_add_u32 v3, v20, 4, v19
    v_add_u32 v19, 16, v18
    v_lshrrev_b32 v20, 1, v19
    v_and_b32 v20, 7, v20
    v_and_b32 v21, 7, v1
    v_xor_b32 v20, v20, v21
    v_add_u32 v19, s98, v19
    v_mul_u32_u24 v19, 2048, v19
    v_lshl_add_u32 v4, v20, 4, v19
    v_add_u32 v19, 24, v18
    v_lshrrev_b32 v20, 1, v19
    v_and_b32 v20, 7, v20
    v_and_b32 v21, 7, v1
    v_xor_b32 v20, v20, v21
    v_add_u32 v19, s98, v19
    v_mul_u32_u24 v19, 2048, v19
    v_lshl_add_u32 v5, v20, 4, v19
    v_add_u32 v19, 32, v18
    v_lshrrev_b32 v20, 1, v19
    v_and_b32 v20, 7, v20
    v_and_b32 v21, 7, v1
    v_xor_b32 v20, v20, v21
    v_add_u32 v19, s98, v19
    v_mul_u32_u24 v19, 2048, v19
    v_lshl_add_u32 v6, v20, 4, v19
    v_add_u32 v19, 40, v18
    v_lshrrev_b32 v20, 1, v19
    v_and_b32 v20, 7, v20
    v_and_b32 v21, 7, v1
    v_xor_b32 v20, v20, v21
    v_add_u32 v19, s98, v19
    v_mul_u32_u24 v19, 2048, v19
    v_lshl_add_u32 v7, v20, 4, v19
    v_add_u32 v19, 48, v18
    v_lshrrev_b32 v20, 1, v19
    v_and_b32 v20, 7, v20
    v_and_b32 v21, 7, v1
    v_xor_b32 v20, v20, v21
    v_add_u32 v19, s98, v19
    v_mul_u32_u24 v19, 2048, v19
    v_lshl_add_u32 v8, v20, 4, v19
    v_add_u32 v19, 56, v18
    v_lshrrev_b32 v20, 1, v19
    v_and_b32 v20, 7, v20
    v_and_b32 v21, 7, v1
    v_xor_b32 v20, v20, v21
    v_add_u32 v19, s98, v19
    v_mul_u32_u24 v19, 2048, v19
    v_lshl_add_u32 v9, v20, 4, v19
    s_lshl_b32 s3, s29, 6
    s_mul_i32 s46, s30, 3
    s_add_u32 s46, s46, 0
    s_lshr_b32 s47, s46, 2
    s_and_b32 s46, s46, 3
    s_lshl_b32 s46, s46, 4
    s_lshl_b32 s47, s47, 11
    s_add_u32 s47, s47, s3
    v_lshrrev_b32 v18, 2, v1
    v_add_u32 v18, s46, v18
    v_and_b32 v19, 3, v1
    v_bfe_u32 v20, v18, 3, 1
    v_lshlrev_b32 v20, 1, v20
    v_xor_b32 v19, v19, v20
    v_mul_u32_u24 v18, 6144, v18
    v_lshl_add_u32 v18, v19, 4, v18
    v_add_u32 v10, s47, v18
    s_mul_i32 s46, s30, 3
    s_add_u32 s46, s46, 1
    s_lshr_b32 s47, s46, 2
    s_and_b32 s46, s46, 3
    s_lshl_b32 s46, s46, 4
    s_lshl_b32 s47, s47, 11
    s_add_u32 s47, s47, s3
    v_lshrrev_b32 v18, 2, v1
    v_add_u32 v18, s46, v18
    v_and_b32 v19, 3, v1
    v_bfe_u32 v20, v18, 3, 1
    v_lshlrev_b32 v20, 1, v20
    v_xor_b32 v19, v19, v20
    v_mul_u32_u24 v18, 6144, v18
    v_lshl_add_u32 v18, v19, 4, v18
    v_add_u32 v11, s47, v18
    s_mul_i32 s46, s30, 3
    s_add_u32 s46, s46, 2
    s_lshr_b32 s47, s46, 2
    s_and_b32 s46, s46, 3
    s_lshl_b32 s46, s46, 4
    s_lshl_b32 s47, s47, 11
    s_add_u32 s47, s47, s3
    v_lshrrev_b32 v18, 2, v1
    v_add_u32 v18, s46, v18
    v_and_b32 v19, 3, v1
    v_bfe_u32 v20, v18, 3, 1
    v_lshlrev_b32 v20, 1, v20
    v_xor_b32 v19, v19, v20
    v_mul_u32_u24 v18, 6144, v18
    v_lshl_add_u32 v18, v19, 4, v18
    v_add_u32 v12, s47, v18
    s_branch L_lpass_74
Q_help:
    s_load_dwordx2 s[24:25], s[0:1], 80
    s_load_dwordx2 s[58:59], s[0:1], 0
    s_load_dwordx2 s[26:27], s[0:1], 8
    v_readlane_b32 s34, v255, 1
    v_readlane_b32 s35, v255, 2
    s_branch Q_go
L_end_1:
    s_endpgm
.p2align 6
P_oproj:
    v_readlane_b32 s46, v255, 3
    s_setprio 0
    s_nop 2
    s_cmp_lg_u32 s46, 0
    s_cbranch_scc1 S_next
    s_and_b32 s3, s2, 7
    s_lshr_b32 s46, s2, 3
    s_lshr_b32 s28, s3, 2
    s_and_b32 s29, s3, 3
    s_mul_i32 s28, s28, 8
    s_mul_i32 s29, s29, 4
    s_lshr_b32 s3, s46, 2
    s_add_u32 s28, s28, s3
    s_and_b32 s3, s46, 3
    s_add_u32 s29, s29, s3
    s_mov_b32 s55, 0
P_oproj_g2:
    s_load_dwordx2 s[24:25], s[0:1], 80
    s_load_dwordx2 s[58:59], s[0:1], 80
    s_load_dwordx2 s[26:27], s[0:1], 16
    s_load_dwordx2 s[34:35], s[0:1], 80
    s_load_dwordx2 s[36:37], s[0:1], 0
    v_and_b32 v1, 63, v0
    v_lshrrev_b32 v20, 6, v0
    s_nop 0
    v_readfirstlane_b32 s49, v20
    s_nop 3
    s_and_b32 s30, s49, 3
    s_lshr_b32 s44, s30, 1
    s_and_b32 s45, s30, 1
    s_mov_b32 s44, s30
    s_mov_b32 s45, 0
    s_lshl_b32 s50, s28, 18
    s_cmp_ge_u32 s49, s55
    s_cbranch_scc1 L_xr_109
    s_lshl_b32 s3, s30, 16
    s_add_u32 s3, s3, s50
    s_lshl_b32 s46, s29, 7
    s_add_u32 s3, s3, s46
    s_add_u32 s46, s3, 32768
    v_and_b32 v20, 15, v1
    v_bfe_u32 v21, v1, 4, 1
    v_lshlrev_b32 v20, 11, v20
    v_lshl_add_u32 v20, v21, 5, v20
    v_lshrrev_b32 v21, 5, v1
    v_lshl_add_u32 v20, v21, 4, v20
    s_waitcnt lgkmcnt(0)
    s_mov_b32 s16, s36
    s_mov_b32 s17, s37
    s_and_b32 s17, s17, 0xffff
    s_mov_b32 s18, 4194304
    s_mov_b32 s19, 0x00020000
    buffer_load_dwordx4 v[164:167], v20, s[16:19], s3 offen offset:0
    buffer_load_dwordx4 v[172:175], v20, s[16:19], s3 offen offset:64
    buffer_load_dwordx4 v[168:171], v20, s[16:19], s46 offen offset:0
    buffer_load_dwordx4 v[176:179], v20, s[16:19], s46 offen offset:64
L_xr_109:
    s_cmp_lg_u32 s49, 0
    s_cbranch_scc1 L_fpolld_111
    s_mov_b32 exec_lo, 0xffffffff
    v_readlane_b32 s96, v255, 1
    v_readlane_b32 s97, v255, 2
    v_readlane_b32 s47, v255, 6
    v_lshlrev_b32 v250, 7, v1
    s_lshr_b32 s3, s28, 1
    s_lshl_b32 s3, s3, 12
    s_lshr_b32 s46, s3, 1
    s_xor_b32 s46, s46, s3
    s_bfe_u32 s46, s46, 0x1000d
    s_mul_i32 s46, s46, 24576
    s_xor_b32 s3, s3, s46
    v_readlane_b32 s46, v255, 20
    s_xor_b32 s3, s3, 0x2000
    s_nop 0
    s_xor_b32 s3, s3, s46
    v_and_b32 v250, 0xf80, v250
    s_xor_b32 s46, s46, 0x2000
    v_add_u32 v250, s46, v250
    s_sub_u32 s3, s3, s46
    s_mov_b32 exec_hi, 0
    v_add_u32 v250, s3, v250
    s_and_b32 s3, s29, 7
    s_cmp_eq_u32 s3, 3
    s_cselect_b32 exec_hi, -1, 0
    s_mov_b32 s3, 0
    s_add_u32 s98, s96, 0x1000000
    s_addc_u32 s99, s97, 0
    s_mov_b32 s101, 200
    v_writelane_b32 v255, 0, 6
    s_cmp_lg_u32 s47, 0
    s_cbranch_scc1 L_fpoll_110x
L_fpoll_110:
    buffer_load_dwordx2 v[252:253], v250, s[76:79], s3 offen sc0 sc1
    s_waitcnt vmcnt(0)
    v_cmp_lt_u64 vcc, s[96:97], v[252:253]
    v_cmp_gt_u64 s[46:47], s[98:99], v[252:253]
    s_nop 1
    s_and_b64 s[46:47], s[46:47], vcc
    s_sub_u32 s101, s101, 1
    s_cselect_b32 s46, -1, s46
    s_cmp_lg_u32 s46, -1
    s_cbranch_scc1 L_fpoll_110
L_fpoll_110x:
    s_mov_b64 exec, -1
    s_lshr_b32 s3, s101, 31
    v_mov_b32 v250, 163776
    v_mov_b32 v251, s3
    v_mov_b32 v252, s47
    ds_write2_b32 v250, v251, v252 offset1:2
    s_cmp_lg_u32 s3, 0
    s_waitcnt lgkmcnt(0)
    s_barrier
    s_cbranch_scc1 S_fail1
L_fpolld_111:
    s_cmp_lt_u32 s49, 4
    s_cbranch_scc1 L_comp_112
L_loader_107:
    s_setprio 2
    v_lshrrev_b32 v20, 3, v1
    v_lshrrev_b32 v21, 4, v1
    v_and_b32 v22, 7, v1
    v_xor_b32 v21, v21, v22
    s_mul_i32 s3, s28, 262144
    s_lshl_b32 s46, s30, 12
    s_add_u32 s3, s3, s46
    s_lshr_b32 s46, s3, 8
    s_xor_b32 s46, s46, s3
    s_bfe_u32 s46, s46, 0x1000d
    s_mul_i32 s46, s46, 2105344
    s_xor_b32 s3, s3, s46
    s_lshr_b32 s46, s3, 8
    s_and_b32 s46, s46, 0x2000
    s_xor_b32 s3, s3, s46
    v_readlane_b32 s46, v255, 20
    s_nop 0
    s_xor_b32 s3, s3, s46
    v_lshl_add_u32 v2, v1, 4, s3
    v_mov_b32 v23, v2
    v_add_u32 v3, 1024, v23
    v_add_u32 v4, 2048, v2
    v_add_u32 v5, 2048, v3
    v_lshrrev_b32 v23, 5, v1
    v_and_b32 v20, 3, v20
    v_lshl_add_u32 v20, v23, 3, v20
    s_mul_i32 s31, s30, 4096
    s_waitcnt lgkmcnt(0)
    s_add_u32 s4, s58, 12582912
    s_addc_u32 s5, s59, 0
    s_and_b32 s5, s5, 0xffff
    s_mov_b32 s6, 4194304
    s_mov_b32 s7, 0x00020000
    s_add_u32 m0, s31, 0
    s_mul_i32 s32, s30, 2048
    s_add_u32 m0, s31, 1024
    s_add_u32 s32, s32, 16384
    s_add_u32 m0, s31, 2048
    s_mul_i32 s3, s29, 128
    s_add_u32 m0, s31, 3072
    s_mul_i32 s46, s30, 32768
    s_add_u32 s3, s3, s46
    s_mov_b32 s8, s26
    s_mov_b32 s9, s27
    s_and_b32 s9, s9, 0xffff
    s_mov_b32 s10, 2097152
    s_mov_b32 s11, 0x00020000
    v_bfe_u32 v21, v1, 4, 1
    v_lshlrev_b32 v21, 1, v21
    v_xor_b32 v21, v21, v22
    v_mul_u32_u24 v20, 2048, v20
    v_lshl_add_u32 v20, v21, 4, v20
    s_mov_b32 m0, s32
    v_add_u32 v6, s3, v20
    buffer_load_dwordx4 v6, s[8:11], 0 offen lds
    v_xor_b32 v20, 64, v6
    s_add_u32 m0, s32, 1024
    v_add_u32 v7, 8192, v20
    buffer_load_dwordx4 v7, s[8:11], 0 offen lds
    s_mov_b32 s40, 16384
    s_mov_b32 s41, 131072
    s_mov_b32 s43, 24576
    s_mov_b32 s42, 0
    s_add_u32 m0, s32, 24576
    s_nop 0
    buffer_load_dwordx4 v6, s[8:11], s41 offen lds
    s_add_u32 m0, s32, 25600
    s_nop 0
    buffer_load_dwordx4 v7, s[8:11], s41 offen lds
    s_add_u32 s41, s41, 131072
    s_add_u32 m0, s32, 49152
    s_nop 0
    buffer_load_dwordx4 v6, s[8:11], s41 offen lds
    s_add_u32 m0, s32, 50176
    s_nop 0
    buffer_load_dwordx4 v7, s[8:11], s41 offen lds
    s_add_u32 s41, s41, 131072
    s_add_u32 m0, s32, 73728
    s_nop 0
    buffer_load_dwordx4 v6, s[8:11], s41 offen lds
    s_add_u32 m0, s32, 74752
    s_nop 0
    buffer_load_dwordx4 v7, s[8:11], s41 offen lds
    s_add_u32 s41, s41, 131072
    v_mov_b32 v246, 163776
    s_barrier
    ds_read_b32 v246, v246
    s_waitcnt lgkmcnt(0)
    v_cmp_ne_u32 vcc, 0, v246
    s_cbranch_vccnz S_fail1
    s_add_u32 m0, s31, 0
    s_mov_b32 s40, 0
    buffer_load_dwordx4 v2, s[4:7], s40 offen lds
    s_add_u32 m0, s31, 1024
    s_mov_b32 s40, 0
    buffer_load_dwordx4 v3, s[4:7], s40 offen lds
    s_add_u32 m0, s31, 2048
    s_mov_b32 s40, 0
    buffer_load_dwordx4 v4, s[4:7], s40 offen lds
    s_add_u32 m0, s31, 3072
    s_mov_b32 s40, 0
    buffer_load_dwordx4 v5, s[4:7], s40 offen lds
    s_add_u32 m0, s31, 24576
    s_mov_b32 s40, 16384
    buffer_load_dwordx4 v2, s[4:7], s40 offen lds
    s_add_u32 m0, s31, 25600
    s_mov_b32 s40, 16384
    buffer_load_dwordx4 v3, s[4:7], s40 offen lds
    s_add_u32 m0, s31, 26624
    s_mov_b32 s40, 16384
    buffer_load_dwordx4 v4, s[4:7], s40 offen lds
    s_add_u32 m0, s31, 27648
    s_mov_b32 s40, 16384
    buffer_load_dwordx4 v5, s[4:7], s40 offen lds
    s_add_u32 m0, s31, 49152
    s_mov_b32 s40, 32768
    buffer_load_dwordx4 v2, s[4:7], s40 offen lds
    s_add_u32 m0, s31, 50176
    s_mov_b32 s40, 32768
    buffer_load_dwordx4 v3, s[4:7], s40 offen lds
    s_add_u32 m0, s31, 51200
    s_mov_b32 s40, 32768
    buffer_load_dwordx4 v4, s[4:7], s40 offen lds
    s_add_u32 m0, s31, 52224
    s_mov_b32 s40, 32768
    buffer_load_dwordx4 v5, s[4:7], s40 offen lds
    s_add_u32 m0, s31, 73728
    s_mov_b32 s40, 49152
    buffer_load_dwordx4 v2, s[4:7], s40 offen lds
    s_add_u32 m0, s31, 74752
    s_mov_b32 s40, 49152
    buffer_load_dwordx4 v3, s[4:7], s40 offen lds
    s_add_u32 m0, s31, 75776
    s_mov_b32 s40, 49152
    buffer_load_dwordx4 v4, s[4:7], s40 offen lds
    s_add_u32 m0, s31, 76800
    s_mov_b32 s40, 49152
    buffer_load_dwordx4 v5, s[4:7], s40 offen lds
    s_mov_b32 s40, 65536
    s_mov_b32 s43, 98304
    v_mov_b32 v247, 163776
    ds_read_b32 v247, v247 offset:8
    s_mov_b32 s55, 131072
    s_and_b32 s46, s29, 7
    s_cmp_lg_u32 s46, 3
    s_waitcnt lgkmcnt(0)
    s_cbranch_scc1 L_wob_116
    v_cmp_ne_u32 vcc, -1, v247
    s_cbranch_vccnz L_wob_116
    s_add_u32 s8, s24, 48234496
    s_addc_u32 s9, s25, 0
    s_and_b32 s9, s9, 0xffff
    s_mov_b32 s10, 524288
    s_mov_b32 s11, 0x00020000
    s_lshr_b32 s3, s29, 3
    s_mul_i32 s3, s3, 262144
    s_mul_i32 s46, s30, 4096
    s_add_u32 s3, s3, s46
    v_lshrrev_b32 v23, 5, v1
    v_bfe_u32 v20, v1, 3, 2
    v_lshl_add_u32 v20, v23, 3, v20
    v_lshlrev_b32 v20, 8, v20
    v_lshl_add_u32 v20, v21, 4, v20
    v_add_u32 v6, s3, v20
    v_xor_b32 v20, 64, v6
    v_add_u32 v7, 1024, v20
    s_mov_b32 s41, 65536
    s_mov_b32 s55, 16384
L_wob_116:
    s_add_u32 s12, s34, 16777216
    s_addc_u32 s13, s35, 0
    s_and_b32 s13, s13, 0xffff
    s_mov_b32 s14, 4194304
    s_mov_b32 s15, 0x00020000
    s_mov_b32 s84, s24
    s_mov_b32 s85, s25
    s_and_b32 s85, s85, 0xffff
    s_mov_b32 s86, 262144
    s_mov_b32 s87, 0x00020000
    s_waitcnt vmcnt(12)
    s_barrier
    s_add_u32 s33, s43, s31
    s_add_u32 m0, s33, 0
    s_nop 0
    buffer_load_dwordx4 v2, s[4:7], s40 offen lds
    s_add_u32 m0, s33, 1024
    s_nop 0
    buffer_load_dwordx4 v3, s[4:7], s40 offen lds
    s_add_u32 m0, s33, 2048
    s_nop 0
    buffer_load_dwordx4 v4, s[4:7], s40 offen lds
    s_add_u32 m0, s33, 3072
    s_nop 0
    buffer_load_dwordx4 v5, s[4:7], s40 offen lds
    s_add_u32 s33, s43, s32
    s_add_u32 m0, s33, 0
    s_nop 0
    buffer_load_dwordx4 v6, s[8:11], s41 offen lds
    s_add_u32 m0, s33, 1024
    s_nop 0
    buffer_load_dwordx4 v7, s[8:11], s41 offen lds
    s_add_u32 s40, s40, 16384
    s_add_u32 s41, s41, s55
    s_add_u32 s43, s43, 24576
    s_cmp_ge_u32 s43, 122880
    s_cselect_b32 s43, 0, s43
    s_waitcnt vmcnt(14)
    s_barrier
    s_add_u32 s33, s43, s31
    s_add_u32 m0, s33, 0
    s_nop 0
    buffer_load_dwordx4 v2, s[4:7], s40 offen lds
    s_add_u32 m0, s33, 1024
    s_nop 0
    buffer_load_dwordx4 v3, s[4:7], s40 offen lds
    s_add_u32 m0, s33, 2048
    s_nop 0
    buffer_load_dwordx4 v4, s[4:7], s40 offen lds
    s_add_u32 m0, s33, 3072
    s_nop 0
    buffer_load_dwordx4 v5, s[4:7], s40 offen lds
    s_add_u32 s33, s43, s32
    s_add_u32 m0, s33, 0
    s_nop 0
    buffer_load_dwordx4 v6, s[8:11], s41 offen lds
    s_add_u32 m0, s33, 1024
    s_nop 0
    buffer_load_dwordx4 v7, s[8:11], s41 offen lds
    s_add_u32 s40, s40, 16384
    s_add_u32 s41, s41, s55
    s_add_u32 s43, s43, 24576
    s_cmp_ge_u32 s43, 122880
    s_cselect_b32 s43, 0, s43
    s_waitcnt vmcnt(16)
    s_barrier
    s_add_u32 s33, s43, s31
    s_add_u32 m0, s33, 0
    s_nop 0
    buffer_load_dwordx4 v2, s[4:7], s40 offen lds
    s_add_u32 m0, s33, 1024
    s_nop 0
    buffer_load_dwordx4 v3, s[4:7], s40 offen lds
    s_add_u32 m0, s33, 2048
    s_nop 0
    buffer_load_dwordx4 v4, s[4:7], s40 offen lds
    s_add_u32 m0, s33, 3072
    s_nop 0
    buffer_load_dwordx4 v5, s[4:7], s40 offen lds
    s_add_u32 s33, s43, s32
    s_add_u32 m0, s33, 0
    s_nop 0
    buffer_load_dwordx4 v6, s[8:11], s41 offen lds
    s_add_u32 m0, s33, 1024
    s_nop 0
    buffer_load_dwordx4 v7, s[8:11], s41 offen lds
    s_add_u32 s40, s40, 16384
    s_add_u32 s41, s41, s55
    s_add_u32 s43, s43, 24576
    s_cmp_ge_u32 s43, 122880
    s_cselect_b32 s43, 0, s43
    s_mov_b32 s48, 9
L_lloop_117:
    s_waitcnt vmcnt(18)
    s_barrier
    s_add_u32 s33, s43, s31
    s_add_u32 m0, s33, 0
    s_nop 0
    buffer_load_dwordx4 v2, s[4:7], s40 offen lds
    s_add_u32 m0, s33, 1024
    s_nop 0
    buffer_load_dwordx4 v3, s[4:7], s40 offen lds
    s_add_u32 m0, s33, 2048
    s_nop 0
    buffer_load_dwordx4 v4, s[4:7], s40 offen lds
    s_add_u32 m0, s33, 3072
    s_nop 0
    buffer_load_dwordx4 v5, s[4:7], s40 offen lds
    s_add_u32 s33, s43, s32
    s_add_u32 m0, s33, 0
    s_nop 0
    buffer_load_dwordx4 v6, s[8:11], s41 offen lds
    s_add_u32 m0, s33, 1024
    s_nop 0
    buffer_load_dwordx4 v7, s[8:11], s41 offen lds
    s_add_u32 s40, s40, 16384
    s_add_u32 s41, s41, s55
    s_add_u32 s43, s43, 24576
    s_cmp_ge_u32 s43, 122880
    s_cselect_b32 s43, 0, s43
    s_sub_u32 s48, s48, 1
    s_cmp_lg_u32 s48, 0
    s_cbranch_scc1 L_lloop_117
    s_waitcnt vmcnt(18)
    s_barrier
    s_waitcnt vmcnt(12)
    s_barrier
    s_waitcnt vmcnt(6)
    s_barrier
    s_waitcnt vmcnt(0)
    s_barrier
    s_branch L_store_108
L_comp_112:
    v_and_b32 v20, 15, v1
    s_lshl_b32 s3, s44, 11
    v_lshl_add_u32 v20, v20, 4, s3
    v_lshrrev_b32 v21, 4, v1
    v_lshl_add_u32 v8, v21, 9, v20
    v_add_u32 v9, 0x2000, v8
    v_lshrrev_b32 v21, 4, v1
    v_bfe_u32 v20, v1, 2, 2
    v_lshl_add_u32 v22, v21, 3, v20
    v_and_b32 v23, 1, v21
    v_lshrrev_b32 v20, 1, v20
    v_lshl_add_u32 v23, v23, 1, v20
    v_mul_u32_u24 v22, 128, v22
    v_and_b32 v20, 3, v1
    v_lshl_add_u32 v22, v20, 3, v22
    v_add_u32 v22, 16384, v22
    s_mul_i32 s3, s45, 4
    s_add_u32 s46, s3, 0
    s_lshr_b32 s47, s46, 2
    s_and_b32 s46, s46, 3
    s_mul_i32 s47, s47, 8192
    v_xor_b32 v20, s46, v23
    v_lshl_add_u32 v20, v20, 5, v22
    v_add_u32 v10, s47, v20
    s_add_u32 s46, s3, 1
    s_lshr_b32 s47, s46, 2
    s_and_b32 s46, s46, 3
    s_mul_i32 s47, s47, 8192
    v_xor_b32 v20, s46, v23
    v_lshl_add_u32 v20, v20, 5, v22
    v_add_u32 v11, s47, v20
    s_add_u32 s46, s3, 2
    s_lshr_b32 s47, s46, 2
    s_and_b32 s46, s46, 3
    s_mul_i32 s47, s47, 8192
    v_xor_b32 v20, s46, v23
    v_lshl_add_u32 v20, v20, 5, v22
    v_add_u32 v12, s47, v20
    s_add_u32 s46, s3, 3
    s_lshr_b32 s47, s46, 2
    s_and_b32 s46, s46, 3
    s_mul_i32 s47, s47, 8192
    v_xor_b32 v20, s46, v23
    v_lshl_add_u32 v20, v20, 5, v22
    v_add_u32 v13, s47, v20
    v_lshlrev_b32 v2, 4, v1
    v_lshrrev_b32 v3, 5, v1
    v_lshlrev_b32 v3, 7, v3
    v_and_b32 v4, 15, v1
    v_lshl_add_u32 v3, v4, 3, v3
    v_bfe_u32 v4, v1, 4, 1
    v_lshl_add_u32 v3, v4, 2, v3
    s_lshl_b32 s3, s29, 14
    s_add_u32 s50, s50, s3
    s_lshl_b32 s3, s30, 11
    s_add_u32 s50, s50, s3
    s_lshr_b32 s51, s50, 8
    s_xor_b32 s51, s51, s50
    s_bfe_u32 s51, s51, 0x1000d
    s_mul_i32 s51, s51, 2105344
    s_xor_b32 s50, s50, s51
    s_lshr_b32 s51, s50, 8
    s_and_b32 s51, s51, 0x2000
    s_xor_b32 s50, s50, s51
    v_readlane_b32 s51, v255, 20
    s_nop 0
    s_xor_b32 s50, s50, s51
    s_xor_b32 s51, s50, 0x202000
    s_lshl_b32 s52, s28, 4
    s_add_u32 s52, s52, s29
    s_lshl_b32 s52, s52, 2
    s_add_u32 s52, s52, s30
    s_lshl_b32 s52, s52, 8
    s_lshr_b32 s53, s52, 4
    s_xor_b32 s53, s53, s52
    s_bfe_u32 s53, s53, 0x1000d
    s_mul_i32 s53, s53, 139264
    s_xor_b32 s52, s52, s53
    v_readlane_b32 s53, v255, 20
    s_nop 0
    s_xor_b32 s52, s52, s53
    s_mov_b32 s53, 0x3f803f80
    s_mov_b32 s42, 0
    s_waitcnt lgkmcnt(0)
    s_add_u32 s4, s58, 12582912
    s_addc_u32 s5, s59, 0
    s_and_b32 s5, s5, 0xffff
    s_mov_b32 s6, 4194304
    s_mov_b32 s7, 0x00020000
    s_mov_b32 s8, s26
    s_mov_b32 s9, s27
    s_and_b32 s9, s9, 0xffff
    s_mov_b32 s10, 2097152
    s_mov_b32 s11, 0x00020000
    s_add_u32 s12, s34, 16777216
    s_addc_u32 s13, s35, 0
    s_and_b32 s13, s13, 0xffff
    s_mov_b32 s14, 4194304
    s_mov_b32 s15, 0x00020000
    s_mov_b32 s84, s24
    s_mov_b32 s85, s25
    s_and_b32 s85, s85, 0xffff
    s_mov_b32 s86, 262144
    s_mov_b32 s87, 0x00020000
    v_add_u32 v14, s42, v8
    v_add_u32 v15, s42, v9
    v_add_u32 v16, s42, v10
    v_add_u32 v17, s42, v11
    v_add_u32 v18, s42, v12
    v_add_u32 v19, s42, v13
    s_add_u32 s42, s42, 24576
    s_cmp_ge_u32 s42, 122880
    s_cselect_b32 s42, 0, s42
    s_cmp_eq_u32 s49, 0
    s_cbranch_scc1 L_t2_113
    v_mov_b32 v246, 163776
    s_barrier
    ds_read_b32 v246, v246
    s_waitcnt lgkmcnt(0)
    v_cmp_ne_u32 vcc, 0, v246
    s_cbranch_vccnz S_fail1
L_t2_113:
L_cpass_114:
    s_waitcnt vmcnt(0)
    v_permlane16_swap_b32 v164, v166
    v_permlane16_swap_b32 v165, v167
    v_permlane16_swap_b32 v168, v170
    v_permlane16_swap_b32 v169, v171
    v_permlane16_swap_b32 v172, v174
    v_permlane16_swap_b32 v173, v175
    v_permlane16_swap_b32 v176, v178
    v_permlane16_swap_b32 v177, v179
    s_nop 1
    v_lshlrev_b32 v76, 16, v164
    v_and_b32 v77, 0xffff0000, v164
    v_lshlrev_b32 v78, 16, v165
    v_and_b32 v79, 0xffff0000, v165
    v_lshlrev_b32 v80, 16, v168
    v_and_b32 v81, 0xffff0000, v168
    v_lshlrev_b32 v82, 16, v169
    v_and_b32 v83, 0xffff0000, v169
    v_lshlrev_b32 v84, 16, v166
    v_and_b32 v85, 0xffff0000, v166
    v_lshlrev_b32 v86, 16, v167
    v_and_b32 v87, 0xffff0000, v167
    v_lshlrev_b32 v88, 16, v170
    v_and_b32 v89, 0xffff0000, v170
    v_lshlrev_b32 v90, 16, v171
    v_and_b32 v91, 0xffff0000, v171
    v_lshlrev_b32 v92, 16, v172
    v_and_b32 v93, 0xffff0000, v172
    v_lshlrev_b32 v94, 16, v173
    v_and_b32 v95, 0xffff0000, v173
    v_lshlrev_b32 v96, 16, v176
    v_and_b32 v97, 0xffff0000, v176
    v_lshlrev_b32 v98, 16, v177
    v_and_b32 v99, 0xffff0000, v177
    v_lshlrev_b32 v100, 16, v174
    v_and_b32 v101, 0xffff0000, v174
    v_lshlrev_b32 v102, 16, v175
    v_and_b32 v103, 0xffff0000, v175
    v_lshlrev_b32 v104, 16, v178
    v_and_b32 v105, 0xffff0000, v178
    v_lshlrev_b32 v106, 16, v179
    v_and_b32 v107, 0xffff0000, v179
    s_barrier
    ds_read_b128 v[28:31], v14 offset:0
    ds_read_b64_tr_b16 v[44:45], v16 offset:0
    ds_read_b64_tr_b16 v[46:47], v16 offset:512
    ds_read_b128 v[32:35], v14 offset:256
    ds_read_b64_tr_b16 v[48:49], v17 offset:0
    ds_read_b64_tr_b16 v[50:51], v17 offset:512
    ds_read_b64_tr_b16 v[52:53], v18 offset:0
    ds_read_b64_tr_b16 v[54:55], v18 offset:512
    ds_read_b64_tr_b16 v[56:57], v19 offset:0
    ds_read_b64_tr_b16 v[58:59], v19 offset:512
    s_waitcnt lgkmcnt(0)
    v_mfma_f32_16x16x32_bf16 v[76:79], v[44:47], v[28:31], v[76:79]
    ds_read_b128 v[36:39], v15 offset:0
    ds_read_b64_tr_b16 v[60:61], v16 offset:4096
    v_mfma_f32_16x16x32_bf16 v[80:83], v[44:47], v[32:35], v[80:83]
    ds_read_b64_tr_b16 v[62:63], v16 offset:4608
    ds_read_b128 v[40:43], v15 offset:256
    v_mfma_f32_16x16x32_bf16 v[84:87], v[48:51], v[28:31], v[84:87]
    ds_read_b64_tr_b16 v[64:65], v17 offset:4096
    ds_read_b64_tr_b16 v[66:67], v17 offset:4608
    v_mfma_f32_16x16x32_bf16 v[88:91], v[48:51], v[32:35], v[88:91]
    ds_read_b64_tr_b16 v[68:69], v18 offset:4096
    ds_read_b64_tr_b16 v[70:71], v18 offset:4608
    v_mfma_f32_16x16x32_bf16 v[92:95], v[52:55], v[28:31], v[92:95]
    ds_read_b64_tr_b16 v[72:73], v19 offset:4096
    ds_read_b64_tr_b16 v[74:75], v19 offset:4608
    v_mfma_f32_16x16x32_bf16 v[96:99], v[52:55], v[32:35], v[96:99]
    v_add_u32 v14, s42, v8
    v_add_u32 v15, s42, v9
    v_add_u32 v16, s42, v10
    v_mfma_f32_16x16x32_bf16 v[100:103], v[56:59], v[28:31], v[100:103]
    v_add_u32 v17, s42, v11
    v_add_u32 v18, s42, v12
    v_add_u32 v19, s42, v13
    v_mfma_f32_16x16x32_bf16 v[104:107], v[56:59], v[32:35], v[104:107]
    s_add_u32 s42, s42, 24576
    s_cmp_ge_u32 s42, 122880
    s_cselect_b32 s42, 0, s42
    s_waitcnt lgkmcnt(0)
    s_mov_b32 s48, 15
L_cloop_115:
    s_barrier
    v_mfma_f32_16x16x32_bf16 v[76:79], v[60:63], v[36:39], v[76:79]
    ds_read_b128 v[28:31], v14 offset:0
    ds_read_b64_tr_b16 v[44:45], v16 offset:0
    v_mfma_f32_16x16x32_bf16 v[80:83], v[60:63], v[40:43], v[80:83]
    ds_read_b64_tr_b16 v[46:47], v16 offset:512
    ds_read_b128 v[32:35], v14 offset:256
    v_mfma_f32_16x16x32_bf16 v[84:87], v[64:67], v[36:39], v[84:87]
    ds_read_b64_tr_b16 v[48:49], v17 offset:0
    ds_read_b64_tr_b16 v[50:51], v17 offset:512
    v_mfma_f32_16x16x32_bf16 v[88:91], v[64:67], v[40:43], v[88:91]
    ds_read_b64_tr_b16 v[52:53], v18 offset:0
    ds_read_b64_tr_b16 v[54:55], v18 offset:512
    v_mfma_f32_16x16x32_bf16 v[92:95], v[68:71], v[36:39], v[92:95]
    ds_read_b64_tr_b16 v[56:57], v19 offset:0
    ds_read_b64_tr_b16 v[58:59], v19 offset:512
    v_mfma_f32_16x16x32_bf16 v[96:99], v[68:71], v[40:43], v[96:99]
    v_mfma_f32_16x16x32_bf16 v[100:103], v[72:75], v[36:39], v[100:103]
    v_mfma_f32_16x16x32_bf16 v[104:107], v[72:75], v[40:43], v[104:107]
    s_waitcnt lgkmcnt(0)
    v_mfma_f32_16x16x32_bf16 v[76:79], v[44:47], v[28:31], v[76:79]
    ds_read_b128 v[36:39], v15 offset:0
    ds_read_b64_tr_b16 v[60:61], v16 offset:4096
    v_mfma_f32_16x16x32_bf16 v[80:83], v[44:47], v[32:35], v[80:83]
    ds_read_b64_tr_b16 v[62:63], v16 offset:4608
    ds_read_b128 v[40:43], v15 offset:256
    v_mfma_f32_16x16x32_bf16 v[84:87], v[48:51], v[28:31], v[84:87]
    ds_read_b64_tr_b16 v[64:65], v17 offset:4096
    ds_read_b64_tr_b16 v[66:67], v17 offset:4608
    v_mfma_f32_16x16x32_bf16 v[88:91], v[48:51], v[32:35], v[88:91]
    ds_read_b64_tr_b16 v[68:69], v18 offset:4096
    ds_read_b64_tr_b16 v[70:71], v18 offset:4608
    v_mfma_f32_16x16x32_bf16 v[92:95], v[52:55], v[28:31], v[92:95]
    ds_read_b64_tr_b16 v[72:73], v19 offset:4096
    ds_read_b64_tr_b16 v[74:75], v19 offset:4608
    v_mfma_f32_16x16x32_bf16 v[96:99], v[52:55], v[32:35], v[96:99]
    v_add_u32 v14, s42, v8
    v_add_u32 v15, s42, v9
    v_add_u32 v16, s42, v10
    v_mfma_f32_16x16x32_bf16 v[100:103], v[56:59], v[28:31], v[100:103]
    v_add_u32 v17, s42, v11
    v_add_u32 v18, s42, v12
    v_add_u32 v19, s42, v13
    v_mfma_f32_16x16x32_bf16 v[104:107], v[56:59], v[32:35], v[104:107]
    s_add_u32 s42, s42, 24576
    s_cmp_ge_u32 s42, 122880
    s_cselect_b32 s42, 0, s42
    s_sub_u32 s48, s48, 1
    s_cmp_lg_u32 s48, 0
    s_waitcnt lgkmcnt(0)
    s_cbranch_scc1 L_cloop_115
    v_mfma_f32_16x16x32_bf16 v[76:79], v[60:63], v[36:39], v[76:79]
    v_mfma_f32_16x16x32_bf16 v[84:87], v[64:67], v[36:39], v[84:87]
    v_mfma_f32_16x16x32_bf16 v[92:95], v[68:71], v[36:39], v[92:95]
    v_mfma_f32_16x16x32_bf16 v[100:103], v[72:75], v[36:39], v[100:103]
    v_mfma_f32_16x16x32_bf16 v[80:83], v[60:63], v[40:43], v[80:83]
    v_cvt_pk_bf16_f32 v76, v76, v77
    v_cvt_pk_bf16_f32 v77, v78, v79
    v_cvt_pk_bf16_f32 v78, v84, v85
    v_cvt_pk_bf16_f32 v79, v86, v87
    buffer_store_dwordx4 v[76:79], v2, s[12:15], s50 offen offset:0 sc0 sc1
    v_mfma_f32_16x16x32_bf16 v[88:91], v[64:67], v[40:43], v[88:91]
    v_dot2_f32_bf16 v28, v76, s53, 0
    v_dot2_f32_bf16 v29, v76, v76, 0
    v_dot2_f32_bf16 v28, v77, s53, v28
    v_mfma_f32_16x16x32_bf16 v[96:99], v[68:71], v[40:43], v[96:99]
    v_cvt_pk_bf16_f32 v92, v92, v93
    v_cvt_pk_bf16_f32 v93, v94, v95
    v_cvt_pk_bf16_f32 v94, v100, v101
    v_cvt_pk_bf16_f32 v95, v102, v103
    buffer_store_dwordx4 v[92:95], v2, s[12:15], s51 offen offset:0 sc0 sc1
    v_mfma_f32_16x16x32_bf16 v[104:107], v[72:75], v[40:43], v[104:107]
    s_nop 0
    v_dot2_f32_bf16 v29, v77, v77, v29
    v_dot2_f32_bf16 v28, v78, s53, v28
    v_dot2_f32_bf16 v29, v78, v78, v29
    v_dot2_f32_bf16 v28, v79, s53, v28
    v_dot2_f32_bf16 v29, v79, v79, v29
    v_cvt_pk_bf16_f32 v80, v80, v81
    v_cvt_pk_bf16_f32 v81, v82, v83
    v_cvt_pk_bf16_f32 v82, v88, v89
    v_cvt_pk_bf16_f32 v83, v90, v91
    buffer_store_dwordx4 v[80:83], v2, s[12:15], s50 offen offset:1024 sc0 sc1
    v_dot2_f32_bf16 v28, v92, s53, v28
    v_dot2_f32_bf16 v29, v92, v92, v29
    v_dot2_f32_bf16 v28, v93, s53, v28
    v_dot2_f32_bf16 v29, v93, v93, v29
    v_cvt_pk_bf16_f32 v96, v96, v97
    v_cvt_pk_bf16_f32 v97, v98, v99
    v_cvt_pk_bf16_f32 v98, v104, v105
    v_cvt_pk_bf16_f32 v99, v106, v107
    buffer_store_dwordx4 v[96:99], v2, s[12:15], s51 offen offset:1024 sc0 sc1
    v_dot2_f32_bf16 v28, v94, s53, v28
    v_dot2_f32_bf16 v29, v94, v94, v29
    v_dot2_f32_bf16 v28, v95, s53, v28
    v_dot2_f32_bf16 v29, v95, v95, v29
    v_dot2_f32_bf16 v30, v80, s53, 0
    v_dot2_f32_bf16 v31, v80, v80, 0
    v_dot2_f32_bf16 v30, v81, s53, v30
    v_dot2_f32_bf16 v31, v81, v81, v31
    v_dot2_f32_bf16 v30, v82, s53, v30
    v_dot2_f32_bf16 v31, v82, v82, v31
    v_dot2_f32_bf16 v30, v83, s53, v30
    v_dot2_f32_bf16 v31, v83, v83, v31
    v_dot2_f32_bf16 v30, v96, s53, v30
    v_dot2_f32_bf16 v31, v96, v96, v31
    v_dot2_f32_bf16 v30, v97, s53, v30
    v_dot2_f32_bf16 v31, v97, v97, v31
    v_dot2_f32_bf16 v30, v98, s53, v30
    v_dot2_f32_bf16 v31, v98, v98, v31
    v_dot2_f32_bf16 v30, v99, s53, v30
    v_dot2_f32_bf16 v31, v99, v99, v31
    s_nop 3
    v_permlane32_swap_b32 v28, v30
    v_permlane32_swap_b32 v29, v31
    s_nop 1
    v_add_f32 v28, v28, v30
    v_add_f32 v29, v29, v31
    s_nop 1
    v_permlane16_swap_b32 v28, v29
    s_nop 1
    v_add_f32 v28, v28, v29
    buffer_store_dword v28, v3, s[84:87], s52 offen sc0 sc1
    s_branch L_store_108
L_store_108:
    s_lshl_b32 s3, s28, 4
    s_add_u32 s3, s3, s29
    s_lshl_b32 s3, s3, 7
    s_lshr_b32 s100, s3, 1
    s_xor_b32 s100, s100, s3
    s_bfe_u32 s100, s100, 0x1000d
    s_mul_i32 s100, s100, 24576
    s_xor_b32 s3, s3, s100
    v_readlane_b32 s100, v255, 20
    s_xor_b32 s3, s3, 0x2000
    s_nop 0
    s_xor_b32 s3, s3, s100
    s_add_u32 s100, s3, 32768
    s_memrealtime s[96:97]
    s_add_u32 s76, s24, 3407872
    s_addc_u32 s77, s25, 0
    s_and_b32 s77, s77, 0xffff
    s_mov_b32 s78, 327680
    s_mov_b32 s79, 0x00020000
    v_lshlrev_b32 v250, 4, v1
    s_waitcnt lgkmcnt(0)
    v_mov_b32 v246, s96
    v_mov_b32 v247, s97
    v_mov_b32 v248, s96
    v_mov_b32 v249, s97
    s_cmp_lg_u32 s49, 0
    s_waitcnt vmcnt(0)
    s_barrier
    s_cbranch_scc1 P_ffn1
    s_mov_b64 exec, 0xff
    buffer_store_dwordx4 v[246:249], v250, s[76:79], s100 offen sc0 sc1
    s_mov_b64 exec, -1
    s_branch P_ffn1
L_end_106:
    s_endpgm
.p2align 6
P_ffn1:
    v_readlane_b32 s46, v255, 3
    s_setprio 0
    s_nop 2
    s_cmp_lg_u32 s46, 0
    s_cbranch_scc1 S_next
    s_and_b32 s3, s2, 7
    s_lshr_b32 s46, s2, 3
    s_lshr_b32 s28, s3, 2
    s_and_b32 s29, s3, 3
    s_mul_i32 s28, s28, 8
    s_mul_i32 s29, s29, 4
    s_lshr_b32 s3, s46, 2
    s_add_u32 s28, s28, s3
    s_and_b32 s3, s46, 3
    s_add_u32 s29, s29, s3
P_ffn1_go:
    s_load_dwordx2 s[24:25], s[0:1], 80
    s_load_dwordx2 s[58:59], s[0:1], 80
    s_load_dwordx2 s[26:27], s[0:1], 32
    s_load_dwordx2 s[34:35], s[0:1], 80
    s_load_dwordx2 s[38:39], s[0:1], 40
    v_and_b32 v1, 63, v0
    v_lshrrev_b32 v31, 6, v0
    s_nop 0
    v_readfirstlane_b32 s49, v31
    s_nop 3
    s_and_b32 s30, s49, 3
    s_lshr_b32 s44, s30, 1
    s_and_b32 s45, s30, 1
    s_cmp_lg_u32 s49, 0
    s_cbranch_scc1 L_fpolld_122
    s_mov_b32 exec_lo, 0xffffffff
    s_mov_b32 exec_hi, 0
    v_readlane_b32 s96, v255, 1
    v_readlane_b32 s97, v255, 2
    v_readlane_b32 s47, v255, 6
    v_lshlrev_b32 v250, 7, v1
    s_lshl_b32 s3, s28, 11
    s_lshr_b32 s46, s3, 1
    s_xor_b32 s46, s46, s3
    s_bfe_u32 s46, s46, 0x1000d
    s_mul_i32 s46, s46, 24576
    s_xor_b32 s3, s3, s46
    v_readlane_b32 s46, v255, 20
    s_xor_b32 s3, s3, 0x2000
    s_nop 0
    s_xor_b32 s3, s3, s46
    s_add_u32 s3, s3, 32768
    s_lshl_b32 s46, s29, 11
    s_lshr_b32 s98, s46, 1
    s_xor_b32 s98, s98, s46
    s_bfe_u32 s98, s98, 0x1000d
    s_mul_i32 s98, s98, 24576
    s_xor_b32 s46, s46, s98
    v_readlane_b32 s98, v255, 20
    s_xor_b32 s46, s46, 0x2000
    s_nop 0
    s_xor_b32 s46, s46, s98
    s_sub_u32 s46, s46, 2048
    v_add_u32 v251, s3, v250
    s_mov_b32 exec_lo, 0xffff0000
    v_add_u32 v251, s46, v250
    s_mov_b32 exec_lo, -1
    v_mov_b32 v250, v251
    s_mov_b32 s3, 0
    s_add_u32 s98, s96, 0x1000000
    s_addc_u32 s99, s97, 0
    s_mov_b32 s101, 200
    v_writelane_b32 v255, 0, 6
    s_cmp_lg_u32 s47, 0
    s_cbranch_scc1 L_fpoll_121x
L_fpoll_121:
    buffer_load_dwordx2 v[252:253], v250, s[76:79], s3 offen sc0 sc1
    s_waitcnt vmcnt(0)
    v_cmp_lt_u64 vcc, s[96:97], v[252:253]
    v_cmp_gt_u64 s[46:47], s[98:99], v[252:253]
    s_nop 1
    s_and_b64 s[46:47], s[46:47], vcc
    s_sub_u32 s101, s101, 1
    s_cselect_b64 s[46:47], exec, s[46:47]
    s_cmp_lg_u64 s[46:47], exec
    s_cbranch_scc1 L_fpoll_121
L_fpoll_121x:
    s_mov_b64 exec, -1
    s_lshr_b32 s3, s101, 31
    v_mov_b32 v250, 163776
    v_mov_b32 v251, s3
    ds_write_b32 v250, v251
    s_cmp_lg_u32 s3, 0
    s_waitcnt lgkmcnt(0)
    s_barrier
    s_cbranch_scc1 S_fail2
L_fpolld_122:
    s_cmp_lt_u32 s49, 4
    s_cbranch_scc1 L_comp_123
L_loader_119:
    s_setprio 2
    v_lshrrev_b32 v31, 3, v1
    v_lshrrev_b32 v32, 4, v1
    v_and_b32 v33, 7, v1
    v_xor_b32 v32, v32, v33
    s_mul_i32 s3, s28, 262144
    s_lshl_b32 s46, s30, 12
    s_add_u32 s3, s3, s46
    s_lshr_b32 s46, s3, 8
    s_xor_b32 s46, s46, s3
    s_bfe_u32 s46, s46, 0x1000d
    s_mul_i32 s46, s46, 2105344
    s_xor_b32 s3, s3, s46
    s_lshr_b32 s46, s3, 8
    s_and_b32 s46, s46, 0x2000
    s_xor_b32 s3, s3, s46
    v_readlane_b32 s46, v255, 20
    s_nop 0
    s_xor_b32 s3, s3, s46
    v_lshl_add_u32 v2, v1, 4, s3
    v_mov_b32 v34, v2
    v_add_u32 v3, 1024, v34
    v_add_u32 v4, 2048, v2
    v_add_u32 v5, 2048, v3
    s_mul_i32 s31, s30, 4096
    s_waitcnt lgkmcnt(0)
    s_add_u32 s4, s58, 16777216
    s_addc_u32 s5, s59, 0
    s_and_b32 s5, s5, 0xffff
    s_mov_b32 s6, 4194304
    s_mov_b32 s7, 0x00020000
    s_add_u32 m0, s31, 0
    s_mul_i32 s32, s30, 7168
    s_add_u32 m0, s31, 1024
    s_add_u32 s32, s32, 16384
    s_add_u32 m0, s31, 2048
    s_mul_i32 s3, s29, 448
    s_add_u32 m0, s31, 3072
    s_lshl_b32 s46, s44, 2
    s_add_u32 s46, s46, s45
    s_mul_i32 s46, s46, 57344
    s_add_u32 s3, s3, s46
    s_mov_b32 s8, s26
    s_mov_b32 s9, s27
    s_and_b32 s9, s9, 0xffff
    s_mov_b32 s10, 7340032
    s_mov_b32 s11, 0x00020000
    s_mov_b32 s47, 153391690
    v_add_u32 v32, 0, v1
    v_mul_hi_u32 v31, v32, s47
    v_mul_u32_u24 v33, 28, v31
    v_sub_u32 v32, v32, v33
    v_bfe_u32 v33, v31, 3, 1
    v_lshlrev_b32 v33, 1, v33
    v_xor_b32 v32, v32, v33
    v_and_b32 v34, 3, v31
    v_lshl_add_u32 v34, v33, 1, v34
    v_bfe_u32 v31, v31, 2, 1
    v_lshl_add_u32 v31, v31, 4, v34
    v_mul_u32_u24 v31, 7168, v31
    v_lshl_add_u32 v31, v32, 4, v31
    s_add_u32 m0, s32, 0
    v_add_u32 v6, s3, v31
    buffer_load_dwordx4 v6, s[8:11], 0 offen lds
    v_add_u32 v32, 64, v1
    v_mul_hi_u32 v31, v32, s47
    v_mul_u32_u24 v33, 28, v31
    v_sub_u32 v32, v32, v33
    v_bfe_u32 v33, v31, 3, 1
    v_lshlrev_b32 v33, 1, v33
    v_xor_b32 v32, v32, v33
    v_and_b32 v34, 3, v31
    v_lshl_add_u32 v34, v33, 1, v34
    v_bfe_u32 v31, v31, 2, 1
    v_lshl_add_u32 v31, v31, 4, v34
    v_mul_u32_u24 v31, 7168, v31
    v_lshl_add_u32 v31, v32, 4, v31
    s_add_u32 m0, s32, 1024
    v_add_u32 v7, s3, v31
    buffer_load_dwordx4 v7, s[8:11], 0 offen lds
    v_add_u32 v32, 128, v1
    v_mul_hi_u32 v31, v32, s47
    v_mul_u32_u24 v33, 28, v31
    v_sub_u32 v32, v32, v33
    v_bfe_u32 v33, v31, 3, 1
    v_lshlrev_b32 v33, 1, v33
    v_xor_b32 v32, v32, v33
    v_and_b32 v34, 3, v31
    v_lshl_add_u32 v34, v33, 1, v34
    v_bfe_u32 v31, v31, 2, 1
    v_lshl_add_u32 v31, v31, 4, v34
    v_mul_u32_u24 v31, 7168, v31
    v_lshl_add_u32 v31, v32, 4, v31
    s_add_u32 m0, s32, 2048
    v_add_u32 v8, s3, v31
    buffer_load_dwordx4 v8, s[8:11], 0 offen lds
    v_add_u32 v32, 192, v1
    v_mul_hi_u32 v31, v32, s47
    v_mul_u32_u24 v33, 28, v31
    v_sub_u32 v32, v32, v33
    v_bfe_u32 v33, v31, 3, 1
    v_lshlrev_b32 v33, 1, v33
    v_xor_b32 v32, v32, v33
    v_and_b32 v34, 3, v31
    v_lshl_add_u32 v34, v33, 1, v34
    v_bfe_u32 v31, v31, 2, 1
    v_lshl_add_u32 v31, v31, 4, v34
    v_mul_u32_u24 v31, 7168, v31
    v_lshl_add_u32 v31, v32, 4, v31
    s_add_u32 m0, s32, 3072
    v_add_u32 v9, s3, v31
    buffer_load_dwordx4 v9, s[8:11], 0 offen lds
    v_add_u32 v32, 256, v1
    v_mul_hi_u32 v31, v32, s47
    v_mul_u32_u24 v33, 28, v31
    v_sub_u32 v32, v32, v33
    v_bfe_u32 v33, v31, 3, 1
    v_lshlrev_b32 v33, 1, v33
    v_xor_b32 v32, v32, v33
    v_and_b32 v34, 3, v31
    v_lshl_add_u32 v34, v33, 1, v34
    v_bfe_u32 v31, v31, 2, 1
    v_lshl_add_u32 v31, v31, 4, v34
    v_mul_u32_u24 v31, 7168, v31
    v_lshl_add_u32 v31, v32, 4, v31
    s_add_u32 m0, s32, 4096
    v_add_u32 v10, s3, v31
    buffer_load_dwordx4 v10, s[8:11], 0 offen lds
    v_add_u32 v32, 320, v1
    v_mul_hi_u32 v31, v32, s47
    v_mul_u32_u24 v33, 28, v31
    v_sub_u32 v32, v32, v33
    v_bfe_u32 v33, v31, 3, 1
    v_lshlrev_b32 v33, 1, v33
    v_xor_b32 v32, v32, v33
    v_and_b32 v34, 3, v31
    v_lshl_add_u32 v34, v33, 1, v34
    v_bfe_u32 v31, v31, 2, 1
    v_lshl_add_u32 v31, v31, 4, v34
    v_mul_u32_u24 v31, 7168, v31
    v_lshl_add_u32 v31, v32, 4, v31
    s_add_u32 m0, s32, 5120
    v_add_u32 v11, s3, v31
    buffer_load_dwordx4 v11, s[8:11], 0 offen lds
    v_add_u32 v32, 384, v1
    v_mul_hi_u32 v31, v32, s47
    v_mul_u32_u24 v33, 28, v31
    v_sub_u32 v32, v32, v33
    v_bfe_u32 v33, v31, 3, 1
    v_lshlrev_b32 v33, 1, v33
    v_xor_b32 v32, v32, v33
    v_and_b32 v34, 3, v31
    v_lshl_add_u32 v34, v33, 1, v34
    v_bfe_u32 v31, v31, 2, 1
    v_lshl_add_u32 v31, v31, 4, v34
    v_mul_u32_u24 v31, 7168, v31
    v_lshl_add_u32 v31, v32, 4, v31
    s_add_u32 m0, s32, 6144
    v_add_u32 v12, s3, v31
    buffer_load_dwordx4 v12, s[8:11], 0 offen lds
    s_mov_b32 s40, 16384
    s_mov_b32 s41, 458752
    s_mov_b32 s43, 45056
    s_mov_b32 s42, 0
    s_add_u32 s12, s34, 20971520
    s_addc_u32 s13, s35, 0
    s_and_b32 s13, s13, 0xffff
    s_mov_b32 s14, 16777216
    s_mov_b32 s15, 0x00020000
    s_mov_b32 s20, s38
    s_mov_b32 s21, s39
    s_and_b32 s21, s21, 0xffff
    s_mov_b32 s22, 7168
    s_mov_b32 s23, 0x00020000
    s_mov_b32 s84, s24
    s_mov_b32 s85, s25
    s_and_b32 s85, s85, 0xffff
    s_mov_b32 s86, 262144
    s_mov_b32 s87, 0x00020000
    s_add_u32 s88, s24, 1048576
    s_addc_u32 s89, s25, 0
    s_and_b32 s89, s89, 0xffff
    s_mov_b32 s90, 229376
    s_mov_b32 s91, 0x00020000
    v_lshlrev_b32 v31, 4, v1
    s_mul_i32 s3, s29, 448
    s_mov_b32 m0, 135168
    s_nop 0
    buffer_load_dwordx4 v31, s[20:23], s3 offen lds
    s_add_u32 m0, s32, 45056
    s_nop 0
    buffer_load_dwordx4 v6, s[8:11], s41 offen lds
    s_add_u32 m0, s32, 46080
    s_nop 0
    buffer_load_dwordx4 v7, s[8:11], s41 offen lds
    s_add_u32 m0, s32, 47104
    s_nop 0
    buffer_load_dwordx4 v8, s[8:11], s41 offen lds
    s_add_u32 m0, s32, 48128
    s_nop 0
    buffer_load_dwordx4 v9, s[8:11], s41 offen lds
    s_add_u32 m0, s32, 49152
    s_nop 0
    buffer_load_dwordx4 v10, s[8:11], s41 offen lds
    s_add_u32 m0, s32, 50176
    s_nop 0
    buffer_load_dwordx4 v11, s[8:11], s41 offen lds
    s_add_u32 m0, s32, 51200
    s_nop 0
    buffer_load_dwordx4 v12, s[8:11], s41 offen lds
    s_add_u32 s41, s41, 458752
    v_mov_b32 v246, 163776
    s_barrier
    ds_read_b32 v246, v246
    s_waitcnt lgkmcnt(0)
    v_cmp_ne_u32 vcc, 0, v246
    s_cbranch_vccnz S_fail2
    s_add_u32 m0, s31, 0
    s_mov_b32 s40, 0
    buffer_load_dwordx4 v2, s[4:7], s40 offen lds
    s_add_u32 m0, s31, 1024
    s_mov_b32 s40, 0
    buffer_load_dwordx4 v3, s[4:7], s40 offen lds
    s_add_u32 m0, s31, 2048
    s_mov_b32 s40, 0
    buffer_load_dwordx4 v4, s[4:7], s40 offen lds
    s_add_u32 m0, s31, 3072
    s_mov_b32 s40, 0
    s_nop 0
    buffer_load_dwordx4 v5, s[4:7], s40 offen lds
    s_add_u32 m0, s31, 45056
    s_mov_b32 s40, 16384
    buffer_load_dwordx4 v2, s[4:7], s40 offen lds
    s_add_u32 m0, s31, 46080
    s_mov_b32 s40, 16384
    buffer_load_dwordx4 v3, s[4:7], s40 offen lds
    s_add_u32 m0, s31, 47104
    s_mov_b32 s40, 16384
    buffer_load_dwordx4 v4, s[4:7], s40 offen lds
    s_add_u32 m0, s31, 48128
    s_mov_b32 s40, 16384
    buffer_load_dwordx4 v5, s[4:7], s40 offen lds
    s_mov_b32 s40, 32768
    s_mov_b32 s43, 90112
    v_and_b32 v40, 15, v1
    v_lshlrev_b32 v40, 4, v40
    s_lshl_b32 s3, s30, 8
    v_add_u32 v40, s3, v40
    v_lshrrev_b32 v32, 4, v1
    v_lshl_add_u32 v34, v32, 10, v40
    s_lshl_b32 s3, s28, 14
    s_lshr_b32 s46, s3, 4
    s_xor_b32 s46, s46, s3
    s_bfe_u32 s46, s46, 0x1000d
    s_mul_i32 s46, s46, 139264
    s_xor_b32 s3, s3, s46
    v_readlane_b32 s46, v255, 20
    s_nop 0
    s_xor_b32 s3, s3, s46
    s_nop 0
    buffer_load_dwordx4 v[84:87], v34, s[84:87], s3 offen
    s_add_u32 s3, s3, 4096
    buffer_load_dwordx4 v[88:91], v34, s[84:87], s3 offen
    s_add_u32 s3, s3, 126976
    buffer_load_dwordx4 v[92:95], v34, s[84:87], s3 offen
    s_add_u32 s3, s3, 4096
    buffer_load_dwordx4 v[96:99], v34, s[84:87], s3 offen
    s_add_u32 s3, s3, 4096
    s_mul_i32 s3, s29, 896
    s_mul_i32 s46, s30, 57344
    s_add_u32 s3, s3, s46
    s_nop 0
    s_mov_b32 exec_hi, 0x00ffffff
    buffer_load_dwordx4 v[100:103], v31, s[88:91], s3 offen
    s_add_u32 s3, s3, 14336
    buffer_load_dwordx4 v[104:107], v31, s[88:91], s3 offen
    s_add_u32 s3, s3, 14336
    buffer_load_dwordx4 v[108:111], v31, s[88:91], s3 offen
    s_add_u32 s3, s3, 14336
    buffer_load_dwordx4 v[112:115], v31, s[88:91], s3 offen
    s_add_u32 s3, s3, 14336
    s_mov_b32 exec_hi, -1
    s_waitcnt vmcnt(12)
    s_barrier
    s_add_u32 s33, s43, s31
    s_add_u32 m0, s33, 0
    s_nop 0
    buffer_load_dwordx4 v2, s[4:7], s40 offen lds
    s_add_u32 m0, s33, 1024
    s_nop 0
    buffer_load_dwordx4 v3, s[4:7], s40 offen lds
    s_add_u32 m0, s33, 2048
    s_nop 0
    buffer_load_dwordx4 v4, s[4:7], s40 offen lds
    s_add_u32 m0, s33, 3072
    s_nop 0
    buffer_load_dwordx4 v5, s[4:7], s40 offen lds
    s_add_u32 s33, s43, s32
    s_add_u32 m0, s33, 0
    s_nop 0
    buffer_load_dwordx4 v6, s[8:11], s41 offen lds
    s_add_u32 m0, s33, 1024
    s_nop 0
    buffer_load_dwordx4 v7, s[8:11], s41 offen lds
    s_add_u32 m0, s33, 2048
    s_nop 0
    buffer_load_dwordx4 v8, s[8:11], s41 offen lds
    s_add_u32 m0, s33, 3072
    s_nop 0
    buffer_load_dwordx4 v9, s[8:11], s41 offen lds
    s_add_u32 m0, s33, 4096
    s_nop 0
    buffer_load_dwordx4 v10, s[8:11], s41 offen lds
    s_add_u32 m0, s33, 5120
    s_nop 0
    buffer_load_dwordx4 v11, s[8:11], s41 offen lds
    s_add_u32 m0, s33, 6144
    s_nop 0
    buffer_load_dwordx4 v12, s[8:11], s41 offen lds
    s_add_u32 s40, s40, 16384
    s_add_u32 s41, s41, 458752
    s_add_u32 s43, s43, 45056
    s_cmp_ge_u32 s43, 135168
    s_cselect_b32 s43, 0, s43
    s_mov_b32 s48, 13
L_lloop_132:
    s_waitcnt vmcnt(11)
    s_barrier
    s_add_u32 s33, s43, s31
    s_add_u32 m0, s33, 0
    s_nop 0
    buffer_load_dwordx4 v2, s[4:7], s40 offen lds
    s_add_u32 m0, s33, 1024
    s_nop 0
    buffer_load_dwordx4 v3, s[4:7], s40 offen lds
    s_add_u32 m0, s33, 2048
    s_nop 0
    buffer_load_dwordx4 v4, s[4:7], s40 offen lds
    s_add_u32 m0, s33, 3072
    s_nop 0
    buffer_load_dwordx4 v5, s[4:7], s40 offen lds
    s_add_u32 s33, s43, s32
    s_add_u32 m0, s33, 0
    s_nop 0
    buffer_load_dwordx4 v6, s[8:11], s41 offen lds
    s_add_u32 m0, s33, 1024
    s_nop 0
    buffer_load_dwordx4 v7, s[8:11], s41 offen lds
    s_add_u32 m0, s33, 2048
    s_nop 0
    buffer_load_dwordx4 v8, s[8:11], s41 offen lds
    s_add_u32 m0, s33, 3072
    s_nop 0
    buffer_load_dwordx4 v9, s[8:11], s41 offen lds
    s_add_u32 m0, s33, 4096
    s_nop 0
    buffer_load_dwordx4 v10, s[8:11], s41 offen lds
    s_add_u32 m0, s33, 5120
    s_nop 0
    buffer_load_dwordx4 v11, s[8:11], s41 offen lds
    s_add_u32 m0, s33, 6144
    s_nop 0
    buffer_load_dwordx4 v12, s[8:11], s41 offen lds
    s_add_u32 s40, s40, 16384
    s_add_u32 s41, s41, 458752
    s_add_u32 s43, s43, 45056
    s_cmp_ge_u32 s43, 135168
    s_cselect_b32 s43, 0, s43
    s_sub_u32 s48, s48, 1
    s_cmp_lg_u32 s48, 0
    s_cbranch_scc1 L_lloop_132
    v_pk_add_f32 v[84:85], v[84:85], v[88:89]
    v_pk_add_f32 v[86:87], v[86:87], v[90:91]
    v_pk_add_f32 v[84:85], v[84:85], v[92:93]
    v_pk_add_f32 v[86:87], v[86:87], v[94:95]
    v_pk_add_f32 v[84:85], v[84:85], v[96:97]
    v_pk_add_f32 v[86:87], v[86:87], v[98:99]
    v_xor_b32 v31, 16, v1
    v_lshlrev_b32 v31, 2, v31
    ds_bpermute_b32 v88, v31, v84
    ds_bpermute_b32 v89, v31, v85
    ds_bpermute_b32 v90, v31, v86
    ds_bpermute_b32 v91, v31, v87
    s_waitcnt lgkmcnt(0)
    v_pk_add_f32 v[84:85], v[84:85], v[88:89]
    v_pk_add_f32 v[86:87], v[86:87], v[90:91]
    v_xor_b32 v31, 32, v1
    v_lshlrev_b32 v31, 2, v31
    ds_bpermute_b32 v88, v31, v84
    ds_bpermute_b32 v89, v31, v85
    ds_bpermute_b32 v90, v31, v86
    ds_bpermute_b32 v91, v31, v87
    s_waitcnt lgkmcnt(0)
    v_pk_add_f32 v[84:85], v[84:85], v[88:89]
    v_pk_add_f32 v[86:87], v[86:87], v[90:91]
    v_mul_f32 v84, 0x3a800000, v84
    v_mul_f32 v85, 0x3a800000, v85
    v_fma_f32 v85, -v84, v84, v85
    v_max_f32 v85, 0, v85
    v_add_f32 v88, 0x3727c5ac, v85
    v_rsq_f32 v88, v88
    s_nop 0
    v_mul_f32 v89, v88, v88
    v_mul_f32 v89, v89, v85
    v_add_f32 v89, 0x3727c5ac, v89
    v_rsq_f32 v89, v89
    s_nop 0
    v_mul_f32 v88, v88, v89
    v_mul_f32 v89, v84, v88
    v_sub_f32 v89, 0, v89
    v_mul_f32 v86, 0x3a800000, v86
    v_mul_f32 v87, 0x3a800000, v87
    v_fma_f32 v87, -v86, v86, v87
    v_max_f32 v87, 0, v87
    v_add_f32 v90, 0x3727c5ac, v87
    v_rsq_f32 v90, v90
    s_nop 0
    v_mul_f32 v91, v90, v90
    v_mul_f32 v91, v91, v87
    v_add_f32 v91, 0x3727c5ac, v91
    v_rsq_f32 v91, v91
    s_nop 0
    v_mul_f32 v90, v90, v91
    v_mul_f32 v91, v86, v90
    v_sub_f32_e64 v91, 0, v91
    v_add_u32 v48, 137216, v40
    ds_write_b128 v48, v[88:91]
    v_pk_add_f32 v[100:101], v[100:101], v[104:105]
    v_pk_add_f32 v[102:103], v[102:103], v[106:107]
    v_pk_add_f32 v[100:101], v[100:101], v[108:109]
    v_pk_add_f32 v[102:103], v[102:103], v[110:111]
    v_pk_add_f32 v[100:101], v[100:101], v[112:113]
    v_pk_add_f32 v[102:103], v[102:103], v[114:115]
    v_lshlrev_b32 v31, 4, v1
    v_add_u32 v31, 138240, v31
    s_lshl_b32 s3, s30, 10
    v_add_u32 v32, s3, v31
    ds_write_b128 v32, v[100:103]
    s_waitcnt lgkmcnt(0)
    s_waitcnt vmcnt(11)
    s_barrier
    s_cmp_lg_u32 s30, 0
    s_cbranch_scc1 L_lcs_133
    ds_read_b128 v[100:103], v31 offset:0
    ds_read_b128 v[104:107], v31 offset:1024
    ds_read_b128 v[108:111], v31 offset:2048
    ds_read_b128 v[112:115], v31 offset:3072
    v_lshlrev_b32 v32, 3, v1
    v_add_u32 v32, 135168, v32
    ds_read_b64 v[84:85], v32
    s_waitcnt lgkmcnt(0)
    v_lshlrev_b32 v88, 16, v84
    v_and_b32 v89, 0xffff0000, v84
    v_lshlrev_b32 v90, 16, v85
    v_and_b32 v91, 0xffff0000, v85
    ds_write_b128 v31, v[88:91]
    v_pk_add_f32 v[100:101], v[100:101], v[104:105]
    v_pk_add_f32 v[102:103], v[102:103], v[106:107]
    v_pk_add_f32 v[100:101], v[100:101], v[108:109]
    v_pk_add_f32 v[102:103], v[102:103], v[110:111]
    v_pk_add_f32 v[100:101], v[100:101], v[112:113]
    v_pk_add_f32 v[102:103], v[102:103], v[114:115]
    v_subrev_u32 v31, 2048, v31
    ds_write_b128 v31, v[100:103]
    s_waitcnt lgkmcnt(0)
L_lcs_133:
    s_branch P_f2_lw
L_comp_123:
    v_and_b32 v31, 15, v1
    s_lshl_b32 s3, s44, 12
    v_lshl_add_u32 v13, v1, 4, s3
    v_add_u32 v14, 0x2000, v13
    v_lshrrev_b32 v32, 4, v1
    v_bfe_u32 v31, v1, 2, 2
    v_lshl_add_u32 v33, v32, 3, v31
    v_and_b32 v34, 1, v32
    v_mul_u32_u24 v33, 448, v33
    v_and_b32 v31, 3, v1
    v_lshl_add_u32 v33, v31, 3, v33
    v_add_u32 v33, 16384, v33
    s_mul_i32 s3, s45, 7
    s_load_dwordx2 s[36:37], s[0:1], 56
    s_cmp_eq_u32 s45, 0
    s_cselect_b32 s46, 0, 10
    s_mov_b32 s47, 0
    s_mul_i32 s47, s47, 28672
    v_xor_b32 v31, s46, v34
    v_lshl_add_u32 v31, v31, 5, v33
    v_add_u32 v15, s47, v31
    s_cmp_eq_u32 s45, 0
    s_cselect_b32 s46, 1, 11
    s_mov_b32 s47, 0
    s_mul_i32 s47, s47, 28672
    v_xor_b32 v31, s46, v34
    v_lshl_add_u32 v31, v31, 5, v33
    v_add_u32 v16, s47, v31
    s_cmp_eq_u32 s45, 0
    s_cselect_b32 s46, 2, 12
    s_mov_b32 s47, 0
    s_mul_i32 s47, s47, 28672
    v_xor_b32 v31, s46, v34
    v_lshl_add_u32 v31, v31, 5, v33
    v_add_u32 v17, s47, v31
    s_cmp_eq_u32 s45, 0
    s_cselect_b32 s46, 3, 13
    s_mov_b32 s47, 0
    s_mul_i32 s47, s47, 28672
    v_xor_b32 v31, s46, v34
    v_lshl_add_u32 v31, v31, 5, v33
    v_add_u32 v18, s47, v31
    s_cmp_eq_u32 s45, 0
    s_cselect_b32 s46, 4, 8
    s_mov_b32 s47, 0
    s_mul_i32 s47, s47, 28672
    v_xor_b32 v31, s46, v34
    v_lshl_add_u32 v31, v31, 5, v33
    v_add_u32 v19, s47, v31
    s_cmp_eq_u32 s45, 0
    s_cselect_b32 s46, 5, 9
    s_mov_b32 s47, 0
    s_mul_i32 s47, s47, 28672
    v_xor_b32 v31, s46, v34
    v_lshl_add_u32 v31, v31, 5, v33
    v_add_u32 v20, s47, v31
    s_cmp_eq_u32 s45, 0
    s_cselect_b32 s46, 6, 7
    s_mov_b32 s47, 0
    s_mul_i32 s47, s47, 28672
    v_xor_b32 v31, s46, v34
    v_lshl_add_u32 v31, v31, 5, v33
    v_add_u32 v21, s47, v31
    s_mov_b32 s42, 0
    s_waitcnt lgkmcnt(0)
    s_add_u32 s4, s58, 16777216
    s_addc_u32 s5, s59, 0
    s_and_b32 s5, s5, 0xffff
    s_mov_b32 s6, 4194304
    s_mov_b32 s7, 0x00020000
    s_mov_b32 s8, s26
    s_mov_b32 s9, s27
    s_and_b32 s9, s9, 0xffff
    s_mov_b32 s10, 7340032
    s_mov_b32 s11, 0x00020000
    s_add_u32 s12, s34, 20971520
    s_addc_u32 s13, s35, 0
    s_and_b32 s13, s13, 0xffff
    s_mov_b32 s14, 16777216
    s_mov_b32 s15, 0x00020000
    s_mov_b32 s20, s38
    s_mov_b32 s21, s39
    s_and_b32 s21, s21, 0xffff
    s_mov_b32 s22, 7168
    s_mov_b32 s23, 0x00020000
    s_mov_b32 s84, s24
    s_mov_b32 s85, s25
    s_and_b32 s85, s85, 0xffff
    s_mov_b32 s86, 262144
    s_mov_b32 s87, 0x00020000
    s_add_u32 s88, s24, 1048576
    s_addc_u32 s89, s25, 0
    s_and_b32 s89, s89, 0xffff
    s_mov_b32 s90, 229376
    s_mov_b32 s91, 0x00020000
    s_lshl_b32 s3, s2, 2
    s_add_u32 s3, s3, s30
    s_load_dwordx2 s[94:95], s[0:1], 48
    s_mul_i32 s92, s3, 7168
    s_waitcnt lgkmcnt(0)
    s_mov_b32 s84, s94
    s_mov_b32 s85, s95
    s_and_b32 s85, s85, 0xffff
    s_mov_b32 s86, 7340032
    s_mov_b32 s87, 0x00020000
    v_lshlrev_b32 v244, 4, v1
    v_add_u32 v22, s42, v13
    v_add_u32 v23, s42, v14
    v_add_u32 v24, s42, v15
    v_add_u32 v25, s42, v16
    v_add_u32 v26, s42, v17
    v_add_u32 v27, s42, v18
    v_add_u32 v28, s42, v19
    v_add_u32 v29, s42, v20
    v_add_u32 v30, s42, v21
    s_add_u32 s42, s42, 45056
    s_cmp_ge_u32 s42, 135168
    s_cselect_b32 s42, 0, s42
    s_cmp_eq_u32 s49, 0
    s_cbranch_scc1 L_t2_124
    v_mov_b32 v246, 163776
    s_barrier
    ds_read_b32 v246, v246
    s_waitcnt lgkmcnt(0)
    v_cmp_ne_u32 vcc, 0, v246
    s_cbranch_vccnz S_fail2
L_t2_124:
L_cpass_125:
    s_barrier
    s_nop 0
    ds_read_b128 v[40:43], v22 offset:0
    ds_read_b64_tr_b16 v[72:73], v24 offset:0
    ds_read_b64_tr_b16 v[74:75], v24 offset:1792
    ds_read_b128 v[44:47], v22 offset:1024
    ds_read_b64_tr_b16 v[76:77], v25 offset:0
    ds_read_b64_tr_b16 v[78:79], v25 offset:1792
    ds_read_b128 v[48:51], v22 offset:2048
    ds_read_b64_tr_b16 v[80:81], v26 offset:0
    ds_read_b64_tr_b16 v[82:83], v26 offset:1792
    ds_read_b128 v[52:55], v22 offset:3072
    ds_read_b64_tr_b16 v[84:85], v27 offset:0
    ds_read_b64_tr_b16 v[86:87], v27 offset:1792
    ds_read_b64_tr_b16 v[88:89], v28 offset:0
    ds_read_b64_tr_b16 v[90:91], v28 offset:1792
    ds_read_b64_tr_b16 v[92:93], v29 offset:0
    ds_read_b64_tr_b16 v[94:95], v29 offset:1792
    ds_read_b64_tr_b16 v[96:97], v30 offset:0
    ds_read_b64_tr_b16 v[98:99], v30 offset:1792
    s_waitcnt lgkmcnt(0)
    v_mfma_f32_16x16x32_bf16 v[128:131], v[72:75], v[40:43], 0
    ds_read_b128 v[56:59], v23 offset:0
    v_mfma_f32_16x16x32_bf16 v[132:135], v[72:75], v[44:47], 0
    ds_read_b64_tr_b16 v[100:101], v24 offset:14336
    v_mfma_f32_16x16x32_bf16 v[136:139], v[72:75], v[48:51], 0
    ds_read_b64_tr_b16 v[102:103], v24 offset:16128
    v_mfma_f32_16x16x32_bf16 v[140:143], v[72:75], v[52:55], 0
    ds_read_b128 v[60:63], v23 offset:1024
    v_mfma_f32_16x16x32_bf16 v[144:147], v[76:79], v[40:43], 0
    ds_read_b64_tr_b16 v[104:105], v25 offset:14336
    v_mfma_f32_16x16x32_bf16 v[148:151], v[76:79], v[44:47], 0
    ds_read_b64_tr_b16 v[106:107], v25 offset:16128
    v_mfma_f32_16x16x32_bf16 v[152:155], v[76:79], v[48:51], 0
    ds_read_b128 v[64:67], v23 offset:2048
    v_mfma_f32_16x16x32_bf16 v[156:159], v[76:79], v[52:55], 0
    ds_read_b64_tr_b16 v[108:109], v26 offset:14336
    v_mfma_f32_16x16x32_bf16 v[160:163], v[80:83], v[40:43], 0
    ds_read_b64_tr_b16 v[110:111], v26 offset:16128
    v_mfma_f32_16x16x32_bf16 v[164:167], v[80:83], v[44:47], 0
    ds_read_b128 v[68:71], v23 offset:3072
    v_mfma_f32_16x16x32_bf16 v[168:171], v[80:83], v[48:51], 0
    ds_read_b64_tr_b16 v[112:113], v27 offset:14336
    v_mfma_f32_16x16x32_bf16 v[172:175], v[80:83], v[52:55], 0
    ds_read_b64_tr_b16 v[114:115], v27 offset:16128
    v_mfma_f32_16x16x32_bf16 v[176:179], v[84:87], v[40:43], 0
    ds_read_b64_tr_b16 v[116:117], v28 offset:14336
    v_mfma_f32_16x16x32_bf16 v[180:183], v[84:87], v[44:47], 0
    ds_read_b64_tr_b16 v[118:119], v28 offset:16128
    v_mfma_f32_16x16x32_bf16 v[184:187], v[84:87], v[48:51], 0
    ds_read_b64_tr_b16 v[120:121], v29 offset:14336
    v_mfma_f32_16x16x32_bf16 v[188:191], v[84:87], v[52:55], 0
    ds_read_b64_tr_b16 v[122:123], v29 offset:16128
    v_mfma_f32_16x16x32_bf16 v[192:195], v[88:91], v[40:43], 0
    ds_read_b64_tr_b16 v[124:125], v30 offset:14336
    v_mfma_f32_16x16x32_bf16 v[196:199], v[88:91], v[44:47], 0
    ds_read_b64_tr_b16 v[126:127], v30 offset:16128
    v_mfma_f32_16x16x32_bf16 v[200:203], v[88:91], v[48:51], 0
    v_add_u32 v22, s42, v13
    v_add_u32 v23, s42, v14
    v_add_u32 v24, s42, v15
    v_mfma_f32_16x16x32_bf16 v[204:207], v[88:91], v[52:55], 0
    v_add_u32 v25, s42, v16
    v_add_u32 v26, s42, v17
    v_add_u32 v27, s42, v18
    v_mfma_f32_16x16x32_bf16 v[208:211], v[92:95], v[40:43], 0
    v_add_u32 v28, s42, v19
    v_add_u32 v29, s42, v20
    v_add_u32 v30, s42, v21
    v_mfma_f32_16x16x32_bf16 v[212:215], v[92:95], v[44:47], 0
    s_add_u32 s42, s42, 45056
    s_cmp_ge_u32 s42, 135168
    s_cselect_b32 s42, 0, s42
    v_mfma_f32_16x16x32_bf16 v[216:219], v[92:95], v[48:51], 0
    v_mfma_f32_16x16x32_bf16 v[220:223], v[92:95], v[52:55], 0
    v_mfma_f32_16x16x32_bf16 v[224:227], v[96:99], v[40:43], 0
    v_mfma_f32_16x16x32_bf16 v[228:231], v[96:99], v[44:47], 0
    v_mfma_f32_16x16x32_bf16 v[232:235], v[96:99], v[48:51], 0
    v_mfma_f32_16x16x32_bf16 v[236:239], v[96:99], v[52:55], 0
    s_waitcnt lgkmcnt(0)
    s_mov_b32 s48, 15
    v_lshrrev_b32 v32, 3, v1
    v_and_b32 v31, 7, v1
    v_lshlrev_b32 v31, 7, v31
    v_lshl_add_u32 v32, v32, 11, v31
    s_lshr_b32 s3, s2, 3
    s_lshl_b32 s3, s3, 2
    s_add_u32 s3, s3, s30
    s_lshr_b32 s46, s29, 3
    s_lshl_b32 s46, s46, 7
    s_add_u32 s3, s3, s46
    s_mul_i32 s96, s3, 28672
    s_bfe_u32 s3, s29, 0x10002
    s_lshl_b32 s3, s3, 10
    s_add_u32 s96, s96, s3
    s_cmp_eq_u32 s49, 1
    s_cselect_b32 s97, 12, 5
    s_branch L_cloop_126
L_xw_127:
    s_cmp_lg_u32 s97, 12
    s_cbranch_scc1 L_c3a_129
    s_mov_b32 s97, 9
    s_branch L_xwb_128
L_c3a_129:
    s_cmp_lg_u32 s97, 9
    s_cbranch_scc1 L_c3b_130
    s_mov_b32 s3, 0
    v_writelane_b32 v255, s3, 5
    s_cmp_lg_u32 s49, 1
    s_cbranch_scc1 L_c3w_131
    v_readlane_b32 s3, v255, 5
    v_mov_b32 v251, 143360
    s_nop 1
    v_mov_b32 v252, s3
    ds_write_b32 v251, v252 offset:4
    s_waitcnt lgkmcnt(0)
L_c3w_131:
    s_mov_b32 s97, 5
    s_branch L_xwb_128
L_c3b_130:
    s_mov_b32 exec_hi, 0x00ffffff
    s_mov_b32 exec_lo, -1
    buffer_load_dword v240, v32, s[84:87], s96 offen
    s_mov_b64 exec, -1
    s_add_u32 s96, s96, 14336
    s_cmp_eq_u32 s97, 5
    s_cselect_b32 s97, 3, 0
    s_branch L_xwb_128
L_cloop_126:
    s_barrier
    v_mfma_f32_16x16x32_bf16 v[128:131], v[100:103], v[56:59], v[128:131]
    ds_read_b128 v[40:43], v22 offset:0
    v_mfma_f32_16x16x32_bf16 v[132:135], v[100:103], v[60:63], v[132:135]
    ds_read_b64_tr_b16 v[72:73], v24 offset:0
    v_mfma_f32_16x16x32_bf16 v[136:139], v[100:103], v[64:67], v[136:139]
    ds_read_b64_tr_b16 v[74:75], v24 offset:1792
    v_mfma_f32_16x16x32_bf16 v[140:143], v[100:103], v[68:71], v[140:143]
    ds_read_b128 v[44:47], v22 offset:1024
    v_mfma_f32_16x16x32_bf16 v[144:147], v[104:107], v[56:59], v[144:147]
    ds_read_b64_tr_b16 v[76:77], v25 offset:0
    v_mfma_f32_16x16x32_bf16 v[148:151], v[104:107], v[60:63], v[148:151]
    ds_read_b64_tr_b16 v[78:79], v25 offset:1792
    v_mfma_f32_16x16x32_bf16 v[152:155], v[104:107], v[64:67], v[152:155]
    ds_read_b128 v[48:51], v22 offset:2048
    v_mfma_f32_16x16x32_bf16 v[156:159], v[104:107], v[68:71], v[156:159]
    ds_read_b64_tr_b16 v[80:81], v26 offset:0
    v_mfma_f32_16x16x32_bf16 v[160:163], v[108:111], v[56:59], v[160:163]
    ds_read_b64_tr_b16 v[82:83], v26 offset:1792
    v_mfma_f32_16x16x32_bf16 v[164:167], v[108:111], v[60:63], v[164:167]
    ds_read_b128 v[52:55], v22 offset:3072
    v_mfma_f32_16x16x32_bf16 v[168:171], v[108:111], v[64:67], v[168:171]
    ds_read_b64_tr_b16 v[84:85], v27 offset:0
    v_mfma_f32_16x16x32_bf16 v[172:175], v[108:111], v[68:71], v[172:175]
    ds_read_b64_tr_b16 v[86:87], v27 offset:1792
    v_mfma_f32_16x16x32_bf16 v[176:179], v[112:115], v[56:59], v[176:179]
    ds_read_b64_tr_b16 v[88:89], v28 offset:0
    v_mfma_f32_16x16x32_bf16 v[180:183], v[112:115], v[60:63], v[180:183]
    ds_read_b64_tr_b16 v[90:91], v28 offset:1792
    v_mfma_f32_16x16x32_bf16 v[184:187], v[112:115], v[64:67], v[184:187]
    ds_read_b64_tr_b16 v[92:93], v29 offset:0
    v_mfma_f32_16x16x32_bf16 v[188:191], v[112:115], v[68:71], v[188:191]
    ds_read_b64_tr_b16 v[94:95], v29 offset:1792
    v_mfma_f32_16x16x32_bf16 v[192:195], v[116:119], v[56:59], v[192:195]
    ds_read_b64_tr_b16 v[96:97], v30 offset:0
    v_mfma_f32_16x16x32_bf16 v[196:199], v[116:119], v[60:63], v[196:199]
    ds_read_b64_tr_b16 v[98:99], v30 offset:1792
    v_mfma_f32_16x16x32_bf16 v[200:203], v[116:119], v[64:67], v[200:203]
    v_mfma_f32_16x16x32_bf16 v[204:207], v[116:119], v[68:71], v[204:207]
    v_mfma_f32_16x16x32_bf16 v[208:211], v[120:123], v[56:59], v[208:211]
    v_mfma_f32_16x16x32_bf16 v[212:215], v[120:123], v[60:63], v[212:215]
    v_mfma_f32_16x16x32_bf16 v[216:219], v[120:123], v[64:67], v[216:219]
    v_mfma_f32_16x16x32_bf16 v[220:223], v[120:123], v[68:71], v[220:223]
    v_mfma_f32_16x16x32_bf16 v[224:227], v[124:127], v[56:59], v[224:227]
    v_mfma_f32_16x16x32_bf16 v[228:231], v[124:127], v[60:63], v[228:231]
    v_mfma_f32_16x16x32_bf16 v[232:235], v[124:127], v[64:67], v[232:235]
    v_mfma_f32_16x16x32_bf16 v[236:239], v[124:127], v[68:71], v[236:239]
    s_waitcnt lgkmcnt(0)
    v_mfma_f32_16x16x32_bf16 v[128:131], v[72:75], v[40:43], v[128:131]
    ds_read_b128 v[56:59], v23 offset:0
    v_mfma_f32_16x16x32_bf16 v[132:135], v[72:75], v[44:47], v[132:135]
    ds_read_b64_tr_b16 v[100:101], v24 offset:14336
    v_mfma_f32_16x16x32_bf16 v[136:139], v[72:75], v[48:51], v[136:139]
    ds_read_b64_tr_b16 v[102:103], v24 offset:16128
    v_mfma_f32_16x16x32_bf16 v[140:143], v[72:75], v[52:55], v[140:143]
    ds_read_b128 v[60:63], v23 offset:1024
    v_mfma_f32_16x16x32_bf16 v[144:147], v[76:79], v[40:43], v[144:147]
    ds_read_b64_tr_b16 v[104:105], v25 offset:14336
    v_mfma_f32_16x16x32_bf16 v[148:151], v[76:79], v[44:47], v[148:151]
    ds_read_b64_tr_b16 v[106:107], v25 offset:16128
    v_mfma_f32_16x16x32_bf16 v[152:155], v[76:79], v[48:51], v[152:155]
    ds_read_b128 v[64:67], v23 offset:2048
    v_mfma_f32_16x16x32_bf16 v[156:159], v[76:79], v[52:55], v[156:159]
    ds_read_b64_tr_b16 v[108:109], v26 offset:14336
    v_mfma_f32_16x16x32_bf16 v[160:163], v[80:83], v[40:43], v[160:163]
    ds_read_b64_tr_b16 v[110:111], v26 offset:16128
    v_mfma_f32_16x16x32_bf16 v[164:167], v[80:83], v[44:47], v[164:167]
    ds_read_b128 v[68:71], v23 offset:3072
    v_mfma_f32_16x16x32_bf16 v[168:171], v[80:83], v[48:51], v[168:171]
    ds_read_b64_tr_b16 v[112:113], v27 offset:14336
    v_mfma_f32_16x16x32_bf16 v[172:175], v[80:83], v[52:55], v[172:175]
    ds_read_b64_tr_b16 v[114:115], v27 offset:16128
    v_mfma_f32_16x16x32_bf16 v[176:179], v[84:87], v[40:43], v[176:179]
    ds_read_b64_tr_b16 v[116:117], v28 offset:14336
    v_mfma_f32_16x16x32_bf16 v[180:183], v[84:87], v[44:47], v[180:183]
    ds_read_b64_tr_b16 v[118:119], v28 offset:16128
    v_mfma_f32_16x16x32_bf16 v[184:187], v[84:87], v[48:51], v[184:187]
    ds_read_b64_tr_b16 v[120:121], v29 offset:14336
    v_mfma_f32_16x16x32_bf16 v[188:191], v[84:87], v[52:55], v[188:191]
    ds_read_b64_tr_b16 v[122:123], v29 offset:16128
    v_mfma_f32_16x16x32_bf16 v[192:195], v[88:91], v[40:43], v[192:195]
    ds_read_b64_tr_b16 v[124:125], v30 offset:14336
    v_mfma_f32_16x16x32_bf16 v[196:199], v[88:91], v[44:47], v[196:199]
    ds_read_b64_tr_b16 v[126:127], v30 offset:16128
    v_mfma_f32_16x16x32_bf16 v[200:203], v[88:91], v[48:51], v[200:203]
    v_add_u32 v22, s42, v13
    v_add_u32 v23, s42, v14
    v_add_u32 v24, s42, v15
    v_mfma_f32_16x16x32_bf16 v[204:207], v[88:91], v[52:55], v[204:207]
    v_add_u32 v25, s42, v16
    v_add_u32 v26, s42, v17
    v_add_u32 v27, s42, v18
    v_mfma_f32_16x16x32_bf16 v[208:211], v[92:95], v[40:43], v[208:211]
    v_add_u32 v28, s42, v19
    v_add_u32 v29, s42, v20
    v_add_u32 v30, s42, v21
    v_mfma_f32_16x16x32_bf16 v[212:215], v[92:95], v[44:47], v[212:215]
    s_add_u32 s42, s42, 45056
    s_cmp_ge_u32 s42, 135168
    s_cselect_b32 s42, 0, s42
    v_mfma_f32_16x16x32_bf16 v[216:219], v[92:95], v[48:51], v[216:219]
    s_cmp_eq_u32 s48, s97
    s_cbranch_scc1 L_xw_127
L_xwb_128:
    s_sub_u32 s48, s48, 1
    s_cmp_lg_u32 s48, 0
    v_mfma_f32_16x16x32_bf16 v[220:223], v[92:95], v[52:55], v[220:223]
    v_mfma_f32_16x16x32_bf16 v[224:227], v[96:99], v[40:43], v[224:227]
    v_mfma_f32_16x16x32_bf16 v[228:231], v[96:99], v[44:47], v[228:231]
    v_mfma_f32_16x16x32_bf16 v[232:235], v[96:99], v[48:51], v[232:235]
    v_mfma_f32_16x16x32_bf16 v[236:239], v[96:99], v[52:55], v[236:239]
    s_waitcnt lgkmcnt(0)
    s_cbranch_scc1 L_cloop_126
    s_memrealtime s[96:97]
    v_and_b32 v31, 15, v1
    s_lshl_b32 s3, s44, 9
    s_add_u32 s3, s3, 137216
    v_lshl_add_u32 v31, v31, 3, s3
    ds_read_b64 v[40:41], v31 offset:0
    ds_read_b64 v[42:43], v31 offset:128
    ds_read_b64 v[44:45], v31 offset:256
    ds_read_b64 v[46:47], v31 offset:384
    v_lshrrev_b32 v32, 4, v1
    v_lshlrev_b32 v3, 4, v32
    v_add_u32 v3, 136192, v3
    s_mul_i32 s3, s45, 640
    v_add_u32 v31, s3, v3
    ds_read_b128 v[4:7], v31 offset:0
    ds_read_b128 v[12:15], v31 offset:2048
    ds_read_b128 v[8:11], v31 offset:64
    ds_read_b128 v[16:19], v31 offset:2112
    v_mfma_f32_16x16x32_bf16 v[128:131], v[100:103], v[56:59], v[128:131]
    v_mfma_f32_16x16x32_bf16 v[144:147], v[104:107], v[56:59], v[144:147]
    s_mul_i32 s3, s45, 640
    v_add_u32 v31, s3, v3
    ds_read_b128 v[20:23], v31 offset:128
    v_mfma_f32_16x16x32_bf16 v[132:135], v[100:103], v[60:63], v[132:135]
    ds_read_b128 v[88:91], v31 offset:2176
    ds_read_b128 v[24:27], v31 offset:192
    v_mfma_f32_16x16x32_bf16 v[148:151], v[104:107], v[60:63], v[148:151]
    ds_read_b128 v[92:95], v31 offset:2240
    v_lshlrev_b32 v2, 4, v1
    v_mfma_f32_16x16x32_bf16 v[136:139], v[100:103], v[64:67], v[136:139]
    s_mov_b32 s52, 0x332ba7e2
    s_mov_b32 s53, 0xb623f428
    s_mov_b32 s56, 0x38866fff
    s_mov_b32 s57, 0xba7cd7e8
    s_mov_b32 s40, 0x3c1b17b1
    s_mov_b32 s41, 0xbd8713de
    s_mov_b32 s98, 0x3ecc1bad
    s_mov_b32 s99, 0x3f000000
    s_barrier
    s_lshr_b32 s3, s28, 3
    s_xor_b32 s3, s3, s28
    s_and_b32 s50, s28, 7
    s_lshl_b32 s50, s50, 8
    s_and_b32 s3, s3, 1
    s_add_u32 s50, s50, s3
    v_readlane_b32 s3, v255, 20
    s_lshl_b32 s50, s50, 13
    s_nop 0
    s_xor_b32 s50, s50, s3
    s_mul_i32 s3, s29, 114688
    s_add_u32 s50, s50, s3
    s_lshl_b32 s3, s44, 12
    s_add_u32 s50, s50, s3
    s_lshr_b32 s92, s29, 3
    s_and_b32 s93, s29, 7
    s_lshl_b32 s46, s92, 11
    s_add_u32 s54, s3, s46
    s_xor_b32 s55, s54, 2048
    s_lshl_b32 s100, s28, 4
    s_add_u32 s100, s100, s29
    s_lshl_b32 s100, s100, 2
    s_add_u32 s100, s100, s30
    s_lshl_b32 s100, s100, 7
    s_lshr_b32 s46, s100, 3
    s_xor_b32 s46, s46, s100
    s_bfe_u32 s46, s46, 0x1000d
    s_mul_i32 s46, s46, 73728
    s_xor_b32 s100, s100, s46
    v_readlane_b32 s46, v255, 20
    v_mfma_f32_16x16x32_bf16 v[152:155], v[104:107], v[64:67], v[152:155]
    s_xor_b32 s100, s100, 0x2000
    s_nop 0
    s_xor_b32 s100, s100, s46
    v_and_b32 v30, 1, v32
    v_lshlrev_b32 v30, 10, v30
    v_mfma_f32_16x16x32_bf16 v[140:143], v[100:103], v[68:71], v[140:143]
    v_lshrrev_b32 v32, 1, v32
    v_lshl_add_u32 v30, v32, 8, v30
    v_mfma_f32_16x16x32_bf16 v[156:159], v[104:107], v[68:71], v[156:159]
    v_and_b32 v32, 15, v1
    v_lshl_add_u32 v30, v32, 4, v30
    v_mfma_f32_16x16x32_bf16 v[160:163], v[108:111], v[56:59], v[160:163]
    s_waitcnt lgkmcnt(0)
    s_mul_i32 s51, s45, 81920
    s_add_u32 s51, s51, 0
    s_lshl_b32 s3, s45, 13
    s_add_u32 s3, s3, 32768
    s_add_u32 s51, s51, s50
    s_add_u32 s46, s3, s54
    s_add_u32 s47, s3, s55
    v_add_u32 v28, s46, v2
    v_add_u32 v29, s47, v2
    v_mfma_f32_16x16x32_bf16 v[176:179], v[112:115], v[56:59], v[176:179]
    v_mfma_f32_16x16x32_bf16 v[164:167], v[108:111], v[60:63], v[164:167]
    v_mfma_f32_16x16x32_bf16 v[180:183], v[112:115], v[60:63], v[180:183]
    v_mfma_f32_16x16x32_bf16 v[168:171], v[108:111], v[64:67], v[168:171]
    v_mfma_f32_16x16x32_bf16 v[184:187], v[112:115], v[64:67], v[184:187]
    v_mfma_f32_16x16x32_bf16 v[172:175], v[108:111], v[68:71], v[172:175]
    v_mfma_f32_16x16x32_bf16 v[188:191], v[112:115], v[68:71], v[188:191]
    v_mfma_f32_16x16x32_bf16 v[192:195], v[116:119], v[56:59], v[192:195]
    v_mfma_f32_16x16x32_bf16 v[208:211], v[120:123], v[56:59], v[208:211]
    v_mfma_f32_16x16x32_bf16 v[196:199], v[116:119], v[60:63], v[196:199]
    v_mfma_f32_16x16x32_bf16 v[212:215], v[120:123], v[60:63], v[212:215]
    v_mfma_f32_16x16x32_bf16 v[200:203], v[116:119], v[64:67], v[200:203]
    v_mfma_f32_16x16x32_bf16 v[216:219], v[120:123], v[64:67], v[216:219]
    v_mfma_f32_16x16x32_bf16 v[204:207], v[116:119], v[68:71], v[204:207]
    v_mfma_f32_16x16x32_bf16 v[220:223], v[120:123], v[68:71], v[220:223]
    v_mfma_f32_16x16x32_bf16 v[224:227], v[124:127], v[56:59], v[224:227]
    v_mfma_f32_16x16x32_bf16 v[228:231], v[124:127], v[60:63], v[228:231]
    v_mfma_f32_16x16x32_bf16 v[232:235], v[124:127], v[64:67], v[232:235]
    v_mfma_f32_16x16x32_bf16 v[236:239], v[124:127], v[68:71], v[236:239]
    s_nop 7
    v_pk_fma_f32 v[72:73], v[4:5], v[40:41], v[12:13] op_sel:[0,1,0] op_sel_hi:[1,1,1]
    v_pk_fma_f32 v[74:75], v[6:7], v[40:41], v[14:15] op_sel:[0,1,0] op_sel_hi:[1,1,1]
    v_pk_fma_f32 v[76:77], v[8:9], v[40:41], v[16:17] op_sel:[0,1,0] op_sel_hi:[1,1,1]
    v_pk_fma_f32 v[78:79], v[10:11], v[40:41], v[18:19] op_sel:[0,1,0] op_sel_hi:[1,1,1]
    v_pk_fma_f32 v[128:129], v[128:129], v[40:41], v[72:73] op_sel:[0,0,0] op_sel_hi:[1,0,1]
    v_pk_fma_f32 v[130:131], v[130:131], v[40:41], v[74:75] op_sel:[0,0,0] op_sel_hi:[1,0,1]
    v_pk_fma_f32 v[144:145], v[144:145], v[40:41], v[76:77] op_sel:[0,0,0] op_sel_hi:[1,0,1]
    v_pk_fma_f32 v[146:147], v[146:147], v[40:41], v[78:79] op_sel:[0,0,0] op_sel_hi:[1,0,1]
    v_pk_mul_f32 v[80:81], v[128:129], v[128:129]
    v_pk_mul_f32 v[82:83], v[130:131], v[130:131]
    v_pk_mul_f32 v[84:85], v[144:145], v[144:145]
    v_pk_mul_f32 v[86:87], v[146:147], v[146:147]
    v_pk_fma_f32 v[72:73], v[80:81], s[52:53], s[52:53] op_sel:[0,0,1] op_sel_hi:[1,0,1]
    v_pk_fma_f32 v[74:75], v[82:83], s[52:53], s[52:53] op_sel:[0,0,1] op_sel_hi:[1,0,1]
    v_pk_fma_f32 v[76:77], v[84:85], s[52:53], s[52:53] op_sel:[0,0,1] op_sel_hi:[1,0,1]
    v_pk_fma_f32 v[78:79], v[86:87], s[52:53], s[52:53] op_sel:[0,0,1] op_sel_hi:[1,0,1]
    v_pk_fma_f32 v[72:73], v[72:73], v[80:81], s[56:57] op_sel:[0,0,0] op_sel_hi:[1,1,0]
    v_pk_fma_f32 v[74:75], v[74:75], v[82:83], s[56:57] op_sel:[0,0,0] op_sel_hi:[1,1,0]
    v_pk_fma_f32 v[76:77], v[76:77], v[84:85], s[56:57] op_sel:[0,0,0] op_sel_hi:[1,1,0]
    v_pk_fma_f32 v[78:79], v[78:79], v[86:87], s[56:57] op_sel:[0,0,0] op_sel_hi:[1,1,0]
    v_pk_fma_f32 v[72:73], v[72:73], v[80:81], s[56:57] op_sel:[0,0,1] op_sel_hi:[1,1,1]
    v_pk_fma_f32 v[74:75], v[74:75], v[82:83], s[56:57] op_sel:[0,0,1] op_sel_hi:[1,1,1]
    v_pk_fma_f32 v[76:77], v[76:77], v[84:85], s[56:57] op_sel:[0,0,1] op_sel_hi:[1,1,1]
    v_pk_fma_f32 v[78:79], v[78:79], v[86:87], s[56:57] op_sel:[0,0,1] op_sel_hi:[1,1,1]
    v_pk_fma_f32 v[72:73], v[72:73], v[80:81], s[40:41] op_sel:[0,0,0] op_sel_hi:[1,1,0]
    v_pk_fma_f32 v[74:75], v[74:75], v[82:83], s[40:41] op_sel:[0,0,0] op_sel_hi:[1,1,0]
    v_pk_fma_f32 v[76:77], v[76:77], v[84:85], s[40:41] op_sel:[0,0,0] op_sel_hi:[1,1,0]
    v_pk_fma_f32 v[78:79], v[78:79], v[86:87], s[40:41] op_sel:[0,0,0] op_sel_hi:[1,1,0]
    v_pk_fma_f32 v[72:73], v[72:73], v[80:81], s[40:41] op_sel:[0,0,1] op_sel_hi:[1,1,1]
    v_pk_fma_f32 v[74:75], v[74:75], v[82:83], s[40:41] op_sel:[0,0,1] op_sel_hi:[1,1,1]
    v_pk_fma_f32 v[76:77], v[76:77], v[84:85], s[40:41] op_sel:[0,0,1] op_sel_hi:[1,1,1]
    v_pk_fma_f32 v[78:79], v[78:79], v[86:87], s[40:41] op_sel:[0,0,1] op_sel_hi:[1,1,1]
    v_pk_fma_f32 v[72:73], v[72:73], v[80:81], s[98:99] op_sel:[0,0,0] op_sel_hi:[1,1,0]
    v_pk_fma_f32 v[74:75], v[74:75], v[82:83], s[98:99] op_sel:[0,0,0] op_sel_hi:[1,1,0]
    v_pk_fma_f32 v[76:77], v[76:77], v[84:85], s[98:99] op_sel:[0,0,0] op_sel_hi:[1,1,0]
    v_pk_fma_f32 v[78:79], v[78:79], v[86:87], s[98:99] op_sel:[0,0,0] op_sel_hi:[1,1,0]
    v_pk_fma_f32 v[72:73], v[72:73], v[128:129], s[98:99] op_sel:[0,0,1] op_sel_hi:[1,1,1] clamp
    v_pk_fma_f32 v[74:75], v[74:75], v[130:131], s[98:99] op_sel:[0,0,1] op_sel_hi:[1,1,1] clamp
    v_pk_fma_f32 v[76:77], v[76:77], v[144:145], s[98:99] op_sel:[0,0,1] op_sel_hi:[1,1,1] clamp
    v_pk_fma_f32 v[78:79], v[78:79], v[146:147], s[98:99] op_sel:[0,0,1] op_sel_hi:[1,1,1] clamp
    v_pk_mul_f32 v[128:129], v[128:129], v[72:73]
    v_pk_mul_f32 v[130:131], v[130:131], v[74:75]
    v_pk_mul_f32 v[144:145], v[144:145], v[76:77]
    v_pk_mul_f32 v[146:147], v[146:147], v[78:79]
    v_cvt_pk_bf16_f32 v128, v128, v129
    v_cvt_pk_bf16_f32 v129, v130, v131
    v_cvt_pk_bf16_f32 v130, v144, v145
    v_cvt_pk_bf16_f32 v131, v146, v147
    buffer_store_dwordx4 v[128:131], v2, s[12:15], s51 offen offset:0 sc0 sc1
    ds_write_b128 v28, v[128:131] offset:0
    v_pk_fma_f32 v[72:73], v[4:5], v[42:43], v[12:13] op_sel:[0,1,0] op_sel_hi:[1,1,1]
    v_pk_fma_f32 v[74:75], v[6:7], v[42:43], v[14:15] op_sel:[0,1,0] op_sel_hi:[1,1,1]
    v_pk_fma_f32 v[76:77], v[8:9], v[42:43], v[16:17] op_sel:[0,1,0] op_sel_hi:[1,1,1]
    v_pk_fma_f32 v[78:79], v[10:11], v[42:43], v[18:19] op_sel:[0,1,0] op_sel_hi:[1,1,1]
    v_pk_fma_f32 v[132:133], v[132:133], v[42:43], v[72:73] op_sel:[0,0,0] op_sel_hi:[1,0,1]
    v_pk_fma_f32 v[134:135], v[134:135], v[42:43], v[74:75] op_sel:[0,0,0] op_sel_hi:[1,0,1]
    v_pk_fma_f32 v[148:149], v[148:149], v[42:43], v[76:77] op_sel:[0,0,0] op_sel_hi:[1,0,1]
    v_pk_fma_f32 v[150:151], v[150:151], v[42:43], v[78:79] op_sel:[0,0,0] op_sel_hi:[1,0,1]
    v_pk_mul_f32 v[80:81], v[132:133], v[132:133]
    v_pk_mul_f32 v[82:83], v[134:135], v[134:135]
    v_pk_mul_f32 v[84:85], v[148:149], v[148:149]
    v_pk_mul_f32 v[86:87], v[150:151], v[150:151]
    v_pk_fma_f32 v[72:73], v[80:81], s[52:53], s[52:53] op_sel:[0,0,1] op_sel_hi:[1,0,1]
    v_pk_fma_f32 v[74:75], v[82:83], s[52:53], s[52:53] op_sel:[0,0,1] op_sel_hi:[1,0,1]
    v_pk_fma_f32 v[76:77], v[84:85], s[52:53], s[52:53] op_sel:[0,0,1] op_sel_hi:[1,0,1]
    v_pk_fma_f32 v[78:79], v[86:87], s[52:53], s[52:53] op_sel:[0,0,1] op_sel_hi:[1,0,1]
    v_pk_fma_f32 v[72:73], v[72:73], v[80:81], s[56:57] op_sel:[0,0,0] op_sel_hi:[1,1,0]
    v_pk_fma_f32 v[74:75], v[74:75], v[82:83], s[56:57] op_sel:[0,0,0] op_sel_hi:[1,1,0]
    v_pk_fma_f32 v[76:77], v[76:77], v[84:85], s[56:57] op_sel:[0,0,0] op_sel_hi:[1,1,0]
    v_pk_fma_f32 v[78:79], v[78:79], v[86:87], s[56:57] op_sel:[0,0,0] op_sel_hi:[1,1,0]
    v_pk_fma_f32 v[72:73], v[72:73], v[80:81], s[56:57] op_sel:[0,0,1] op_sel_hi:[1,1,1]
    v_pk_fma_f32 v[74:75], v[74:75], v[82:83], s[56:57] op_sel:[0,0,1] op_sel_hi:[1,1,1]
    v_pk_fma_f32 v[76:77], v[76:77], v[84:85], s[56:57] op_sel:[0,0,1] op_sel_hi:[1,1,1]
    v_pk_fma_f32 v[78:79], v[78:79], v[86:87], s[56:57] op_sel:[0,0,1] op_sel_hi:[1,1,1]
    v_pk_fma_f32 v[72:73], v[72:73], v[80:81], s[40:41] op_sel:[0,0,0] op_sel_hi:[1,1,0]
    v_pk_fma_f32 v[74:75], v[74:75], v[82:83], s[40:41] op_sel:[0,0,0] op_sel_hi:[1,1,0]
    v_pk_fma_f32 v[76:77], v[76:77], v[84:85], s[40:41] op_sel:[0,0,0] op_sel_hi:[1,1,0]
    v_pk_fma_f32 v[78:79], v[78:79], v[86:87], s[40:41] op_sel:[0,0,0] op_sel_hi:[1,1,0]
    v_pk_fma_f32 v[72:73], v[72:73], v[80:81], s[40:41] op_sel:[0,0,1] op_sel_hi:[1,1,1]
    v_pk_fma_f32 v[74:75], v[74:75], v[82:83], s[40:41] op_sel:[0,0,1] op_sel_hi:[1,1,1]
    v_pk_fma_f32 v[76:77], v[76:77], v[84:85], s[40:41] op_sel:[0,0,1] op_sel_hi:[1,1,1]
    v_pk_fma_f32 v[78:79], v[78:79], v[86:87], s[40:41] op_sel:[0,0,1] op_sel_hi:[1,1,1]
    v_pk_fma_f32 v[72:73], v[72:73], v[80:81], s[98:99] op_sel:[0,0,0] op_sel_hi:[1,1,0]
    v_pk_fma_f32 v[74:75], v[74:75], v[82:83], s[98:99] op_sel:[0,0,0] op_sel_hi:[1,1,0]
    v_pk_fma_f32 v[76:77], v[76:77], v[84:85], s[98:99] op_sel:[0,0,0] op_sel_hi:[1,1,0]
    v_pk_fma_f32 v[78:79], v[78:79], v[86:87], s[98:99] op_sel:[0,0,0] op_sel_hi:[1,1,0]
    v_pk_fma_f32 v[72:73], v[72:73], v[132:133], s[98:99] op_sel:[0,0,1] op_sel_hi:[1,1,1] clamp
    v_pk_fma_f32 v[74:75], v[74:75], v[134:135], s[98:99] op_sel:[0,0,1] op_sel_hi:[1,1,1] clamp
    v_pk_fma_f32 v[76:77], v[76:77], v[148:149], s[98:99] op_sel:[0,0,1] op_sel_hi:[1,1,1] clamp
    v_pk_fma_f32 v[78:79], v[78:79], v[150:151], s[98:99] op_sel:[0,0,1] op_sel_hi:[1,1,1] clamp
    v_pk_mul_f32 v[132:133], v[132:133], v[72:73]
    v_pk_mul_f32 v[134:135], v[134:135], v[74:75]
    v_pk_mul_f32 v[148:149], v[148:149], v[76:77]
    v_pk_mul_f32 v[150:151], v[150:151], v[78:79]
    v_cvt_pk_bf16_f32 v132, v132, v133
    v_cvt_pk_bf16_f32 v133, v134, v135
    v_cvt_pk_bf16_f32 v134, v148, v149
    v_cvt_pk_bf16_f32 v135, v150, v151
    buffer_store_dwordx4 v[132:135], v2, s[12:15], s51 offen offset:1024 sc0 sc1
    ds_write_b128 v28, v[132:135] offset:1024
    s_mov_b32 s16, s36
    s_mov_b32 s17, s37
    s_and_b32 s17, s17, 0xffff
    s_mov_b32 s18, 2048
    s_mov_b32 s19, 0x00020000
    v_and_b32 v31, 15, v1
    v_lshrrev_b32 v32, 4, v1
    v_lshlrev_b32 v32, 3, v32
    v_lshlrev_b32 v31, 4, v1
    s_lshl_b32 s3, s28, 18
    s_lshl_b32 s46, s93, 15
    s_add_u32 s3, s3, s46
    s_lshl_b32 s46, s45, 14
    s_add_u32 s3, s3, s46
    s_lshl_b32 s46, s44, 12
    s_add_u32 s3, s3, s46
    s_lshl_b32 s46, s92, 11
    s_add_u32 s3, s3, s46
    s_lshr_b32 s46, s3, 8
    s_xor_b32 s46, s46, s3
    s_bfe_u32 s46, s46, 0x1000d
    s_mul_i32 s46, s46, 2105344
    s_xor_b32 s3, s3, s46
    s_lshr_b32 s46, s3, 8
    s_and_b32 s46, s46, 0x2000
    s_xor_b32 s3, s3, s46
    v_readlane_b32 s46, v255, 20
    s_nop 0
    s_xor_b32 s3, s3, s46
    s_xor_b32 s46, s3, 0x202000
    buffer_load_dwordx4 v[56:59], v31, s[4:7], s3 offen offset:0
    buffer_load_dwordx4 v[60:63], v31, s[4:7], s3 offen offset:1024
    buffer_load_dwordx4 v[64:67], v31, s[4:7], s46 offen offset:0
    buffer_load_dwordx4 v[68:71], v31, s[4:7], s46 offen offset:1024
    s_lshl_b32 s3, s93, 8
    s_lshl_b32 s46, s45, 7
    s_add_u32 s3, s3, s46
    s_nop 0
    buffer_load_dwordx2 v[100:101], v32, s[16:19], s3 offen offset:0
    buffer_load_dwordx2 v[102:103], v32, s[16:19], s3 offen offset:32
    buffer_load_dwordx2 v[104:105], v32, s[16:19], s3 offen offset:64
    buffer_load_dwordx2 v[106:107], v32, s[16:19], s3 offen offset:96
    v_pk_fma_f32 v[72:73], v[4:5], v[44:45], v[12:13] op_sel:[0,1,0] op_sel_hi:[1,1,1]
    v_pk_fma_f32 v[74:75], v[6:7], v[44:45], v[14:15] op_sel:[0,1,0] op_sel_hi:[1,1,1]
    v_pk_fma_f32 v[76:77], v[8:9], v[44:45], v[16:17] op_sel:[0,1,0] op_sel_hi:[1,1,1]
    v_pk_fma_f32 v[78:79], v[10:11], v[44:45], v[18:19] op_sel:[0,1,0] op_sel_hi:[1,1,1]
    v_pk_fma_f32 v[136:137], v[136:137], v[44:45], v[72:73] op_sel:[0,0,0] op_sel_hi:[1,0,1]
    v_pk_fma_f32 v[138:139], v[138:139], v[44:45], v[74:75] op_sel:[0,0,0] op_sel_hi:[1,0,1]
    v_pk_fma_f32 v[152:153], v[152:153], v[44:45], v[76:77] op_sel:[0,0,0] op_sel_hi:[1,0,1]
    v_pk_fma_f32 v[154:155], v[154:155], v[44:45], v[78:79] op_sel:[0,0,0] op_sel_hi:[1,0,1]
    v_pk_mul_f32 v[80:81], v[136:137], v[136:137]
    v_pk_mul_f32 v[82:83], v[138:139], v[138:139]
    v_pk_mul_f32 v[84:85], v[152:153], v[152:153]
    v_pk_mul_f32 v[86:87], v[154:155], v[154:155]
    v_pk_fma_f32 v[72:73], v[80:81], s[52:53], s[52:53] op_sel:[0,0,1] op_sel_hi:[1,0,1]
    v_pk_fma_f32 v[74:75], v[82:83], s[52:53], s[52:53] op_sel:[0,0,1] op_sel_hi:[1,0,1]
    v_pk_fma_f32 v[76:77], v[84:85], s[52:53], s[52:53] op_sel:[0,0,1] op_sel_hi:[1,0,1]
    v_pk_fma_f32 v[78:79], v[86:87], s[52:53], s[52:53] op_sel:[0,0,1] op_sel_hi:[1,0,1]
    v_pk_fma_f32 v[72:73], v[72:73], v[80:81], s[56:57] op_sel:[0,0,0] op_sel_hi:[1,1,0]
    v_pk_fma_f32 v[74:75], v[74:75], v[82:83], s[56:57] op_sel:[0,0,0] op_sel_hi:[1,1,0]
    v_pk_fma_f32 v[76:77], v[76:77], v[84:85], s[56:57] op_sel:[0,0,0] op_sel_hi:[1,1,0]
    v_pk_fma_f32 v[78:79], v[78:79], v[86:87], s[56:57] op_sel:[0,0,0] op_sel_hi:[1,1,0]
    v_pk_fma_f32 v[72:73], v[72:73], v[80:81], s[56:57] op_sel:[0,0,1] op_sel_hi:[1,1,1]
    v_pk_fma_f32 v[74:75], v[74:75], v[82:83], s[56:57] op_sel:[0,0,1] op_sel_hi:[1,1,1]
    v_pk_fma_f32 v[76:77], v[76:77], v[84:85], s[56:57] op_sel:[0,0,1] op_sel_hi:[1,1,1]
    v_pk_fma_f32 v[78:79], v[78:79], v[86:87], s[56:57] op_sel:[0,0,1] op_sel_hi:[1,1,1]
    v_pk_fma_f32 v[72:73], v[72:73], v[80:81], s[40:41] op_sel:[0,0,0] op_sel_hi:[1,1,0]
    v_pk_fma_f32 v[74:75], v[74:75], v[82:83], s[40:41] op_sel:[0,0,0] op_sel_hi:[1,1,0]
    v_pk_fma_f32 v[76:77], v[76:77], v[84:85], s[40:41] op_sel:[0,0,0] op_sel_hi:[1,1,0]
    v_pk_fma_f32 v[78:79], v[78:79], v[86:87], s[40:41] op_sel:[0,0,0] op_sel_hi:[1,1,0]
    v_pk_fma_f32 v[72:73], v[72:73], v[80:81], s[40:41] op_sel:[0,0,1] op_sel_hi:[1,1,1]
    v_pk_fma_f32 v[74:75], v[74:75], v[82:83], s[40:41] op_sel:[0,0,1] op_sel_hi:[1,1,1]
    v_pk_fma_f32 v[76:77], v[76:77], v[84:85], s[40:41] op_sel:[0,0,1] op_sel_hi:[1,1,1]
    v_pk_fma_f32 v[78:79], v[78:79], v[86:87], s[40:41] op_sel:[0,0,1] op_sel_hi:[1,1,1]
    v_pk_fma_f32 v[72:73], v[72:73], v[80:81], s[98:99] op_sel:[0,0,0] op_sel_hi:[1,1,0]
    v_pk_fma_f32 v[74:75], v[74:75], v[82:83], s[98:99] op_sel:[0,0,0] op_sel_hi:[1,1,0]
    v_pk_fma_f32 v[76:77], v[76:77], v[84:85], s[98:99] op_sel:[0,0,0] op_sel_hi:[1,1,0]
    v_pk_fma_f32 v[78:79], v[78:79], v[86:87], s[98:99] op_sel:[0,0,0] op_sel_hi:[1,1,0]
    v_pk_fma_f32 v[72:73], v[72:73], v[136:137], s[98:99] op_sel:[0,0,1] op_sel_hi:[1,1,1] clamp
    v_pk_fma_f32 v[74:75], v[74:75], v[138:139], s[98:99] op_sel:[0,0,1] op_sel_hi:[1,1,1] clamp
    v_pk_fma_f32 v[76:77], v[76:77], v[152:153], s[98:99] op_sel:[0,0,1] op_sel_hi:[1,1,1] clamp
    v_pk_fma_f32 v[78:79], v[78:79], v[154:155], s[98:99] op_sel:[0,0,1] op_sel_hi:[1,1,1] clamp
    v_pk_mul_f32 v[136:137], v[136:137], v[72:73]
    v_pk_mul_f32 v[138:139], v[138:139], v[74:75]
    v_pk_mul_f32 v[152:153], v[152:153], v[76:77]
    v_pk_mul_f32 v[154:155], v[154:155], v[78:79]
    v_cvt_pk_bf16_f32 v136, v136, v137
    v_cvt_pk_bf16_f32 v137, v138, v139
    v_cvt_pk_bf16_f32 v138, v152, v153
    v_cvt_pk_bf16_f32 v139, v154, v155
    buffer_store_dwordx4 v[136:139], v2, s[12:15], s51 offen offset:2048 sc0 sc1
    ds_write_b128 v29, v[136:139] offset:0
    v_pk_fma_f32 v[72:73], v[4:5], v[46:47], v[12:13] op_sel:[0,1,0] op_sel_hi:[1,1,1]
    v_pk_fma_f32 v[74:75], v[6:7], v[46:47], v[14:15] op_sel:[0,1,0] op_sel_hi:[1,1,1]
    v_pk_fma_f32 v[76:77], v[8:9], v[46:47], v[16:17] op_sel:[0,1,0] op_sel_hi:[1,1,1]
    v_pk_fma_f32 v[78:79], v[10:11], v[46:47], v[18:19] op_sel:[0,1,0] op_sel_hi:[1,1,1]
    v_pk_fma_f32 v[140:141], v[140:141], v[46:47], v[72:73] op_sel:[0,0,0] op_sel_hi:[1,0,1]
    v_pk_fma_f32 v[142:143], v[142:143], v[46:47], v[74:75] op_sel:[0,0,0] op_sel_hi:[1,0,1]
    v_pk_fma_f32 v[156:157], v[156:157], v[46:47], v[76:77] op_sel:[0,0,0] op_sel_hi:[1,0,1]
    v_pk_fma_f32 v[158:159], v[158:159], v[46:47], v[78:79] op_sel:[0,0,0] op_sel_hi:[1,0,1]
    v_pk_mul_f32 v[80:81], v[140:141], v[140:141]
    v_pk_mul_f32 v[82:83], v[142:143], v[142:143]
    v_pk_mul_f32 v[84:85], v[156:157], v[156:157]
    v_pk_mul_f32 v[86:87], v[158:159], v[158:159]
    v_pk_fma_f32 v[72:73], v[80:81], s[52:53], s[52:53] op_sel:[0,0,1] op_sel_hi:[1,0,1]
    v_pk_fma_f32 v[74:75], v[82:83], s[52:53], s[52:53] op_sel:[0,0,1] op_sel_hi:[1,0,1]
    v_pk_fma_f32 v[76:77], v[84:85], s[52:53], s[52:53] op_sel:[0,0,1] op_sel_hi:[1,0,1]
    v_pk_fma_f32 v[78:79], v[86:87], s[52:53], s[52:53] op_sel:[0,0,1] op_sel_hi:[1,0,1]
    v_pk_fma_f32 v[72:73], v[72:73], v[80:81], s[56:57] op_sel:[0,0,0] op_sel_hi:[1,1,0]
    v_pk_fma_f32 v[74:75], v[74:75], v[82:83], s[56:57] op_sel:[0,0,0] op_sel_hi:[1,1,0]
    v_pk_fma_f32 v[76:77], v[76:77], v[84:85], s[56:57] op_sel:[0,0,0] op_sel_hi:[1,1,0]
    v_pk_fma_f32 v[78:79], v[78:79], v[86:87], s[56:57] op_sel:[0,0,0] op_sel_hi:[1,1,0]
    v_pk_fma_f32 v[72:73], v[72:73], v[80:81], s[56:57] op_sel:[0,0,1] op_sel_hi:[1,1,1]
    v_pk_fma_f32 v[74:75], v[74:75], v[82:83], s[56:57] op_sel:[0,0,1] op_sel_hi:[1,1,1]
    v_pk_fma_f32 v[76:77], v[76:77], v[84:85], s[56:57] op_sel:[0,0,1] op_sel_hi:[1,1,1]
    v_pk_fma_f32 v[78:79], v[78:79], v[86:87], s[56:57] op_sel:[0,0,1] op_sel_hi:[1,1,1]
    v_pk_fma_f32 v[72:73], v[72:73], v[80:81], s[40:41] op_sel:[0,0,0] op_sel_hi:[1,1,0]
    v_pk_fma_f32 v[74:75], v[74:75], v[82:83], s[40:41] op_sel:[0,0,0] op_sel_hi:[1,1,0]
    v_pk_fma_f32 v[76:77], v[76:77], v[84:85], s[40:41] op_sel:[0,0,0] op_sel_hi:[1,1,0]
    v_pk_fma_f32 v[78:79], v[78:79], v[86:87], s[40:41] op_sel:[0,0,0] op_sel_hi:[1,1,0]
    v_pk_fma_f32 v[72:73], v[72:73], v[80:81], s[40:41] op_sel:[0,0,1] op_sel_hi:[1,1,1]
    v_pk_fma_f32 v[74:75], v[74:75], v[82:83], s[40:41] op_sel:[0,0,1] op_sel_hi:[1,1,1]
    v_pk_fma_f32 v[76:77], v[76:77], v[84:85], s[40:41] op_sel:[0,0,1] op_sel_hi:[1,1,1]
    v_pk_fma_f32 v[78:79], v[78:79], v[86:87], s[40:41] op_sel:[0,0,1] op_sel_hi:[1,1,1]
    v_pk_fma_f32 v[72:73], v[72:73], v[80:81], s[98:99] op_sel:[0,0,0] op_sel_hi:[1,1,0]
    v_pk_fma_f32 v[74:75], v[74:75], v[82:83], s[98:99] op_sel:[0,0,0] op_sel_hi:[1,1,0]
    v_pk_fma_f32 v[76:77], v[76:77], v[84:85], s[98:99] op_sel:[0,0,0] op_sel_hi:[1,1,0]
    v_pk_fma_f32 v[78:79], v[78:79], v[86:87], s[98:99] op_sel:[0,0,0] op_sel_hi:[1,1,0]
    v_pk_fma_f32 v[72:73], v[72:73], v[140:141], s[98:99] op_sel:[0,0,1] op_sel_hi:[1,1,1] clamp
    v_pk_fma_f32 v[74:75], v[74:75], v[142:143], s[98:99] op_sel:[0,0,1] op_sel_hi:[1,1,1] clamp
    v_pk_fma_f32 v[76:77], v[76:77], v[156:157], s[98:99] op_sel:[0,0,1] op_sel_hi:[1,1,1] clamp
    v_pk_fma_f32 v[78:79], v[78:79], v[158:159], s[98:99] op_sel:[0,0,1] op_sel_hi:[1,1,1] clamp
    v_pk_mul_f32 v[140:141], v[140:141], v[72:73]
    v_pk_mul_f32 v[142:143], v[142:143], v[74:75]
    v_pk_mul_f32 v[156:157], v[156:157], v[76:77]
    v_pk_mul_f32 v[158:159], v[158:159], v[78:79]
    v_cvt_pk_bf16_f32 v140, v140, v141
    v_cvt_pk_bf16_f32 v141, v142, v143
    v_cvt_pk_bf16_f32 v142, v156, v157
    v_cvt_pk_bf16_f32 v143, v158, v159
    buffer_store_dwordx4 v[140:143], v2, s[12:15], s51 offen offset:3072 sc0 sc1
    ds_write_b128 v29, v[140:143] offset:1024
    s_mul_i32 s3, s45, 256
    v_add_u32 v31, s3, v3
    ds_read_b128 v[4:7], v31 offset:256
    ds_read_b128 v[12:15], v31 offset:2304
    ds_read_b128 v[8:11], v31 offset:320
    ds_read_b128 v[16:19], v31 offset:2368
    s_mul_i32 s51, s45, 81920
    s_add_u32 s51, s51, 16384
    s_lshl_b32 s3, s45, 13
    s_add_u32 s3, s3, 65536
    s_add_u32 s51, s51, s50
    s_add_u32 s46, s3, s54
    s_add_u32 s47, s3, s55
    v_add_u32 v28, s46, v2
    v_add_u32 v29, s47, v2
    s_waitcnt lgkmcnt(0)
    v_mov_b32 v246, s96
    v_mov_b32 v247, s97
    v_mov_b32 v248, s96
    v_mov_b32 v249, s97
    v_pk_fma_f32 v[72:73], v[20:21], v[40:41], v[88:89] op_sel:[0,1,0] op_sel_hi:[1,1,1]
    v_pk_fma_f32 v[74:75], v[22:23], v[40:41], v[90:91] op_sel:[0,1,0] op_sel_hi:[1,1,1]
    v_pk_fma_f32 v[76:77], v[24:25], v[40:41], v[92:93] op_sel:[0,1,0] op_sel_hi:[1,1,1]
    v_pk_fma_f32 v[78:79], v[26:27], v[40:41], v[94:95] op_sel:[0,1,0] op_sel_hi:[1,1,1]
    v_pk_fma_f32 v[160:161], v[160:161], v[40:41], v[72:73] op_sel:[0,0,0] op_sel_hi:[1,0,1]
    v_pk_fma_f32 v[162:163], v[162:163], v[40:41], v[74:75] op_sel:[0,0,0] op_sel_hi:[1,0,1]
    v_pk_fma_f32 v[176:177], v[176:177], v[40:41], v[76:77] op_sel:[0,0,0] op_sel_hi:[1,0,1]
    v_pk_fma_f32 v[178:179], v[178:179], v[40:41], v[78:79] op_sel:[0,0,0] op_sel_hi:[1,0,1]
    v_pk_mul_f32 v[80:81], v[160:161], v[160:161]
    v_pk_mul_f32 v[82:83], v[162:163], v[162:163]
    v_pk_mul_f32 v[84:85], v[176:177], v[176:177]
    v_pk_mul_f32 v[86:87], v[178:179], v[178:179]
    v_pk_fma_f32 v[72:73], v[80:81], s[52:53], s[52:53] op_sel:[0,0,1] op_sel_hi:[1,0,1]
    v_pk_fma_f32 v[74:75], v[82:83], s[52:53], s[52:53] op_sel:[0,0,1] op_sel_hi:[1,0,1]
    v_pk_fma_f32 v[76:77], v[84:85], s[52:53], s[52:53] op_sel:[0,0,1] op_sel_hi:[1,0,1]
    v_pk_fma_f32 v[78:79], v[86:87], s[52:53], s[52:53] op_sel:[0,0,1] op_sel_hi:[1,0,1]
    v_pk_fma_f32 v[72:73], v[72:73], v[80:81], s[56:57] op_sel:[0,0,0] op_sel_hi:[1,1,0]
    v_pk_fma_f32 v[74:75], v[74:75], v[82:83], s[56:57] op_sel:[0,0,0] op_sel_hi:[1,1,0]
    v_pk_fma_f32 v[76:77], v[76:77], v[84:85], s[56:57] op_sel:[0,0,0] op_sel_hi:[1,1,0]
    v_pk_fma_f32 v[78:79], v[78:79], v[86:87], s[56:57] op_sel:[0,0,0] op_sel_hi:[1,1,0]
    v_pk_fma_f32 v[72:73], v[72:73], v[80:81], s[56:57] op_sel:[0,0,1] op_sel_hi:[1,1,1]
    v_pk_fma_f32 v[74:75], v[74:75], v[82:83], s[56:57] op_sel:[0,0,1] op_sel_hi:[1,1,1]
    v_pk_fma_f32 v[76:77], v[76:77], v[84:85], s[56:57] op_sel:[0,0,1] op_sel_hi:[1,1,1]
    v_pk_fma_f32 v[78:79], v[78:79], v[86:87], s[56:57] op_sel:[0,0,1] op_sel_hi:[1,1,1]
    v_pk_fma_f32 v[72:73], v[72:73], v[80:81], s[40:41] op_sel:[0,0,0] op_sel_hi:[1,1,0]
    v_pk_fma_f32 v[74:75], v[74:75], v[82:83], s[40:41] op_sel:[0,0,0] op_sel_hi:[1,1,0]
    v_pk_fma_f32 v[76:77], v[76:77], v[84:85], s[40:41] op_sel:[0,0,0] op_sel_hi:[1,1,0]
    v_pk_fma_f32 v[78:79], v[78:79], v[86:87], s[40:41] op_sel:[0,0,0] op_sel_hi:[1,1,0]
    v_pk_fma_f32 v[72:73], v[72:73], v[80:81], s[40:41] op_sel:[0,0,1] op_sel_hi:[1,1,1]
    v_pk_fma_f32 v[74:75], v[74:75], v[82:83], s[40:41] op_sel:[0,0,1] op_sel_hi:[1,1,1]
    v_pk_fma_f32 v[76:77], v[76:77], v[84:85], s[40:41] op_sel:[0,0,1] op_sel_hi:[1,1,1]
    v_pk_fma_f32 v[78:79], v[78:79], v[86:87], s[40:41] op_sel:[0,0,1] op_sel_hi:[1,1,1]
    v_pk_fma_f32 v[72:73], v[72:73], v[80:81], s[98:99] op_sel:[0,0,0] op_sel_hi:[1,1,0]
    v_pk_fma_f32 v[74:75], v[74:75], v[82:83], s[98:99] op_sel:[0,0,0] op_sel_hi:[1,1,0]
    v_pk_fma_f32 v[76:77], v[76:77], v[84:85], s[98:99] op_sel:[0,0,0] op_sel_hi:[1,1,0]
    v_pk_fma_f32 v[78:79], v[78:79], v[86:87], s[98:99] op_sel:[0,0,0] op_sel_hi:[1,1,0]
    v_pk_fma_f32 v[72:73], v[72:73], v[160:161], s[98:99] op_sel:[0,0,1] op_sel_hi:[1,1,1] clamp
    v_pk_fma_f32 v[74:75], v[74:75], v[162:163], s[98:99] op_sel:[0,0,1] op_sel_hi:[1,1,1] clamp
    v_pk_fma_f32 v[76:77], v[76:77], v[176:177], s[98:99] op_sel:[0,0,1] op_sel_hi:[1,1,1] clamp
    v_pk_fma_f32 v[78:79], v[78:79], v[178:179], s[98:99] op_sel:[0,0,1] op_sel_hi:[1,1,1] clamp
    v_pk_mul_f32 v[160:161], v[160:161], v[72:73]
    v_pk_mul_f32 v[162:163], v[162:163], v[74:75]
    v_pk_mul_f32 v[176:177], v[176:177], v[76:77]
    v_pk_mul_f32 v[178:179], v[178:179], v[78:79]
    v_cvt_pk_bf16_f32 v160, v160, v161
    v_cvt_pk_bf16_f32 v161, v162, v163
    v_cvt_pk_bf16_f32 v162, v176, v177
    v_cvt_pk_bf16_f32 v163, v178, v179
    buffer_store_dwordx4 v[160:163], v2, s[12:15], s51 offen offset:0 sc0 sc1
    ds_write_b128 v28, v[160:163] offset:0
    v_pk_fma_f32 v[72:73], v[20:21], v[42:43], v[88:89] op_sel:[0,1,0] op_sel_hi:[1,1,1]
    v_pk_fma_f32 v[74:75], v[22:23], v[42:43], v[90:91] op_sel:[0,1,0] op_sel_hi:[1,1,1]
    v_pk_fma_f32 v[76:77], v[24:25], v[42:43], v[92:93] op_sel:[0,1,0] op_sel_hi:[1,1,1]
    v_pk_fma_f32 v[78:79], v[26:27], v[42:43], v[94:95] op_sel:[0,1,0] op_sel_hi:[1,1,1]
    v_pk_fma_f32 v[164:165], v[164:165], v[42:43], v[72:73] op_sel:[0,0,0] op_sel_hi:[1,0,1]
    v_pk_fma_f32 v[166:167], v[166:167], v[42:43], v[74:75] op_sel:[0,0,0] op_sel_hi:[1,0,1]
    v_pk_fma_f32 v[180:181], v[180:181], v[42:43], v[76:77] op_sel:[0,0,0] op_sel_hi:[1,0,1]
    v_pk_fma_f32 v[182:183], v[182:183], v[42:43], v[78:79] op_sel:[0,0,0] op_sel_hi:[1,0,1]
    v_pk_mul_f32 v[80:81], v[164:165], v[164:165]
    v_pk_mul_f32 v[82:83], v[166:167], v[166:167]
    v_pk_mul_f32 v[84:85], v[180:181], v[180:181]
    v_pk_mul_f32 v[86:87], v[182:183], v[182:183]
    v_pk_fma_f32 v[72:73], v[80:81], s[52:53], s[52:53] op_sel:[0,0,1] op_sel_hi:[1,0,1]
    v_pk_fma_f32 v[74:75], v[82:83], s[52:53], s[52:53] op_sel:[0,0,1] op_sel_hi:[1,0,1]
    v_pk_fma_f32 v[76:77], v[84:85], s[52:53], s[52:53] op_sel:[0,0,1] op_sel_hi:[1,0,1]
    v_pk_fma_f32 v[78:79], v[86:87], s[52:53], s[52:53] op_sel:[0,0,1] op_sel_hi:[1,0,1]
    v_pk_fma_f32 v[72:73], v[72:73], v[80:81], s[56:57] op_sel:[0,0,0] op_sel_hi:[1,1,0]
    v_pk_fma_f32 v[74:75], v[74:75], v[82:83], s[56:57] op_sel:[0,0,0] op_sel_hi:[1,1,0]
    v_pk_fma_f32 v[76:77], v[76:77], v[84:85], s[56:57] op_sel:[0,0,0] op_sel_hi:[1,1,0]
    v_pk_fma_f32 v[78:79], v[78:79], v[86:87], s[56:57] op_sel:[0,0,0] op_sel_hi:[1,1,0]
    v_pk_fma_f32 v[72:73], v[72:73], v[80:81], s[56:57] op_sel:[0,0,1] op_sel_hi:[1,1,1]
    v_pk_fma_f32 v[74:75], v[74:75], v[82:83], s[56:57] op_sel:[0,0,1] op_sel_hi:[1,1,1]
    v_pk_fma_f32 v[76:77], v[76:77], v[84:85], s[56:57] op_sel:[0,0,1] op_sel_hi:[1,1,1]
    v_pk_fma_f32 v[78:79], v[78:79], v[86:87], s[56:57] op_sel:[0,0,1] op_sel_hi:[1,1,1]
    v_pk_fma_f32 v[72:73], v[72:73], v[80:81], s[40:41] op_sel:[0,0,0] op_sel_hi:[1,1,0]
    v_pk_fma_f32 v[74:75], v[74:75], v[82:83], s[40:41] op_sel:[0,0,0] op_sel_hi:[1,1,0]
    v_pk_fma_f32 v[76:77], v[76:77], v[84:85], s[40:41] op_sel:[0,0,0] op_sel_hi:[1,1,0]
    v_pk_fma_f32 v[78:79], v[78:79], v[86:87], s[40:41] op_sel:[0,0,0] op_sel_hi:[1,1,0]
    v_pk_fma_f32 v[72:73], v[72:73], v[80:81], s[40:41] op_sel:[0,0,1] op_sel_hi:[1,1,1]
    v_pk_fma_f32 v[74:75], v[74:75], v[82:83], s[40:41] op_sel:[0,0,1] op_sel_hi:[1,1,1]
    v_pk_fma_f32 v[76:77], v[76:77], v[84:85], s[40:41] op_sel:[0,0,1] op_sel_hi:[1,1,1]
    v_pk_fma_f32 v[78:79], v[78:79], v[86:87], s[40:41] op_sel:[0,0,1] op_sel_hi:[1,1,1]
    v_pk_fma_f32 v[72:73], v[72:73], v[80:81], s[98:99] op_sel:[0,0,0] op_sel_hi:[1,1,0]
    v_pk_fma_f32 v[74:75], v[74:75], v[82:83], s[98:99] op_sel:[0,0,0] op_sel_hi:[1,1,0]
    v_pk_fma_f32 v[76:77], v[76:77], v[84:85], s[98:99] op_sel:[0,0,0] op_sel_hi:[1,1,0]
    v_pk_fma_f32 v[78:79], v[78:79], v[86:87], s[98:99] op_sel:[0,0,0] op_sel_hi:[1,1,0]
    v_pk_fma_f32 v[72:73], v[72:73], v[164:165], s[98:99] op_sel:[0,0,1] op_sel_hi:[1,1,1] clamp
    v_pk_fma_f32 v[74:75], v[74:75], v[166:167], s[98:99] op_sel:[0,0,1] op_sel_hi:[1,1,1] clamp
    v_pk_fma_f32 v[76:77], v[76:77], v[180:181], s[98:99] op_sel:[0,0,1] op_sel_hi:[1,1,1] clamp
    v_pk_fma_f32 v[78:79], v[78:79], v[182:183], s[98:99] op_sel:[0,0,1] op_sel_hi:[1,1,1] clamp
    v_pk_mul_f32 v[164:165], v[164:165], v[72:73]
    v_pk_mul_f32 v[166:167], v[166:167], v[74:75]
    v_pk_mul_f32 v[180:181], v[180:181], v[76:77]
    v_pk_mul_f32 v[182:183], v[182:183], v[78:79]
    v_cvt_pk_bf16_f32 v164, v164, v165
    v_cvt_pk_bf16_f32 v165, v166, v167
    v_cvt_pk_bf16_f32 v166, v180, v181
    v_cvt_pk_bf16_f32 v167, v182, v183
    buffer_store_dwordx4 v[164:167], v2, s[12:15], s51 offen offset:1024 sc0 sc1
    ds_write_b128 v28, v[164:167] offset:1024
    v_pk_fma_f32 v[72:73], v[20:21], v[44:45], v[88:89] op_sel:[0,1,0] op_sel_hi:[1,1,1]
    v_pk_fma_f32 v[74:75], v[22:23], v[44:45], v[90:91] op_sel:[0,1,0] op_sel_hi:[1,1,1]
    v_pk_fma_f32 v[76:77], v[24:25], v[44:45], v[92:93] op_sel:[0,1,0] op_sel_hi:[1,1,1]
    v_pk_fma_f32 v[78:79], v[26:27], v[44:45], v[94:95] op_sel:[0,1,0] op_sel_hi:[1,1,1]
    v_pk_fma_f32 v[168:169], v[168:169], v[44:45], v[72:73] op_sel:[0,0,0] op_sel_hi:[1,0,1]
    v_pk_fma_f32 v[170:171], v[170:171], v[44:45], v[74:75] op_sel:[0,0,0] op_sel_hi:[1,0,1]
    v_pk_fma_f32 v[184:185], v[184:185], v[44:45], v[76:77] op_sel:[0,0,0] op_sel_hi:[1,0,1]
    v_pk_fma_f32 v[186:187], v[186:187], v[44:45], v[78:79] op_sel:[0,0,0] op_sel_hi:[1,0,1]
    v_pk_mul_f32 v[80:81], v[168:169], v[168:169]
    v_pk_mul_f32 v[82:83], v[170:171], v[170:171]
    v_pk_mul_f32 v[84:85], v[184:185], v[184:185]
    v_pk_mul_f32 v[86:87], v[186:187], v[186:187]
    v_pk_fma_f32 v[72:73], v[80:81], s[52:53], s[52:53] op_sel:[0,0,1] op_sel_hi:[1,0,1]
    v_pk_fma_f32 v[74:75], v[82:83], s[52:53], s[52:53] op_sel:[0,0,1] op_sel_hi:[1,0,1]
    v_pk_fma_f32 v[76:77], v[84:85], s[52:53], s[52:53] op_sel:[0,0,1] op_sel_hi:[1,0,1]
    v_pk_fma_f32 v[78:79], v[86:87], s[52:53], s[52:53] op_sel:[0,0,1] op_sel_hi:[1,0,1]
    v_pk_fma_f32 v[72:73], v[72:73], v[80:81], s[56:57] op_sel:[0,0,0] op_sel_hi:[1,1,0]
    v_pk_fma_f32 v[74:75], v[74:75], v[82:83], s[56:57] op_sel:[0,0,0] op_sel_hi:[1,1,0]
    v_pk_fma_f32 v[76:77], v[76:77], v[84:85], s[56:57] op_sel:[0,0,0] op_sel_hi:[1,1,0]
    v_pk_fma_f32 v[78:79], v[78:79], v[86:87], s[56:57] op_sel:[0,0,0] op_sel_hi:[1,1,0]
    v_pk_fma_f32 v[72:73], v[72:73], v[80:81], s[56:57] op_sel:[0,0,1] op_sel_hi:[1,1,1]
    v_pk_fma_f32 v[74:75], v[74:75], v[82:83], s[56:57] op_sel:[0,0,1] op_sel_hi:[1,1,1]
    v_pk_fma_f32 v[76:77], v[76:77], v[84:85], s[56:57] op_sel:[0,0,1] op_sel_hi:[1,1,1]
    v_pk_fma_f32 v[78:79], v[78:79], v[86:87], s[56:57] op_sel:[0,0,1] op_sel_hi:[1,1,1]
    v_pk_fma_f32 v[72:73], v[72:73], v[80:81], s[40:41] op_sel:[0,0,0] op_sel_hi:[1,1,0]
    v_pk_fma_f32 v[74:75], v[74:75], v[82:83], s[40:41] op_sel:[0,0,0] op_sel_hi:[1,1,0]
    v_pk_fma_f32 v[76:77], v[76:77], v[84:85], s[40:41] op_sel:[0,0,0] op_sel_hi:[1,1,0]
    v_pk_fma_f32 v[78:79], v[78:79], v[86:87], s[40:41] op_sel:[0,0,0] op_sel_hi:[1,1,0]
    v_pk_fma_f32 v[72:73], v[72:73], v[80:81], s[40:41] op_sel:[0,0,1] op_sel_hi:[1,1,1]
    v_pk_fma_f32 v[74:75], v[74:75], v[82:83], s[40:41] op_sel:[0,0,1] op_sel_hi:[1,1,1]
    v_pk_fma_f32 v[76:77], v[76:77], v[84:85], s[40:41] op_sel:[0,0,1] op_sel_hi:[1,1,1]
    v_pk_fma_f32 v[78:79], v[78:79], v[86:87], s[40:41] op_sel:[0,0,1] op_sel_hi:[1,1,1]
    v_pk_fma_f32 v[72:73], v[72:73], v[80:81], s[98:99] op_sel:[0,0,0] op_sel_hi:[1,1,0]
    v_pk_fma_f32 v[74:75], v[74:75], v[82:83], s[98:99] op_sel:[0,0,0] op_sel_hi:[1,1,0]
    v_pk_fma_f32 v[76:77], v[76:77], v[84:85], s[98:99] op_sel:[0,0,0] op_sel_hi:[1,1,0]
    v_pk_fma_f32 v[78:79], v[78:79], v[86:87], s[98:99] op_sel:[0,0,0] op_sel_hi:[1,1,0]
    v_pk_fma_f32 v[72:73], v[72:73], v[168:169], s[98:99] op_sel:[0,0,1] op_sel_hi:[1,1,1] clamp
    v_pk_fma_f32 v[74:75], v[74:75], v[170:171], s[98:99] op_sel:[0,0,1] op_sel_hi:[1,1,1] clamp
    v_pk_fma_f32 v[76:77], v[76:77], v[184:185], s[98:99] op_sel:[0,0,1] op_sel_hi:[1,1,1] clamp
    v_pk_fma_f32 v[78:79], v[78:79], v[186:187], s[98:99] op_sel:[0,0,1] op_sel_hi:[1,1,1] clamp
    v_pk_mul_f32 v[168:169], v[168:169], v[72:73]
    v_pk_mul_f32 v[170:171], v[170:171], v[74:75]
    v_pk_mul_f32 v[184:185], v[184:185], v[76:77]
    v_pk_mul_f32 v[186:187], v[186:187], v[78:79]
    v_cvt_pk_bf16_f32 v168, v168, v169
    v_cvt_pk_bf16_f32 v169, v170, v171
    v_cvt_pk_bf16_f32 v170, v184, v185
    v_cvt_pk_bf16_f32 v171, v186, v187
    buffer_store_dwordx4 v[168:171], v2, s[12:15], s51 offen offset:2048 sc0 sc1
    ds_write_b128 v29, v[168:171] offset:0
    v_pk_fma_f32 v[72:73], v[20:21], v[46:47], v[88:89] op_sel:[0,1,0] op_sel_hi:[1,1,1]
    v_pk_fma_f32 v[74:75], v[22:23], v[46:47], v[90:91] op_sel:[0,1,0] op_sel_hi:[1,1,1]
    v_pk_fma_f32 v[76:77], v[24:25], v[46:47], v[92:93] op_sel:[0,1,0] op_sel_hi:[1,1,1]
    v_pk_fma_f32 v[78:79], v[26:27], v[46:47], v[94:95] op_sel:[0,1,0] op_sel_hi:[1,1,1]
    v_pk_fma_f32 v[172:173], v[172:173], v[46:47], v[72:73] op_sel:[0,0,0] op_sel_hi:[1,0,1]
    v_pk_fma_f32 v[174:175], v[174:175], v[46:47], v[74:75] op_sel:[0,0,0] op_sel_hi:[1,0,1]
    v_pk_fma_f32 v[188:189], v[188:189], v[46:47], v[76:77] op_sel:[0,0,0] op_sel_hi:[1,0,1]
    v_pk_fma_f32 v[190:191], v[190:191], v[46:47], v[78:79] op_sel:[0,0,0] op_sel_hi:[1,0,1]
    v_pk_mul_f32 v[80:81], v[172:173], v[172:173]
    v_pk_mul_f32 v[82:83], v[174:175], v[174:175]
    v_pk_mul_f32 v[84:85], v[188:189], v[188:189]
    v_pk_mul_f32 v[86:87], v[190:191], v[190:191]
    v_pk_fma_f32 v[72:73], v[80:81], s[52:53], s[52:53] op_sel:[0,0,1] op_sel_hi:[1,0,1]
    v_pk_fma_f32 v[74:75], v[82:83], s[52:53], s[52:53] op_sel:[0,0,1] op_sel_hi:[1,0,1]
    v_pk_fma_f32 v[76:77], v[84:85], s[52:53], s[52:53] op_sel:[0,0,1] op_sel_hi:[1,0,1]
    v_pk_fma_f32 v[78:79], v[86:87], s[52:53], s[52:53] op_sel:[0,0,1] op_sel_hi:[1,0,1]
    v_pk_fma_f32 v[72:73], v[72:73], v[80:81], s[56:57] op_sel:[0,0,0] op_sel_hi:[1,1,0]
    v_pk_fma_f32 v[74:75], v[74:75], v[82:83], s[56:57] op_sel:[0,0,0] op_sel_hi:[1,1,0]
    v_pk_fma_f32 v[76:77], v[76:77], v[84:85], s[56:57] op_sel:[0,0,0] op_sel_hi:[1,1,0]
    v_pk_fma_f32 v[78:79], v[78:79], v[86:87], s[56:57] op_sel:[0,0,0] op_sel_hi:[1,1,0]
    v_pk_fma_f32 v[72:73], v[72:73], v[80:81], s[56:57] op_sel:[0,0,1] op_sel_hi:[1,1,1]
    v_pk_fma_f32 v[74:75], v[74:75], v[82:83], s[56:57] op_sel:[0,0,1] op_sel_hi:[1,1,1]
    v_pk_fma_f32 v[76:77], v[76:77], v[84:85], s[56:57] op_sel:[0,0,1] op_sel_hi:[1,1,1]
    v_pk_fma_f32 v[78:79], v[78:79], v[86:87], s[56:57] op_sel:[0,0,1] op_sel_hi:[1,1,1]
    v_pk_fma_f32 v[72:73], v[72:73], v[80:81], s[40:41] op_sel:[0,0,0] op_sel_hi:[1,1,0]
    v_pk_fma_f32 v[74:75], v[74:75], v[82:83], s[40:41] op_sel:[0,0,0] op_sel_hi:[1,1,0]
    v_pk_fma_f32 v[76:77], v[76:77], v[84:85], s[40:41] op_sel:[0,0,0] op_sel_hi:[1,1,0]
    v_pk_fma_f32 v[78:79], v[78:79], v[86:87], s[40:41] op_sel:[0,0,0] op_sel_hi:[1,1,0]
    v_pk_fma_f32 v[72:73], v[72:73], v[80:81], s[40:41] op_sel:[0,0,1] op_sel_hi:[1,1,1]
    v_pk_fma_f32 v[74:75], v[74:75], v[82:83], s[40:41] op_sel:[0,0,1] op_sel_hi:[1,1,1]
    v_pk_fma_f32 v[76:77], v[76:77], v[84:85], s[40:41] op_sel:[0,0,1] op_sel_hi:[1,1,1]
    v_pk_fma_f32 v[78:79], v[78:79], v[86:87], s[40:41] op_sel:[0,0,1] op_sel_hi:[1,1,1]
    v_pk_fma_f32 v[72:73], v[72:73], v[80:81], s[98:99] op_sel:[0,0,0] op_sel_hi:[1,1,0]
    v_pk_fma_f32 v[74:75], v[74:75], v[82:83], s[98:99] op_sel:[0,0,0] op_sel_hi:[1,1,0]
    v_pk_fma_f32 v[76:77], v[76:77], v[84:85], s[98:99] op_sel:[0,0,0] op_sel_hi:[1,1,0]
    v_pk_fma_f32 v[78:79], v[78:79], v[86:87], s[98:99] op_sel:[0,0,0] op_sel_hi:[1,1,0]
    v_pk_fma_f32 v[72:73], v[72:73], v[172:173], s[98:99] op_sel:[0,0,1] op_sel_hi:[1,1,1] clamp
    v_pk_fma_f32 v[74:75], v[74:75], v[174:175], s[98:99] op_sel:[0,0,1] op_sel_hi:[1,1,1] clamp
    v_pk_fma_f32 v[76:77], v[76:77], v[188:189], s[98:99] op_sel:[0,0,1] op_sel_hi:[1,1,1] clamp
    v_pk_fma_f32 v[78:79], v[78:79], v[190:191], s[98:99] op_sel:[0,0,1] op_sel_hi:[1,1,1] clamp
    v_pk_mul_f32 v[172:173], v[172:173], v[72:73]
    v_pk_mul_f32 v[174:175], v[174:175], v[74:75]
    v_pk_mul_f32 v[188:189], v[188:189], v[76:77]
    v_pk_mul_f32 v[190:191], v[190:191], v[78:79]
    v_cvt_pk_bf16_f32 v172, v172, v173
    v_cvt_pk_bf16_f32 v173, v174, v175
    v_cvt_pk_bf16_f32 v174, v188, v189
    v_cvt_pk_bf16_f32 v175, v190, v191
    buffer_store_dwordx4 v[172:175], v2, s[12:15], s51 offen offset:3072 sc0 sc1
    ds_write_b128 v29, v[172:175] offset:1024
    s_mul_i32 s3, s45, 64
    v_add_u32 v31, s3, v3
    ds_read_b128 v[20:23], v31 offset:384
    ds_read_b128 v[88:91], v31 offset:2432
    s_mul_i32 s51, s45, 32768
    s_add_u32 s51, s51, 32768
    s_lshl_b32 s3, s45, 13
    s_add_u32 s3, s3, 98304
    s_add_u32 s51, s51, s50
    s_add_u32 s46, s3, s54
    s_add_u32 s47, s3, s55
    v_add_u32 v28, s46, v2
    v_add_u32 v29, s47, v2
    s_waitcnt lgkmcnt(0)
    s_nop 0
    v_pk_fma_f32 v[72:73], v[4:5], v[40:41], v[12:13] op_sel:[0,1,0] op_sel_hi:[1,1,1]
    v_pk_fma_f32 v[74:75], v[6:7], v[40:41], v[14:15] op_sel:[0,1,0] op_sel_hi:[1,1,1]
    v_pk_fma_f32 v[76:77], v[8:9], v[40:41], v[16:17] op_sel:[0,1,0] op_sel_hi:[1,1,1]
    v_pk_fma_f32 v[78:79], v[10:11], v[40:41], v[18:19] op_sel:[0,1,0] op_sel_hi:[1,1,1]
    v_pk_fma_f32 v[192:193], v[192:193], v[40:41], v[72:73] op_sel:[0,0,0] op_sel_hi:[1,0,1]
    v_pk_fma_f32 v[194:195], v[194:195], v[40:41], v[74:75] op_sel:[0,0,0] op_sel_hi:[1,0,1]
    v_pk_fma_f32 v[208:209], v[208:209], v[40:41], v[76:77] op_sel:[0,0,0] op_sel_hi:[1,0,1]
    v_pk_fma_f32 v[210:211], v[210:211], v[40:41], v[78:79] op_sel:[0,0,0] op_sel_hi:[1,0,1]
    v_pk_mul_f32 v[80:81], v[192:193], v[192:193]
    v_pk_mul_f32 v[82:83], v[194:195], v[194:195]
    v_pk_mul_f32 v[84:85], v[208:209], v[208:209]
    v_pk_mul_f32 v[86:87], v[210:211], v[210:211]
    v_pk_fma_f32 v[72:73], v[80:81], s[52:53], s[52:53] op_sel:[0,0,1] op_sel_hi:[1,0,1]
    v_pk_fma_f32 v[74:75], v[82:83], s[52:53], s[52:53] op_sel:[0,0,1] op_sel_hi:[1,0,1]
    v_pk_fma_f32 v[76:77], v[84:85], s[52:53], s[52:53] op_sel:[0,0,1] op_sel_hi:[1,0,1]
    v_pk_fma_f32 v[78:79], v[86:87], s[52:53], s[52:53] op_sel:[0,0,1] op_sel_hi:[1,0,1]
    v_pk_fma_f32 v[72:73], v[72:73], v[80:81], s[56:57] op_sel:[0,0,0] op_sel_hi:[1,1,0]
    v_pk_fma_f32 v[74:75], v[74:75], v[82:83], s[56:57] op_sel:[0,0,0] op_sel_hi:[1,1,0]
    v_pk_fma_f32 v[76:77], v[76:77], v[84:85], s[56:57] op_sel:[0,0,0] op_sel_hi:[1,1,0]
    v_pk_fma_f32 v[78:79], v[78:79], v[86:87], s[56:57] op_sel:[0,0,0] op_sel_hi:[1,1,0]
    v_pk_fma_f32 v[72:73], v[72:73], v[80:81], s[56:57] op_sel:[0,0,1] op_sel_hi:[1,1,1]
    v_pk_fma_f32 v[74:75], v[74:75], v[82:83], s[56:57] op_sel:[0,0,1] op_sel_hi:[1,1,1]
    v_pk_fma_f32 v[76:77], v[76:77], v[84:85], s[56:57] op_sel:[0,0,1] op_sel_hi:[1,1,1]
    v_pk_fma_f32 v[78:79], v[78:79], v[86:87], s[56:57] op_sel:[0,0,1] op_sel_hi:[1,1,1]
    v_pk_fma_f32 v[72:73], v[72:73], v[80:81], s[40:41] op_sel:[0,0,0] op_sel_hi:[1,1,0]
    v_pk_fma_f32 v[74:75], v[74:75], v[82:83], s[40:41] op_sel:[0,0,0] op_sel_hi:[1,1,0]
    v_pk_fma_f32 v[76:77], v[76:77], v[84:85], s[40:41] op_sel:[0,0,0] op_sel_hi:[1,1,0]
    v_pk_fma_f32 v[78:79], v[78:79], v[86:87], s[40:41] op_sel:[0,0,0] op_sel_hi:[1,1,0]
    v_pk_fma_f32 v[72:73], v[72:73], v[80:81], s[40:41] op_sel:[0,0,1] op_sel_hi:[1,1,1]
    v_pk_fma_f32 v[74:75], v[74:75], v[82:83], s[40:41] op_sel:[0,0,1] op_sel_hi:[1,1,1]
    v_pk_fma_f32 v[76:77], v[76:77], v[84:85], s[40:41] op_sel:[0,0,1] op_sel_hi:[1,1,1]
    v_pk_fma_f32 v[78:79], v[78:79], v[86:87], s[40:41] op_sel:[0,0,1] op_sel_hi:[1,1,1]
    v_pk_fma_f32 v[72:73], v[72:73], v[80:81], s[98:99] op_sel:[0,0,0] op_sel_hi:[1,1,0]
    v_pk_fma_f32 v[74:75], v[74:75], v[82:83], s[98:99] op_sel:[0,0,0] op_sel_hi:[1,1,0]
    v_pk_fma_f32 v[76:77], v[76:77], v[84:85], s[98:99] op_sel:[0,0,0] op_sel_hi:[1,1,0]
    v_pk_fma_f32 v[78:79], v[78:79], v[86:87], s[98:99] op_sel:[0,0,0] op_sel_hi:[1,1,0]
    v_pk_fma_f32 v[72:73], v[72:73], v[192:193], s[98:99] op_sel:[0,0,1] op_sel_hi:[1,1,1] clamp
    v_pk_fma_f32 v[74:75], v[74:75], v[194:195], s[98:99] op_sel:[0,0,1] op_sel_hi:[1,1,1] clamp
    v_pk_fma_f32 v[76:77], v[76:77], v[208:209], s[98:99] op_sel:[0,0,1] op_sel_hi:[1,1,1] clamp
    v_pk_fma_f32 v[78:79], v[78:79], v[210:211], s[98:99] op_sel:[0,0,1] op_sel_hi:[1,1,1] clamp
    v_pk_mul_f32 v[192:193], v[192:193], v[72:73]
    v_pk_mul_f32 v[194:195], v[194:195], v[74:75]
    v_pk_mul_f32 v[208:209], v[208:209], v[76:77]
    v_pk_mul_f32 v[210:211], v[210:211], v[78:79]
    v_cvt_pk_bf16_f32 v192, v192, v193
    v_cvt_pk_bf16_f32 v193, v194, v195
    v_cvt_pk_bf16_f32 v194, v208, v209
    v_cvt_pk_bf16_f32 v195, v210, v211
    buffer_store_dwordx4 v[192:195], v2, s[12:15], s51 offen offset:0 sc0 sc1
    ds_write_b128 v28, v[192:195] offset:0
    v_pk_fma_f32 v[72:73], v[4:5], v[42:43], v[12:13] op_sel:[0,1,0] op_sel_hi:[1,1,1]
    v_pk_fma_f32 v[74:75], v[6:7], v[42:43], v[14:15] op_sel:[0,1,0] op_sel_hi:[1,1,1]
    v_pk_fma_f32 v[76:77], v[8:9], v[42:43], v[16:17] op_sel:[0,1,0] op_sel_hi:[1,1,1]
    v_pk_fma_f32 v[78:79], v[10:11], v[42:43], v[18:19] op_sel:[0,1,0] op_sel_hi:[1,1,1]
    v_pk_fma_f32 v[196:197], v[196:197], v[42:43], v[72:73] op_sel:[0,0,0] op_sel_hi:[1,0,1]
    v_pk_fma_f32 v[198:199], v[198:199], v[42:43], v[74:75] op_sel:[0,0,0] op_sel_hi:[1,0,1]
    v_pk_fma_f32 v[212:213], v[212:213], v[42:43], v[76:77] op_sel:[0,0,0] op_sel_hi:[1,0,1]
    v_pk_fma_f32 v[214:215], v[214:215], v[42:43], v[78:79] op_sel:[0,0,0] op_sel_hi:[1,0,1]
    v_pk_mul_f32 v[80:81], v[196:197], v[196:197]
    v_pk_mul_f32 v[82:83], v[198:199], v[198:199]
    v_pk_mul_f32 v[84:85], v[212:213], v[212:213]
    v_pk_mul_f32 v[86:87], v[214:215], v[214:215]
    v_pk_fma_f32 v[72:73], v[80:81], s[52:53], s[52:53] op_sel:[0,0,1] op_sel_hi:[1,0,1]
    v_pk_fma_f32 v[74:75], v[82:83], s[52:53], s[52:53] op_sel:[0,0,1] op_sel_hi:[1,0,1]
    v_pk_fma_f32 v[76:77], v[84:85], s[52:53], s[52:53] op_sel:[0,0,1] op_sel_hi:[1,0,1]
    v_pk_fma_f32 v[78:79], v[86:87], s[52:53], s[52:53] op_sel:[0,0,1] op_sel_hi:[1,0,1]
    v_pk_fma_f32 v[72:73], v[72:73], v[80:81], s[56:57] op_sel:[0,0,0] op_sel_hi:[1,1,0]
    v_pk_fma_f32 v[74:75], v[74:75], v[82:83], s[56:57] op_sel:[0,0,0] op_sel_hi:[1,1,0]
    v_pk_fma_f32 v[76:77], v[76:77], v[84:85], s[56:57] op_sel:[0,0,0] op_sel_hi:[1,1,0]
    v_pk_fma_f32 v[78:79], v[78:79], v[86:87], s[56:57] op_sel:[0,0,0] op_sel_hi:[1,1,0]
    v_pk_fma_f32 v[72:73], v[72:73], v[80:81], s[56:57] op_sel:[0,0,1] op_sel_hi:[1,1,1]
    v_pk_fma_f32 v[74:75], v[74:75], v[82:83], s[56:57] op_sel:[0,0,1] op_sel_hi:[1,1,1]
    v_pk_fma_f32 v[76:77], v[76:77], v[84:85], s[56:57] op_sel:[0,0,1] op_sel_hi:[1,1,1]
    v_pk_fma_f32 v[78:79], v[78:79], v[86:87], s[56:57] op_sel:[0,0,1] op_sel_hi:[1,1,1]
    v_pk_fma_f32 v[72:73], v[72:73], v[80:81], s[40:41] op_sel:[0,0,0] op_sel_hi:[1,1,0]
    v_pk_fma_f32 v[74:75], v[74:75], v[82:83], s[40:41] op_sel:[0,0,0] op_sel_hi:[1,1,0]
    v_pk_fma_f32 v[76:77], v[76:77], v[84:85], s[40:41] op_sel:[0,0,0] op_sel_hi:[1,1,0]
    v_pk_fma_f32 v[78:79], v[78:79], v[86:87], s[40:41] op_sel:[0,0,0] op_sel_hi:[1,1,0]
    v_pk_fma_f32 v[72:73], v[72:73], v[80:81], s[40:41] op_sel:[0,0,1] op_sel_hi:[1,1,1]
    v_pk_fma_f32 v[74:75], v[74:75], v[82:83], s[40:41] op_sel:[0,0,1] op_sel_hi:[1,1,1]
    v_pk_fma_f32 v[76:77], v[76:77], v[84:85], s[40:41] op_sel:[0,0,1] op_sel_hi:[1,1,1]
    v_pk_fma_f32 v[78:79], v[78:79], v[86:87], s[40:41] op_sel:[0,0,1] op_sel_hi:[1,1,1]
    v_pk_fma_f32 v[72:73], v[72:73], v[80:81], s[98:99] op_sel:[0,0,0] op_sel_hi:[1,1,0]
    v_pk_fma_f32 v[74:75], v[74:75], v[82:83], s[98:99] op_sel:[0,0,0] op_sel_hi:[1,1,0]
    v_pk_fma_f32 v[76:77], v[76:77], v[84:85], s[98:99] op_sel:[0,0,0] op_sel_hi:[1,1,0]
    v_pk_fma_f32 v[78:79], v[78:79], v[86:87], s[98:99] op_sel:[0,0,0] op_sel_hi:[1,1,0]
    v_pk_fma_f32 v[72:73], v[72:73], v[196:197], s[98:99] op_sel:[0,0,1] op_sel_hi:[1,1,1] clamp
    v_pk_fma_f32 v[74:75], v[74:75], v[198:199], s[98:99] op_sel:[0,0,1] op_sel_hi:[1,1,1] clamp
    v_pk_fma_f32 v[76:77], v[76:77], v[212:213], s[98:99] op_sel:[0,0,1] op_sel_hi:[1,1,1] clamp
    v_pk_fma_f32 v[78:79], v[78:79], v[214:215], s[98:99] op_sel:[0,0,1] op_sel_hi:[1,1,1] clamp
    v_pk_mul_f32 v[196:197], v[196:197], v[72:73]
    v_pk_mul_f32 v[198:199], v[198:199], v[74:75]
    v_pk_mul_f32 v[212:213], v[212:213], v[76:77]
    v_pk_mul_f32 v[214:215], v[214:215], v[78:79]
    v_cvt_pk_bf16_f32 v196, v196, v197
    v_cvt_pk_bf16_f32 v197, v198, v199
    v_cvt_pk_bf16_f32 v198, v212, v213
    v_cvt_pk_bf16_f32 v199, v214, v215
    buffer_store_dwordx4 v[196:199], v2, s[12:15], s51 offen offset:1024 sc0 sc1
    ds_write_b128 v28, v[196:199] offset:1024
    s_waitcnt vmcnt(6)
    s_add_u32 s3, s100, 65536
    s_mov_b64 exec, 0xff
    buffer_store_dwordx4 v[246:249], v2, s[76:79], s3 offen sc0 sc1
    s_mov_b64 exec, -1
    v_pk_fma_f32 v[72:73], v[4:5], v[44:45], v[12:13] op_sel:[0,1,0] op_sel_hi:[1,1,1]
    v_pk_fma_f32 v[74:75], v[6:7], v[44:45], v[14:15] op_sel:[0,1,0] op_sel_hi:[1,1,1]
    v_pk_fma_f32 v[76:77], v[8:9], v[44:45], v[16:17] op_sel:[0,1,0] op_sel_hi:[1,1,1]
    v_pk_fma_f32 v[78:79], v[10:11], v[44:45], v[18:19] op_sel:[0,1,0] op_sel_hi:[1,1,1]
    v_pk_fma_f32 v[200:201], v[200:201], v[44:45], v[72:73] op_sel:[0,0,0] op_sel_hi:[1,0,1]
    v_pk_fma_f32 v[202:203], v[202:203], v[44:45], v[74:75] op_sel:[0,0,0] op_sel_hi:[1,0,1]
    v_pk_fma_f32 v[216:217], v[216:217], v[44:45], v[76:77] op_sel:[0,0,0] op_sel_hi:[1,0,1]
    v_pk_fma_f32 v[218:219], v[218:219], v[44:45], v[78:79] op_sel:[0,0,0] op_sel_hi:[1,0,1]
    v_pk_mul_f32 v[80:81], v[200:201], v[200:201]
    v_pk_mul_f32 v[82:83], v[202:203], v[202:203]
    v_pk_mul_f32 v[84:85], v[216:217], v[216:217]
    v_pk_mul_f32 v[86:87], v[218:219], v[218:219]
    v_pk_fma_f32 v[72:73], v[80:81], s[52:53], s[52:53] op_sel:[0,0,1] op_sel_hi:[1,0,1]
    v_pk_fma_f32 v[74:75], v[82:83], s[52:53], s[52:53] op_sel:[0,0,1] op_sel_hi:[1,0,1]
    v_pk_fma_f32 v[76:77], v[84:85], s[52:53], s[52:53] op_sel:[0,0,1] op_sel_hi:[1,0,1]
    v_pk_fma_f32 v[78:79], v[86:87], s[52:53], s[52:53] op_sel:[0,0,1] op_sel_hi:[1,0,1]
    v_pk_fma_f32 v[72:73], v[72:73], v[80:81], s[56:57] op_sel:[0,0,0] op_sel_hi:[1,1,0]
    v_pk_fma_f32 v[74:75], v[74:75], v[82:83], s[56:57] op_sel:[0,0,0] op_sel_hi:[1,1,0]
    v_pk_fma_f32 v[76:77], v[76:77], v[84:85], s[56:57] op_sel:[0,0,0] op_sel_hi:[1,1,0]
    v_pk_fma_f32 v[78:79], v[78:79], v[86:87], s[56:57] op_sel:[0,0,0] op_sel_hi:[1,1,0]
    v_pk_fma_f32 v[72:73], v[72:73], v[80:81], s[56:57] op_sel:[0,0,1] op_sel_hi:[1,1,1]
    v_pk_fma_f32 v[74:75], v[74:75], v[82:83], s[56:57] op_sel:[0,0,1] op_sel_hi:[1,1,1]
    v_pk_fma_f32 v[76:77], v[76:77], v[84:85], s[56:57] op_sel:[0,0,1] op_sel_hi:[1,1,1]
    v_pk_fma_f32 v[78:79], v[78:79], v[86:87], s[56:57] op_sel:[0,0,1] op_sel_hi:[1,1,1]
    v_pk_fma_f32 v[72:73], v[72:73], v[80:81], s[40:41] op_sel:[0,0,0] op_sel_hi:[1,1,0]
    v_pk_fma_f32 v[74:75], v[74:75], v[82:83], s[40:41] op_sel:[0,0,0] op_sel_hi:[1,1,0]
    v_pk_fma_f32 v[76:77], v[76:77], v[84:85], s[40:41] op_sel:[0,0,0] op_sel_hi:[1,1,0]
    v_pk_fma_f32 v[78:79], v[78:79], v[86:87], s[40:41] op_sel:[0,0,0] op_sel_hi:[1,1,0]
    v_pk_fma_f32 v[72:73], v[72:73], v[80:81], s[40:41] op_sel:[0,0,1] op_sel_hi:[1,1,1]
    v_pk_fma_f32 v[74:75], v[74:75], v[82:83], s[40:41] op_sel:[0,0,1] op_sel_hi:[1,1,1]
    v_pk_fma_f32 v[76:77], v[76:77], v[84:85], s[40:41] op_sel:[0,0,1] op_sel_hi:[1,1,1]
    v_pk_fma_f32 v[78:79], v[78:79], v[86:87], s[40:41] op_sel:[0,0,1] op_sel_hi:[1,1,1]
    v_pk_fma_f32 v[72:73], v[72:73], v[80:81], s[98:99] op_sel:[0,0,0] op_sel_hi:[1,1,0]
    v_pk_fma_f32 v[74:75], v[74:75], v[82:83], s[98:99] op_sel:[0,0,0] op_sel_hi:[1,1,0]
    v_pk_fma_f32 v[76:77], v[76:77], v[84:85], s[98:99] op_sel:[0,0,0] op_sel_hi:[1,1,0]
    v_pk_fma_f32 v[78:79], v[78:79], v[86:87], s[98:99] op_sel:[0,0,0] op_sel_hi:[1,1,0]
    v_pk_fma_f32 v[72:73], v[72:73], v[200:201], s[98:99] op_sel:[0,0,1] op_sel_hi:[1,1,1] clamp
    v_pk_fma_f32 v[74:75], v[74:75], v[202:203], s[98:99] op_sel:[0,0,1] op_sel_hi:[1,1,1] clamp
    v_pk_fma_f32 v[76:77], v[76:77], v[216:217], s[98:99] op_sel:[0,0,1] op_sel_hi:[1,1,1] clamp
    v_pk_fma_f32 v[78:79], v[78:79], v[218:219], s[98:99] op_sel:[0,0,1] op_sel_hi:[1,1,1] clamp
    v_pk_mul_f32 v[200:201], v[200:201], v[72:73]
    v_pk_mul_f32 v[202:203], v[202:203], v[74:75]
    v_pk_mul_f32 v[216:217], v[216:217], v[76:77]
    v_pk_mul_f32 v[218:219], v[218:219], v[78:79]
    v_cvt_pk_bf16_f32 v200, v200, v201
    v_cvt_pk_bf16_f32 v201, v202, v203
    v_cvt_pk_bf16_f32 v202, v216, v217
    v_cvt_pk_bf16_f32 v203, v218, v219
    buffer_store_dwordx4 v[200:203], v2, s[12:15], s51 offen offset:2048 sc0 sc1
    ds_write_b128 v29, v[200:203] offset:0
    v_pk_fma_f32 v[72:73], v[4:5], v[46:47], v[12:13] op_sel:[0,1,0] op_sel_hi:[1,1,1]
    v_pk_fma_f32 v[74:75], v[6:7], v[46:47], v[14:15] op_sel:[0,1,0] op_sel_hi:[1,1,1]
    v_pk_fma_f32 v[76:77], v[8:9], v[46:47], v[16:17] op_sel:[0,1,0] op_sel_hi:[1,1,1]
    v_pk_fma_f32 v[78:79], v[10:11], v[46:47], v[18:19] op_sel:[0,1,0] op_sel_hi:[1,1,1]
    v_pk_fma_f32 v[204:205], v[204:205], v[46:47], v[72:73] op_sel:[0,0,0] op_sel_hi:[1,0,1]
    v_pk_fma_f32 v[206:207], v[206:207], v[46:47], v[74:75] op_sel:[0,0,0] op_sel_hi:[1,0,1]
    v_pk_fma_f32 v[220:221], v[220:221], v[46:47], v[76:77] op_sel:[0,0,0] op_sel_hi:[1,0,1]
    v_pk_fma_f32 v[222:223], v[222:223], v[46:47], v[78:79] op_sel:[0,0,0] op_sel_hi:[1,0,1]
    v_pk_mul_f32 v[80:81], v[204:205], v[204:205]
    v_pk_mul_f32 v[82:83], v[206:207], v[206:207]
    v_pk_mul_f32 v[84:85], v[220:221], v[220:221]
    v_pk_mul_f32 v[86:87], v[222:223], v[222:223]
    v_pk_fma_f32 v[72:73], v[80:81], s[52:53], s[52:53] op_sel:[0,0,1] op_sel_hi:[1,0,1]
    v_pk_fma_f32 v[74:75], v[82:83], s[52:53], s[52:53] op_sel:[0,0,1] op_sel_hi:[1,0,1]
    v_pk_fma_f32 v[76:77], v[84:85], s[52:53], s[52:53] op_sel:[0,0,1] op_sel_hi:[1,0,1]
    v_pk_fma_f32 v[78:79], v[86:87], s[52:53], s[52:53] op_sel:[0,0,1] op_sel_hi:[1,0,1]
    v_pk_fma_f32 v[72:73], v[72:73], v[80:81], s[56:57] op_sel:[0,0,0] op_sel_hi:[1,1,0]
    v_pk_fma_f32 v[74:75], v[74:75], v[82:83], s[56:57] op_sel:[0,0,0] op_sel_hi:[1,1,0]
    v_pk_fma_f32 v[76:77], v[76:77], v[84:85], s[56:57] op_sel:[0,0,0] op_sel_hi:[1,1,0]
    v_pk_fma_f32 v[78:79], v[78:79], v[86:87], s[56:57] op_sel:[0,0,0] op_sel_hi:[1,1,0]
    v_pk_fma_f32 v[72:73], v[72:73], v[80:81], s[56:57] op_sel:[0,0,1] op_sel_hi:[1,1,1]
    v_pk_fma_f32 v[74:75], v[74:75], v[82:83], s[56:57] op_sel:[0,0,1] op_sel_hi:[1,1,1]
    v_pk_fma_f32 v[76:77], v[76:77], v[84:85], s[56:57] op_sel:[0,0,1] op_sel_hi:[1,1,1]
    v_pk_fma_f32 v[78:79], v[78:79], v[86:87], s[56:57] op_sel:[0,0,1] op_sel_hi:[1,1,1]
    v_pk_fma_f32 v[72:73], v[72:73], v[80:81], s[40:41] op_sel:[0,0,0] op_sel_hi:[1,1,0]
    v_pk_fma_f32 v[74:75], v[74:75], v[82:83], s[40:41] op_sel:[0,0,0] op_sel_hi:[1,1,0]
    v_pk_fma_f32 v[76:77], v[76:77], v[84:85], s[40:41] op_sel:[0,0,0] op_sel_hi:[1,1,0]
    v_pk_fma_f32 v[78:79], v[78:79], v[86:87], s[40:41] op_sel:[0,0,0] op_sel_hi:[1,1,0]
    v_pk_fma_f32 v[72:73], v[72:73], v[80:81], s[40:41] op_sel:[0,0,1] op_sel_hi:[1,1,1]
    v_pk_fma_f32 v[74:75], v[74:75], v[82:83], s[40:41] op_sel:[0,0,1] op_sel_hi:[1,1,1]
    v_pk_fma_f32 v[76:77], v[76:77], v[84:85], s[40:41] op_sel:[0,0,1] op_sel_hi:[1,1,1]
    v_pk_fma_f32 v[78:79], v[78:79], v[86:87], s[40:41] op_sel:[0,0,1] op_sel_hi:[1,1,1]
    v_pk_fma_f32 v[72:73], v[72:73], v[80:81], s[98:99] op_sel:[0,0,0] op_sel_hi:[1,1,0]
    v_pk_fma_f32 v[74:75], v[74:75], v[82:83], s[98:99] op_sel:[0,0,0] op_sel_hi:[1,1,0]
    v_pk_fma_f32 v[76:77], v[76:77], v[84:85], s[98:99] op_sel:[0,0,0] op_sel_hi:[1,1,0]
    v_pk_fma_f32 v[78:79], v[78:79], v[86:87], s[98:99] op_sel:[0,0,0] op_sel_hi:[1,1,0]
    v_pk_fma_f32 v[72:73], v[72:73], v[204:205], s[98:99] op_sel:[0,0,1] op_sel_hi:[1,1,1] clamp
    v_pk_fma_f32 v[74:75], v[74:75], v[206:207], s[98:99] op_sel:[0,0,1] op_sel_hi:[1,1,1] clamp
    v_pk_fma_f32 v[76:77], v[76:77], v[220:221], s[98:99] op_sel:[0,0,1] op_sel_hi:[1,1,1] clamp
    v_pk_fma_f32 v[78:79], v[78:79], v[222:223], s[98:99] op_sel:[0,0,1] op_sel_hi:[1,1,1] clamp
    v_pk_mul_f32 v[204:205], v[204:205], v[72:73]
    v_pk_mul_f32 v[206:207], v[206:207], v[74:75]
    v_pk_mul_f32 v[220:221], v[220:221], v[76:77]
    v_pk_mul_f32 v[222:223], v[222:223], v[78:79]
    v_cvt_pk_bf16_f32 v204, v204, v205
    v_cvt_pk_bf16_f32 v205, v206, v207
    v_cvt_pk_bf16_f32 v206, v220, v221
    v_cvt_pk_bf16_f32 v207, v222, v223
    buffer_store_dwordx4 v[204:207], v2, s[12:15], s51 offen offset:3072 sc0 sc1
    ds_write_b128 v29, v[204:207] offset:1024
    s_lshl_b32 s51, s45, 9
    s_add_u32 s51, s51, 49152
    s_add_u32 s51, s51, s50
    s_waitcnt lgkmcnt(0)
    s_nop 0
    v_pk_fma_f32 v[72:73], v[20:21], v[40:41], v[88:89] op_sel:[0,1,0] op_sel_hi:[1,1,1]
    v_pk_fma_f32 v[74:75], v[22:23], v[40:41], v[90:91] op_sel:[0,1,0] op_sel_hi:[1,1,1]
    v_pk_fma_f32 v[76:77], v[20:21], v[42:43], v[88:89] op_sel:[0,1,0] op_sel_hi:[1,1,1]
    v_pk_fma_f32 v[78:79], v[22:23], v[42:43], v[90:91] op_sel:[0,1,0] op_sel_hi:[1,1,1]
    v_pk_fma_f32 v[224:225], v[224:225], v[40:41], v[72:73] op_sel:[0,0,0] op_sel_hi:[1,0,1]
    v_pk_fma_f32 v[226:227], v[226:227], v[40:41], v[74:75] op_sel:[0,0,0] op_sel_hi:[1,0,1]
    v_pk_fma_f32 v[228:229], v[228:229], v[42:43], v[76:77] op_sel:[0,0,0] op_sel_hi:[1,0,1]
    v_pk_fma_f32 v[230:231], v[230:231], v[42:43], v[78:79] op_sel:[0,0,0] op_sel_hi:[1,0,1]
    v_pk_mul_f32 v[80:81], v[224:225], v[224:225]
    v_pk_mul_f32 v[82:83], v[226:227], v[226:227]
    v_pk_mul_f32 v[84:85], v[228:229], v[228:229]
    v_pk_mul_f32 v[86:87], v[230:231], v[230:231]
    v_pk_fma_f32 v[72:73], v[80:81], s[52:53], s[52:53] op_sel:[0,0,1] op_sel_hi:[1,0,1]
    v_pk_fma_f32 v[74:75], v[82:83], s[52:53], s[52:53] op_sel:[0,0,1] op_sel_hi:[1,0,1]
    v_pk_fma_f32 v[76:77], v[84:85], s[52:53], s[52:53] op_sel:[0,0,1] op_sel_hi:[1,0,1]
    v_pk_fma_f32 v[78:79], v[86:87], s[52:53], s[52:53] op_sel:[0,0,1] op_sel_hi:[1,0,1]
    v_pk_fma_f32 v[72:73], v[72:73], v[80:81], s[56:57] op_sel:[0,0,0] op_sel_hi:[1,1,0]
    v_pk_fma_f32 v[74:75], v[74:75], v[82:83], s[56:57] op_sel:[0,0,0] op_sel_hi:[1,1,0]
    v_pk_fma_f32 v[76:77], v[76:77], v[84:85], s[56:57] op_sel:[0,0,0] op_sel_hi:[1,1,0]
    v_pk_fma_f32 v[78:79], v[78:79], v[86:87], s[56:57] op_sel:[0,0,0] op_sel_hi:[1,1,0]
    v_pk_fma_f32 v[72:73], v[72:73], v[80:81], s[56:57] op_sel:[0,0,1] op_sel_hi:[1,1,1]
    v_pk_fma_f32 v[74:75], v[74:75], v[82:83], s[56:57] op_sel:[0,0,1] op_sel_hi:[1,1,1]
    v_pk_fma_f32 v[76:77], v[76:77], v[84:85], s[56:57] op_sel:[0,0,1] op_sel_hi:[1,1,1]
    v_pk_fma_f32 v[78:79], v[78:79], v[86:87], s[56:57] op_sel:[0,0,1] op_sel_hi:[1,1,1]
    v_pk_fma_f32 v[72:73], v[72:73], v[80:81], s[40:41] op_sel:[0,0,0] op_sel_hi:[1,1,0]
    v_pk_fma_f32 v[74:75], v[74:75], v[82:83], s[40:41] op_sel:[0,0,0] op_sel_hi:[1,1,0]
    v_pk_fma_f32 v[76:77], v[76:77], v[84:85], s[40:41] op_sel:[0,0,0] op_sel_hi:[1,1,0]
    v_pk_fma_f32 v[78:79], v[78:79], v[86:87], s[40:41] op_sel:[0,0,0] op_sel_hi:[1,1,0]
    v_pk_fma_f32 v[72:73], v[72:73], v[80:81], s[40:41] op_sel:[0,0,1] op_sel_hi:[1,1,1]
    v_pk_fma_f32 v[74:75], v[74:75], v[82:83], s[40:41] op_sel:[0,0,1] op_sel_hi:[1,1,1]
    v_pk_fma_f32 v[76:77], v[76:77], v[84:85], s[40:41] op_sel:[0,0,1] op_sel_hi:[1,1,1]
    v_pk_fma_f32 v[78:79], v[78:79], v[86:87], s[40:41] op_sel:[0,0,1] op_sel_hi:[1,1,1]
    v_pk_fma_f32 v[72:73], v[72:73], v[80:81], s[98:99] op_sel:[0,0,0] op_sel_hi:[1,1,0]
    v_pk_fma_f32 v[74:75], v[74:75], v[82:83], s[98:99] op_sel:[0,0,0] op_sel_hi:[1,1,0]
    v_pk_fma_f32 v[76:77], v[76:77], v[84:85], s[98:99] op_sel:[0,0,0] op_sel_hi:[1,1,0]
    v_pk_fma_f32 v[78:79], v[78:79], v[86:87], s[98:99] op_sel:[0,0,0] op_sel_hi:[1,1,0]
    v_pk_fma_f32 v[72:73], v[72:73], v[224:225], s[98:99] op_sel:[0,0,1] op_sel_hi:[1,1,1] clamp
    v_pk_fma_f32 v[74:75], v[74:75], v[226:227], s[98:99] op_sel:[0,0,1] op_sel_hi:[1,1,1] clamp
    v_pk_fma_f32 v[76:77], v[76:77], v[228:229], s[98:99] op_sel:[0,0,1] op_sel_hi:[1,1,1] clamp
    v_pk_fma_f32 v[78:79], v[78:79], v[230:231], s[98:99] op_sel:[0,0,1] op_sel_hi:[1,1,1] clamp
    v_pk_mul_f32 v[224:225], v[224:225], v[72:73]
    v_pk_mul_f32 v[226:227], v[226:227], v[74:75]
    v_pk_mul_f32 v[228:229], v[228:229], v[76:77]
    v_pk_mul_f32 v[230:231], v[230:231], v[78:79]
    v_cvt_pk_bf16_f32 v224, v224, v225
    v_cvt_pk_bf16_f32 v225, v226, v227
    v_cvt_pk_bf16_f32 v226, v228, v229
    v_cvt_pk_bf16_f32 v227, v230, v231
    s_nop 1
    v_permlane16_swap_b32 v224, v226
    v_permlane16_swap_b32 v225, v227
    s_nop 1
    buffer_store_dwordx4 v[224:227], v30, s[12:15], s51 offen offset:0 sc0 sc1
    v_pk_fma_f32 v[72:73], v[20:21], v[44:45], v[88:89] op_sel:[0,1,0] op_sel_hi:[1,1,1]
    v_pk_fma_f32 v[74:75], v[22:23], v[44:45], v[90:91] op_sel:[0,1,0] op_sel_hi:[1,1,1]
    v_pk_fma_f32 v[76:77], v[20:21], v[46:47], v[88:89] op_sel:[0,1,0] op_sel_hi:[1,1,1]
    v_pk_fma_f32 v[78:79], v[22:23], v[46:47], v[90:91] op_sel:[0,1,0] op_sel_hi:[1,1,1]
    v_pk_fma_f32 v[232:233], v[232:233], v[44:45], v[72:73] op_sel:[0,0,0] op_sel_hi:[1,0,1]
    v_pk_fma_f32 v[234:235], v[234:235], v[44:45], v[74:75] op_sel:[0,0,0] op_sel_hi:[1,0,1]
    v_pk_fma_f32 v[236:237], v[236:237], v[46:47], v[76:77] op_sel:[0,0,0] op_sel_hi:[1,0,1]
    v_pk_fma_f32 v[238:239], v[238:239], v[46:47], v[78:79] op_sel:[0,0,0] op_sel_hi:[1,0,1]
    v_pk_mul_f32 v[80:81], v[232:233], v[232:233]
    v_pk_mul_f32 v[82:83], v[234:235], v[234:235]
    v_pk_mul_f32 v[84:85], v[236:237], v[236:237]
    v_pk_mul_f32 v[86:87], v[238:239], v[238:239]
    v_pk_fma_f32 v[72:73], v[80:81], s[52:53], s[52:53] op_sel:[0,0,1] op_sel_hi:[1,0,1]
    v_pk_fma_f32 v[74:75], v[82:83], s[52:53], s[52:53] op_sel:[0,0,1] op_sel_hi:[1,0,1]
    v_pk_fma_f32 v[76:77], v[84:85], s[52:53], s[52:53] op_sel:[0,0,1] op_sel_hi:[1,0,1]
    v_pk_fma_f32 v[78:79], v[86:87], s[52:53], s[52:53] op_sel:[0,0,1] op_sel_hi:[1,0,1]
    v_pk_fma_f32 v[72:73], v[72:73], v[80:81], s[56:57] op_sel:[0,0,0] op_sel_hi:[1,1,0]
    v_pk_fma_f32 v[74:75], v[74:75], v[82:83], s[56:57] op_sel:[0,0,0] op_sel_hi:[1,1,0]
    v_pk_fma_f32 v[76:77], v[76:77], v[84:85], s[56:57] op_sel:[0,0,0] op_sel_hi:[1,1,0]
    v_pk_fma_f32 v[78:79], v[78:79], v[86:87], s[56:57] op_sel:[0,0,0] op_sel_hi:[1,1,0]
    v_pk_fma_f32 v[72:73], v[72:73], v[80:81], s[56:57] op_sel:[0,0,1] op_sel_hi:[1,1,1]
    v_pk_fma_f32 v[74:75], v[74:75], v[82:83], s[56:57] op_sel:[0,0,1] op_sel_hi:[1,1,1]
    v_pk_fma_f32 v[76:77], v[76:77], v[84:85], s[56:57] op_sel:[0,0,1] op_sel_hi:[1,1,1]
    v_pk_fma_f32 v[78:79], v[78:79], v[86:87], s[56:57] op_sel:[0,0,1] op_sel_hi:[1,1,1]
    v_pk_fma_f32 v[72:73], v[72:73], v[80:81], s[40:41] op_sel:[0,0,0] op_sel_hi:[1,1,0]
    v_pk_fma_f32 v[74:75], v[74:75], v[82:83], s[40:41] op_sel:[0,0,0] op_sel_hi:[1,1,0]
    v_pk_fma_f32 v[76:77], v[76:77], v[84:85], s[40:41] op_sel:[0,0,0] op_sel_hi:[1,1,0]
    v_pk_fma_f32 v[78:79], v[78:79], v[86:87], s[40:41] op_sel:[0,0,0] op_sel_hi:[1,1,0]
    v_pk_fma_f32 v[72:73], v[72:73], v[80:81], s[40:41] op_sel:[0,0,1] op_sel_hi:[1,1,1]
    v_pk_fma_f32 v[74:75], v[74:75], v[82:83], s[40:41] op_sel:[0,0,1] op_sel_hi:[1,1,1]
    v_pk_fma_f32 v[76:77], v[76:77], v[84:85], s[40:41] op_sel:[0,0,1] op_sel_hi:[1,1,1]
    v_pk_fma_f32 v[78:79], v[78:79], v[86:87], s[40:41] op_sel:[0,0,1] op_sel_hi:[1,1,1]
    v_pk_fma_f32 v[72:73], v[72:73], v[80:81], s[98:99] op_sel:[0,0,0] op_sel_hi:[1,1,0]
    v_pk_fma_f32 v[74:75], v[74:75], v[82:83], s[98:99] op_sel:[0,0,0] op_sel_hi:[1,1,0]
    v_pk_fma_f32 v[76:77], v[76:77], v[84:85], s[98:99] op_sel:[0,0,0] op_sel_hi:[1,1,0]
    v_pk_fma_f32 v[78:79], v[78:79], v[86:87], s[98:99] op_sel:[0,0,0] op_sel_hi:[1,1,0]
    v_pk_fma_f32 v[72:73], v[72:73], v[232:233], s[98:99] op_sel:[0,0,1] op_sel_hi:[1,1,1] clamp
    v_pk_fma_f32 v[74:75], v[74:75], v[234:235], s[98:99] op_sel:[0,0,1] op_sel_hi:[1,1,1] clamp
    v_pk_fma_f32 v[76:77], v[76:77], v[236:237], s[98:99] op_sel:[0,0,1] op_sel_hi:[1,1,1] clamp
    v_pk_fma_f32 v[78:79], v[78:79], v[238:239], s[98:99] op_sel:[0,0,1] op_sel_hi:[1,1,1] clamp
    v_pk_mul_f32 v[232:233], v[232:233], v[72:73]
    v_pk_mul_f32 v[234:235], v[234:235], v[74:75]
    v_pk_mul_f32 v[236:237], v[236:237], v[76:77]
    v_pk_mul_f32 v[238:239], v[238:239], v[78:79]
    v_cvt_pk_bf16_f32 v232, v232, v233
    v_cvt_pk_bf16_f32 v233, v234, v235
    v_cvt_pk_bf16_f32 v234, v236, v237
    v_cvt_pk_bf16_f32 v235, v238, v239
    s_nop 1
    v_permlane16_swap_b32 v232, v234
    v_permlane16_swap_b32 v233, v235
    s_nop 1
    buffer_store_dwordx4 v[232:235], v30, s[12:15], s51 offen offset:2048 sc0 sc1
    s_branch P_f2_cw
P_ffn2_go:
    s_load_dwordx2 s[24:25], s[0:1], 80
    s_load_dwordx2 s[36:37], s[0:1], 56
    s_and_b32 s92, s29, 1
    s_lshr_b32 s93, s29, 1
    v_and_b32 v1, 63, v0
    v_lshrrev_b32 v14, 6, v0
    s_nop 0
    v_readfirstlane_b32 s49, v14
    s_nop 3
    s_and_b32 s30, s49, 3
    s_lshr_b32 s44, s30, 1
    s_and_b32 s45, s30, 1
    s_cmp_lg_u32 s49, 1
    s_cbranch_scc1 L_c3w_139
    v_readlane_b32 s3, v255, 5
    v_mov_b32 v251, 143360
    s_nop 1
    v_mov_b32 v252, s3
    ds_write_b32 v251, v252 offset:4
    s_waitcnt lgkmcnt(0)
L_c3w_139:
    s_add_u32 s95, s95, 1
    s_waitcnt lgkmcnt(0)
    s_barrier
    s_cmp_ge_u32 s49, 4
    s_cbranch_scc1 L_lset_134
    s_add_u32 s4, s24, 16777216
    s_addc_u32 s5, s25, 0
    s_and_b32 s5, s5, 0xffff
    s_mov_b32 s6, 4194304
    s_mov_b32 s7, 0x00020000
    s_mov_b32 s16, s36
    s_mov_b32 s17, s37
    s_and_b32 s17, s17, 0xffff
    s_mov_b32 s18, 2048
    s_mov_b32 s19, 0x00020000
    v_and_b32 v14, 15, v1
    v_lshrrev_b32 v15, 4, v1
    v_lshlrev_b32 v15, 3, v15
    v_lshlrev_b32 v14, 4, v1
    s_lshl_b32 s3, s28, 18
    s_lshl_b32 s46, s93, 15
    s_add_u32 s3, s3, s46
    s_lshl_b32 s46, s45, 14
    s_add_u32 s3, s3, s46
    s_lshl_b32 s46, s44, 12
    s_add_u32 s3, s3, s46
    s_lshl_b32 s46, s92, 11
    s_add_u32 s3, s3, s46
    s_lshr_b32 s46, s3, 8
    s_xor_b32 s46, s46, s3
    s_bfe_u32 s46, s46, 0x1000d
    s_mul_i32 s46, s46, 2105344
    s_xor_b32 s3, s3, s46
    s_lshr_b32 s46, s3, 8
    s_and_b32 s46, s46, 0x2000
    s_xor_b32 s3, s3, s46
    v_readlane_b32 s46, v255, 20
    s_nop 0
    s_xor_b32 s3, s3, s46
    s_xor_b32 s46, s3, 0x202000
    buffer_load_dwordx4 v[56:59], v14, s[4:7], s3 offen offset:0
    buffer_load_dwordx4 v[60:63], v14, s[4:7], s3 offen offset:1024
    buffer_load_dwordx4 v[64:67], v14, s[4:7], s46 offen offset:0
    buffer_load_dwordx4 v[68:71], v14, s[4:7], s46 offen offset:1024
    s_lshl_b32 s3, s93, 8
    s_lshl_b32 s46, s45, 7
    s_add_u32 s3, s3, s46
    buffer_load_dwordx2 v[100:101], v15, s[16:19], s3 offen offset:0
    buffer_load_dwordx2 v[102:103], v15, s[16:19], s3 offen offset:32
    buffer_load_dwordx2 v[104:105], v15, s[16:19], s3 offen offset:64
    buffer_load_dwordx2 v[106:107], v15, s[16:19], s3 offen offset:96
    s_waitcnt vmcnt(0)
    s_branch L_cset_135
L_h3_140:
    s_waitcnt vmcnt(0)
    s_barrier
    s_barrier
    s_branch L_h2_138
L_h1_137:
    v_lshlrev_b32 v2, 4, v1
    s_waitcnt vmcnt(0)
    s_add_u32 s3, s100, 196608
    s_mov_b64 exec, 0xff
    buffer_store_dwordx4 v[246:249], v2, s[76:79], s3 offen sc0 sc1
    s_mov_b64 exec, -1
L_h2_138:
    s_waitcnt vmcnt(0) lgkmcnt(0)
    s_barrier
    s_branch S_next
.p2align 6
P_f2_lw:
    v_readlane_b32 s46, v255, 3
    s_lshr_b32 s92, s29, 3
    s_and_b32 s93, s29, 7
    s_mov_b32 s95, 0
    s_cmp_lg_u32 s46, 0
    s_cbranch_scc1 L_h3_140
    s_lshl_b32 s29, s93, 1
    s_add_u32 s29, s29, s92
L_lset_134:
    s_load_dwordx2 s[26:27], s[0:1], 48
    s_setprio 2
    v_mov_b32 v247, 143360
    ds_read_b32 v247, v247 offset:4
    v_subrev_u32 v14, 3, v1
    v_mul_u32_u24 v15, 37, v14
    v_lshrrev_b32 v15, 8, v15
    v_mul_u32_u24 v16, 7, v15
    v_sub_u32 v14, v14, v16
    v_add_u32 v14, 1, v14
    v_cmp_gt_u32 vcc, 3, v1
    v_cndmask_b32 v14, v14, 0, vcc
    v_cndmask_b32 v15, v15, v1, vcc
    v_add_u32 v14, s93, v14
    v_and_b32 v14, 7, v14
    v_mad_u32_u24 v14, v14, 7, v15
    v_cmp_gt_u32 vcc, 2, v15
    v_cndmask_b32 v15, 2, 5, vcc
    v_mad_u32_u24 v14, v15, s45, v14
    s_mul_i32 s3, s92, 56
    v_add_u32 v11, s3, v14
    v_lshlrev_b32 v10, 14, v11
    s_lshr_b32 s46, s28, 3
    s_xor_b32 s46, s46, s28
    s_and_b32 s3, s28, 7
    s_lshl_b32 s3, s3, 8
    s_and_b32 s46, s46, 1
    s_add_u32 s3, s3, s46
    v_readlane_b32 s46, v255, 20
    s_lshl_b32 s3, s3, 13
    s_nop 0
    s_xor_b32 s3, s3, s46
    s_lshl_b32 s46, s44, 12
    s_add_u32 s3, s3, s46
    s_add_u32 s3, s3, 4096
    s_lshl_b32 s47, s92, 11
    s_add_u32 s31, s3, s47
    s_sub_u32 s3, s3, s47
    v_lshl_add_u32 v2, v1, 4, s31
    v_lshl_add_u32 v3, v1, 4, s3
    s_lshl_b32 s31, s45, 13
    s_add_u32 s31, s31, s46
    s_lshl_b32 s32, s30, 12
    s_add_u32 s32, s32, 16384
    s_lshl_b32 s94, s93, 1
    s_add_u32 s94, s94, s44
    s_lshl_b32 s3, s94, 7
    v_lshrrev_b32 v14, 3, v1
    v_and_b32 v16, 7, v1
    v_bfe_u32 v15, v1, 4, 1
    v_lshlrev_b32 v15, 1, v15
    v_xor_b32 v15, v15, v16
    v_lshlrev_b32 v15, 4, v15
    v_lshrrev_b32 v16, 5, v1
    v_and_b32 v17, 3, v14
    v_lshl_add_u32 v16, v16, 4, v17
    s_waitcnt lgkmcnt(0)
    s_mov_b32 s8, s26
    s_mov_b32 s9, s27
    s_and_b32 s9, s9, 0xffff
    s_mov_b32 s10, 7340032
    s_mov_b32 s11, 0x00020000
    s_add_u32 s50, s24, 46137344
    s_addc_u32 s51, s25, 0
    s_and_b32 s51, s51, 0xffff
    s_mov_b32 s52, 1835008
    s_mov_b32 s53, 0x00020000
    v_readfirstlane_b32 s54, v247
    s_lshr_b32 s47, s94, 3
    s_mul_i32 s47, s47, 917504
    s_and_b32 s46, s94, 7
    s_nop 0
    s_lshl_b32 s54, s54, 3
    s_add_u32 s46, s46, s54
    s_cmp_eq_u32 s46, 11
    s_cselect_b32 s3, s47, s3
    s_cselect_b32 s8, s50, s8
    s_cselect_b32 s9, s51, s9
    s_cselect_b32 s10, s52, s10
    s_cselect_b32 s55, 8, 11
    v_add_u32 v15, s3, v15
    s_add_u32 s54, s55, 5
    v_lshlrev_b32 v11, s54, v11
    v_lshl_add_u32 v6, v16, s55, v15
    s_lshl_b32 s46, 4, s55
    s_lshl_b32 s47, 8, s55
    v_xor_b32 v17, 64, v6
    v_add_u32 v7, s46, v17
    v_add_u32 v8, s47, v6
    v_add_u32 v9, s47, v7
    v_lshl_add_u32 v12, v14, s55, v15
    s_lshl_b32 s46, 8, s55
    s_lshl_b32 s47, 16, s55
    v_xor_b32 v17, 64, v12
    v_add_u32 v13, s46, v17
    v_add_u32 v22, s47, v12
    v_add_u32 v23, s47, v13
    v_readlane_b32 s84, v11, 0
    v_readlane_b32 s85, v11, 1
    v_readlane_b32 s86, v11, 2
    v_readlane_b32 s87, v11, 3
    v_readlane_b32 s88, v11, 4
    v_readlane_b32 s96, v255, 1
    v_readlane_b32 s97, v255, 2
    v_lshlrev_b32 v24, 7, v1
    s_nop 1
    s_add_u32 m0, s32, 32768
    s_nop 0
    buffer_load_dwordx4 v6, s[8:11], s84 offen lds
    s_add_u32 m0, s32, 33792
    s_nop 0
    buffer_load_dwordx4 v7, s[8:11], s84 offen lds
    s_add_u32 m0, s32, 34816
    s_nop 0
    buffer_load_dwordx4 v8, s[8:11], s84 offen lds
    s_add_u32 m0, s32, 35840
    s_nop 0
    buffer_load_dwordx4 v9, s[8:11], s84 offen lds
    s_add_u32 m0, s32, 131072
    s_nop 0
    buffer_load_dwordx4 v6, s[8:11], s87 offen lds
    s_add_u32 m0, s32, 132096
    s_nop 0
    buffer_load_dwordx4 v7, s[8:11], s87 offen lds
    s_add_u32 m0, s32, 133120
    s_nop 0
    buffer_load_dwordx4 v8, s[8:11], s87 offen lds
    s_add_u32 m0, s32, 134144
    s_nop 0
    buffer_load_dwordx4 v9, s[8:11], s87 offen lds
    s_cmp_lg_u32 s95, 0
    s_cbranch_scc1 L_cold_141
    s_waitcnt vmcnt(8)
    s_barrier
L_cold_141:
    s_add_u32 m0, s32, 65536
    s_nop 0
    buffer_load_dwordx4 v6, s[8:11], s85 offen lds
    s_add_u32 m0, s32, 66560
    s_nop 0
    buffer_load_dwordx4 v7, s[8:11], s85 offen lds
    s_add_u32 m0, s32, 67584
    s_nop 0
    buffer_load_dwordx4 v8, s[8:11], s85 offen lds
    s_add_u32 m0, s32, 68608
    s_nop 0
    buffer_load_dwordx4 v9, s[8:11], s85 offen lds
    s_add_u32 m0, s32, 98304
    s_nop 0
    buffer_load_dwordx4 v6, s[8:11], s86 offen lds
    s_add_u32 m0, s32, 99328
    s_nop 0
    buffer_load_dwordx4 v7, s[8:11], s86 offen lds
    s_add_u32 m0, s32, 100352
    s_nop 0
    buffer_load_dwordx4 v8, s[8:11], s86 offen lds
    s_add_u32 m0, s32, 101376
    s_nop 0
    buffer_load_dwordx4 v9, s[8:11], s86 offen lds
    s_add_u32 s4, s24, 20967424
    s_addc_u32 s5, s25, 0
    s_and_b32 s5, s5, 0xffff
    s_mov_b32 s6, 16781312
    s_mov_b32 s7, 0x00020000
    s_add_u32 s76, s24, 3407872
    s_addc_u32 s77, s25, 0
    s_and_b32 s77, s77, 0xffff
    s_mov_b32 s78, 327680
    s_mov_b32 s79, 0x00020000
    v_readlane_b32 s84, v10, 0
    v_readlane_b32 s85, v10, 1
    v_readlane_b32 s86, v10, 2
    v_readlane_b32 s87, v10, 3
    v_readlane_b32 s89, v10, 4
    s_add_u32 s98, s96, 0x1000000
    s_addc_u32 s99, s97, 0
    s_lshl_b32 s90, s28, 13
    s_lshr_b32 s91, s90, 3
    s_xor_b32 s91, s91, s90
    s_bfe_u32 s91, s91, 0x1000d
    s_mul_i32 s91, s91, 73728
    s_xor_b32 s90, s90, s91
    v_readlane_b32 s91, v255, 20
    s_xor_b32 s90, s90, 0x2000
    s_nop 0
    s_xor_b32 s90, s90, s91
    s_add_u32 s90, s90, 65536
    s_add_u32 s91, s90, 131072
    s_lshl_b32 s3, s92, 12
    s_add_u32 s90, s90, s3
    s_mov_b32 s101, 0
    s_cmp_eq_u32 s95, 0
    s_cbranch_scc1 L_warm_142
    s_cmp_eq_u32 s95, 2
    s_cbranch_scc1 L_np_143
    s_mov_b32 s48, 200
L_poll_145:
    buffer_load_dwordx2 v[26:27], v24, s[76:79], s91 offen sc0 sc1
    s_waitcnt vmcnt(0)
    v_cmp_lt_u64 vcc, s[96:97], v[26:27]
    v_cmp_gt_u64 s[46:47], s[98:99], v[26:27]
    s_nop 1
    s_and_b64 s[46:47], s[46:47], vcc
    s_cmp_eq_u64 s[46:47], exec
    s_cbranch_scc1 L_pok_146
    s_sub_u32 s48, s48, 1
    s_cmp_lg_u32 s48, 0
    s_cbranch_scc1 L_poll_145
    s_mov_b32 s101, 1
    s_mov_b32 s6, 0
L_pok_146:
    s_mov_b64 exec, -1
L_np_143:
    s_add_u32 m0, s31, 32768
    s_nop 0
    buffer_load_dwordx4 v2, s[4:7], s84 offen offset:0 lds
    buffer_load_dwordx4 v2, s[4:7], s84 offen offset:1024 lds
    buffer_load_dwordx4 v3, s[4:7], s84 offen offset:2048 lds
    buffer_load_dwordx4 v3, s[4:7], s84 offen offset:3072 lds
    s_add_u32 m0, s31, 65536
    s_nop 0
    buffer_load_dwordx4 v2, s[4:7], s85 offen offset:0 lds
    buffer_load_dwordx4 v2, s[4:7], s85 offen offset:1024 lds
    buffer_load_dwordx4 v3, s[4:7], s85 offen offset:2048 lds
    buffer_load_dwordx4 v3, s[4:7], s85 offen offset:3072 lds
    s_add_u32 m0, s31, 98304
    s_nop 0
    buffer_load_dwordx4 v2, s[4:7], s86 offen offset:0 lds
    buffer_load_dwordx4 v2, s[4:7], s86 offen offset:1024 lds
    buffer_load_dwordx4 v3, s[4:7], s86 offen offset:2048 lds
    buffer_load_dwordx4 v3, s[4:7], s86 offen offset:3072 lds
    s_branch L_warm_144
L_warm_142:
    s_barrier
L_warm_144:
    s_waitcnt vmcnt(0)
    s_barrier
    s_add_u32 m0, s32, 0
    s_nop 0
    buffer_load_dwordx4 v6, s[8:11], s88 offen lds
    s_add_u32 m0, s32, 1024
    s_nop 0
    buffer_load_dwordx4 v7, s[8:11], s88 offen lds
    s_add_u32 m0, s32, 2048
    s_nop 0
    buffer_load_dwordx4 v8, s[8:11], s88 offen lds
    s_add_u32 m0, s32, 3072
    s_nop 0
    buffer_load_dwordx4 v9, s[8:11], s88 offen lds
    s_cmp_lg_u32 s95, 0
    s_cbranch_scc1 L_np_147
    s_mov_b32 exec_hi, 0
    s_mov_b32 s48, 200
L_poll_148:
    buffer_load_dwordx2 v[26:27], v24, s[76:79], s90 offen sc0 sc1
    s_waitcnt vmcnt(0)
    v_cmp_lt_u64 vcc, s[96:97], v[26:27]
    v_cmp_gt_u64 s[46:47], s[98:99], v[26:27]
    s_nop 1
    s_and_b64 s[46:47], s[46:47], vcc
    s_cmp_eq_u64 s[46:47], exec
    s_cbranch_scc1 L_pok_149
    s_sub_u32 s48, s48, 1
    s_cmp_lg_u32 s48, 0
    s_cbranch_scc1 L_poll_148
    s_mov_b32 s101, 1
    s_mov_b32 s6, 0
L_pok_149:
    s_mov_b64 exec, -1
L_np_147:
    s_add_u32 m0, s31, 131072
    s_nop 0
    buffer_load_dwordx4 v2, s[4:7], s87 offen offset:0 lds
    buffer_load_dwordx4 v2, s[4:7], s87 offen offset:1024 lds
    buffer_load_dwordx4 v3, s[4:7], s87 offen offset:2048 lds
    buffer_load_dwordx4 v3, s[4:7], s87 offen offset:3072 lds
    s_add_u32 m0, s31, 0
    s_nop 0
    buffer_load_dwordx4 v2, s[4:7], s89 offen offset:0 lds
    buffer_load_dwordx4 v2, s[4:7], s89 offen offset:1024 lds
    buffer_load_dwordx4 v3, s[4:7], s89 offen offset:2048 lds
    buffer_load_dwordx4 v3, s[4:7], s89 offen offset:3072 lds
    v_readlane_b32 s84, v10, 5
    v_readlane_b32 s87, v11, 5
    v_readlane_b32 s85, v10, 6
    v_readlane_b32 s88, v11, 6
    v_readlane_b32 s86, v10, 7
    v_readlane_b32 s89, v11, 7
    v_readlane_b32 s40, v10, 8
    v_readlane_b32 s41, v11, 8
    s_cmp_eq_u32 s95, 0
    s_cselect_b32 s53, 8, 0
    s_mov_b32 s48, 8
    s_mov_b32 s43, 131072
    s_waitcnt vmcnt(4)
    s_barrier
    s_add_u32 m0, s31, 32768
    s_nop 0
    buffer_load_dwordx4 v2, s[4:7], s84 offen offset:0 lds
    buffer_load_dwordx4 v2, s[4:7], s84 offen offset:1024 lds
    buffer_load_dwordx4 v3, s[4:7], s84 offen offset:2048 lds
    buffer_load_dwordx4 v3, s[4:7], s84 offen offset:3072 lds
    s_add_u32 m0, s32, 32768
    s_nop 0
    buffer_load_dwordx4 v6, s[8:11], s87 offen lds
    s_add_u32 m0, s32, 33792
    s_nop 0
    buffer_load_dwordx4 v7, s[8:11], s87 offen lds
    s_add_u32 m0, s32, 34816
    s_nop 0
    buffer_load_dwordx4 v8, s[8:11], s87 offen lds
    s_add_u32 m0, s32, 35840
    s_nop 0
    buffer_load_dwordx4 v9, s[8:11], s87 offen lds
    s_add_u32 m0, s31, 65536
    s_nop 0
    buffer_load_dwordx4 v2, s[4:7], s85 offen offset:0 lds
    buffer_load_dwordx4 v2, s[4:7], s85 offen offset:1024 lds
    buffer_load_dwordx4 v3, s[4:7], s85 offen offset:2048 lds
    buffer_load_dwordx4 v3, s[4:7], s85 offen offset:3072 lds
    s_add_u32 m0, s32, 65536
    s_nop 0
    buffer_load_dwordx4 v6, s[8:11], s88 offen lds
    s_add_u32 m0, s32, 66560
    s_nop 0
    buffer_load_dwordx4 v7, s[8:11], s88 offen lds
    s_add_u32 m0, s32, 67584
    s_nop 0
    buffer_load_dwordx4 v8, s[8:11], s88 offen lds
    s_add_u32 m0, s32, 68608
    s_nop 0
    buffer_load_dwordx4 v9, s[8:11], s88 offen lds
    s_add_u32 m0, s31, 98304
    s_nop 0
    buffer_load_dwordx4 v2, s[4:7], s86 offen offset:0 lds
    buffer_load_dwordx4 v2, s[4:7], s86 offen offset:1024 lds
    buffer_load_dwordx4 v3, s[4:7], s86 offen offset:2048 lds
    buffer_load_dwordx4 v3, s[4:7], s86 offen offset:3072 lds
    s_add_u32 m0, s32, 98304
    s_nop 0
    buffer_load_dwordx4 v6, s[8:11], s89 offen lds
    s_add_u32 m0, s32, 99328
    s_nop 0
    buffer_load_dwordx4 v7, s[8:11], s89 offen lds
    s_add_u32 m0, s32, 100352
    s_nop 0
    buffer_load_dwordx4 v8, s[8:11], s89 offen lds
    s_add_u32 m0, s32, 101376
    s_nop 0
    buffer_load_dwordx4 v9, s[8:11], s89 offen lds
L_lloop_150:
    s_cmp_eq_u32 s48, s53
    s_waitcnt vmcnt(24)
    s_barrier
    s_cbranch_scc1 L_lev_151
L_levb_152:
    s_add_u32 s48, s48, 1
    s_add_u32 m0, s31, s43
    s_nop 0
    buffer_load_dwordx4 v2, s[4:7], s40 offen offset:0 lds
    buffer_load_dwordx4 v2, s[4:7], s40 offen offset:1024 lds
    buffer_load_dwordx4 v3, s[4:7], s40 offen offset:2048 lds
    buffer_load_dwordx4 v3, s[4:7], s40 offen offset:3072 lds
    v_readlane_b32 s40, v10, s48
    s_add_u32 s33, s32, s43
    s_add_u32 m0, s33, 0
    s_nop 0
    buffer_load_dwordx4 v6, s[8:11], s41 offen lds
    s_add_u32 m0, s33, 1024
    s_nop 0
    buffer_load_dwordx4 v7, s[8:11], s41 offen lds
    s_add_u32 m0, s33, 2048
    s_nop 0
    buffer_load_dwordx4 v8, s[8:11], s41 offen lds
    s_add_u32 m0, s33, 3072
    s_nop 0
    buffer_load_dwordx4 v9, s[8:11], s41 offen lds
    v_readlane_b32 s41, v11, s48
    s_add_u32 s43, s43, 32768
    s_cmp_ge_u32 s43, 163840
    s_cselect_b32 s43, 0, s43
    s_cmp_lg_u32 s48, 24
    s_cbranch_scc1 L_lloop_150
    s_mul_i32 s84, s45, 7
    s_add_u32 s84, s84, 3
    s_mul_i32 s3, s92, 56
    s_sub_u32 s85, s84, s3
    s_add_u32 s85, s85, 56
    s_add_u32 s84, s84, s3
    s_add_u32 s41, s84, 0
    s_lshl_b32 s40, s41, 14
    s_lshl_b32 s41, s41, s54
    s_waitcnt vmcnt(24)
    s_barrier
    s_add_u32 m0, s31, 0
    s_nop 0
    buffer_load_dwordx4 v2, s[4:7], s40 offen offset:0 lds
    buffer_load_dwordx4 v2, s[4:7], s40 offen offset:1024 lds
    buffer_load_dwordx4 v3, s[4:7], s40 offen offset:2048 lds
    buffer_load_dwordx4 v3, s[4:7], s40 offen offset:3072 lds
    s_add_u32 m0, s32, 0
    s_nop 0
    buffer_load_dwordx4 v12, s[8:11], s41 offen lds
    s_add_u32 m0, s32, 1024
    s_nop 0
    buffer_load_dwordx4 v13, s[8:11], s41 offen lds
    s_add_u32 m0, s32, 2048
    s_nop 0
    buffer_load_dwordx4 v22, s[8:11], s41 offen lds
    s_add_u32 m0, s32, 3072
    s_nop 0
    buffer_load_dwordx4 v23, s[8:11], s41 offen lds
    s_add_u32 s41, s84, 14
    s_lshl_b32 s40, s41, 14
    s_lshl_b32 s41, s41, s54
    s_waitcnt vmcnt(24)
    s_barrier
    s_add_u32 m0, s31, 32768
    s_nop 0
    buffer_load_dwordx4 v2, s[4:7], s40 offen offset:0 lds
    buffer_load_dwordx4 v2, s[4:7], s40 offen offset:1024 lds
    s_add_u32 m0, s32, 32768
    s_nop 0
    buffer_load_dwordx4 v12, s[8:11], s41 offen lds
    s_add_u32 m0, s32, 33792
    s_nop 0
    buffer_load_dwordx4 v13, s[8:11], s41 offen lds
    s_add_u32 m0, s32, 34816
    s_nop 0
    buffer_load_dwordx4 v22, s[8:11], s41 offen lds
    s_add_u32 m0, s32, 35840
    s_nop 0
    buffer_load_dwordx4 v23, s[8:11], s41 offen lds
    s_lshl_b32 s3, s30, 2
    s_add_u32 s3, s3, 34816
    v_mov_b32 v14, s3
    v_mov_b32 v15, s101
    ds_write_b32 v14, v15
    s_waitcnt lgkmcnt(0)
    s_add_u32 s41, s84, 28
    s_lshl_b32 s40, s41, 14
    s_lshl_b32 s41, s41, s54
    s_waitcnt vmcnt(22)
    s_barrier
    s_add_u32 m0, s31, 65536
    s_nop 0
    buffer_load_dwordx4 v2, s[4:7], s40 offen offset:0 lds
    buffer_load_dwordx4 v2, s[4:7], s40 offen offset:1024 lds
    s_add_u32 m0, s32, 65536
    s_nop 0
    buffer_load_dwordx4 v12, s[8:11], s41 offen lds
    s_add_u32 m0, s32, 66560
    s_nop 0
    buffer_load_dwordx4 v13, s[8:11], s41 offen lds
    s_add_u32 m0, s32, 67584
    s_nop 0
    buffer_load_dwordx4 v22, s[8:11], s41 offen lds
    s_add_u32 m0, s32, 68608
    s_nop 0
    buffer_load_dwordx4 v23, s[8:11], s41 offen lds
    s_add_u32 s41, s84, 42
    s_lshl_b32 s40, s41, 14
    s_lshl_b32 s41, s41, s54
    s_waitcnt vmcnt(20)
    s_barrier
    s_add_u32 m0, s31, 98304
    s_nop 0
    buffer_load_dwordx4 v2, s[4:7], s40 offen offset:0 lds
    buffer_load_dwordx4 v2, s[4:7], s40 offen offset:1024 lds
    s_add_u32 m0, s32, 98304
    s_nop 0
    buffer_load_dwordx4 v12, s[8:11], s41 offen lds
    s_add_u32 m0, s32, 99328
    s_nop 0
    buffer_load_dwordx4 v13, s[8:11], s41 offen lds
    s_add_u32 m0, s32, 100352
    s_nop 0
    buffer_load_dwordx4 v22, s[8:11], s41 offen lds
    s_add_u32 m0, s32, 101376
    s_nop 0
    buffer_load_dwordx4 v23, s[8:11], s41 offen lds
    s_add_u32 s41, s85, 14
    s_lshl_b32 s40, s41, 14
    s_lshl_b32 s41, s41, s54
    s_waitcnt vmcnt(18)
    s_barrier
    s_add_u32 m0, s31, 131072
    s_nop 0
    buffer_load_dwordx4 v2, s[4:7], s40 offen offset:0 lds
    buffer_load_dwordx4 v2, s[4:7], s40 offen offset:1024 lds
    s_add_u32 m0, s32, 131072
    s_nop 0
    buffer_load_dwordx4 v12, s[8:11], s41 offen lds
    s_add_u32 m0, s32, 132096
    s_nop 0
    buffer_load_dwordx4 v13, s[8:11], s41 offen lds
    s_add_u32 m0, s32, 133120
    s_nop 0
    buffer_load_dwordx4 v22, s[8:11], s41 offen lds
    s_add_u32 m0, s32, 134144
    s_nop 0
    buffer_load_dwordx4 v23, s[8:11], s41 offen lds
    s_add_u32 s41, s85, 28
    s_lshl_b32 s40, s41, 14
    s_lshl_b32 s41, s41, s54
    s_waitcnt vmcnt(18)
    s_barrier
    s_add_u32 m0, s31, 0
    s_nop 0
    buffer_load_dwordx4 v2, s[4:7], s40 offen offset:0 lds
    buffer_load_dwordx4 v2, s[4:7], s40 offen offset:1024 lds
    s_add_u32 m0, s32, 0
    s_nop 0
    buffer_load_dwordx4 v12, s[8:11], s41 offen lds
    s_add_u32 m0, s32, 1024
    s_nop 0
    buffer_load_dwordx4 v13, s[8:11], s41 offen lds
    s_add_u32 m0, s32, 2048
    s_nop 0
    buffer_load_dwordx4 v22, s[8:11], s41 offen lds
    s_add_u32 m0, s32, 3072
    s_nop 0
    buffer_load_dwordx4 v23, s[8:11], s41 offen lds
    s_add_u32 s41, s85, 42
    s_lshl_b32 s40, s41, 14
    s_lshl_b32 s41, s41, s54
    s_waitcnt vmcnt(18)
    s_barrier
    s_add_u32 m0, s31, 32768
    s_nop 0
    buffer_load_dwordx4 v2, s[4:7], s40 offen offset:0 lds
    buffer_load_dwordx4 v2, s[4:7], s40 offen offset:1024 lds
    s_add_u32 m0, s32, 32768
    s_nop 0
    buffer_load_dwordx4 v12, s[8:11], s41 offen lds
    s_add_u32 m0, s32, 33792
    s_nop 0
    buffer_load_dwordx4 v13, s[8:11], s41 offen lds
    s_add_u32 m0, s32, 34816
    s_nop 0
    buffer_load_dwordx4 v22, s[8:11], s41 offen lds
    s_add_u32 m0, s32, 35840
    s_nop 0
    buffer_load_dwordx4 v23, s[8:11], s41 offen lds
    s_waitcnt vmcnt(18)
    s_barrier
    s_waitcnt vmcnt(12)
    s_barrier
    s_waitcnt vmcnt(6)
    s_barrier
    s_waitcnt vmcnt(0)
    s_barrier
    s_branch L_fin_136
L_lev_151:
    s_bitcmp1_b32 s48, 1
    s_cbranch_scc1 L_lev2_153
    buffer_load_dwordx2 v[26:27], v24, s[76:79], s91 offen sc0 sc1
    s_add_u32 s53, s48, 2
    s_branch L_levb_152
L_lev2_153:
    s_waitcnt vmcnt(16)
    v_cmp_lt_u64 vcc, s[96:97], v[26:27]
    v_cmp_gt_u64 s[46:47], s[98:99], v[26:27]
    s_nop 1
    s_and_b64 s[46:47], s[46:47], vcc
    s_cmp_eq_u64 s[46:47], exec
    s_cbranch_scc1 L_levb_152
    s_mov_b32 s52, s48
    s_cmp_eq_u32 s48, 10
    s_cbranch_scc0 L_lev3_154
    s_mov_b32 s53, 20
    s_cmp_eq_u32 s92, 0
    s_cselect_b32 s46, s46, s47
    s_cmp_eq_u32 s46, -1
    s_cbranch_scc1 L_levb_152
    s_add_u32 s90, s90, 131072
    s_mov_b32 exec_hi, 0
    s_mov_b32 s48, 200
L_poll_155:
    buffer_load_dwordx2 v[26:27], v24, s[76:79], s90 offen sc0 sc1
    s_waitcnt vmcnt(0)
    v_cmp_lt_u64 vcc, s[96:97], v[26:27]
    v_cmp_gt_u64 s[46:47], s[98:99], v[26:27]
    s_nop 1
    s_and_b64 s[46:47], s[46:47], vcc
    s_cmp_eq_u64 s[46:47], exec
    s_cbranch_scc1 L_pok_156
    s_sub_u32 s48, s48, 1
    s_cmp_lg_u32 s48, 0
    s_cbranch_scc1 L_poll_155
    s_mov_b32 s101, 1
    s_mov_b32 s6, 0
L_pok_156:
    s_mov_b64 exec, -1
    s_mov_b32 s48, s52
    s_branch L_levb_152
L_lev3_154:
    s_mov_b32 s48, 200
L_poll_157:
    buffer_load_dwordx2 v[26:27], v24, s[76:79], s91 offen sc0 sc1
    s_waitcnt vmcnt(0)
    v_cmp_lt_u64 vcc, s[96:97], v[26:27]
    v_cmp_gt_u64 s[46:47], s[98:99], v[26:27]
    s_nop 1
    s_and_b64 s[46:47], s[46:47], vcc
    s_cmp_eq_u64 s[46:47], exec
    s_cbranch_scc1 L_pok_158
    s_sub_u32 s48, s48, 1
    s_cmp_lg_u32 s48, 0
    s_cbranch_scc1 L_poll_157
    s_mov_b32 s101, 1
    s_mov_b32 s6, 0
L_pok_158:
    s_mov_b64 exec, -1
    s_mov_b32 s48, s52
    s_branch L_levb_152
.p2align 6
P_f2_cw:
    v_readlane_b32 s46, v255, 3
    s_mov_b32 s95, 0
    s_nop 2
    s_cmp_lg_u32 s46, 0
    s_cbranch_scc1 L_h1_137
    s_lshl_b32 s29, s93, 1
    s_add_u32 s29, s29, s92
L_cset_135:
    s_load_dwordx2 s[34:35], s[0:1], 64
    v_lshlrev_b32 v2, 4, v1
    s_lshl_b32 s3, s44, 12
    v_add_u32 v3, s3, v2
    v_lshrrev_b32 v15, 4, v1
    v_bfe_u32 v14, v1, 2, 2
    v_lshl_add_u32 v16, v15, 3, v14
    v_and_b32 v17, 1, v15
    v_lshrrev_b32 v14, 1, v14
    v_lshl_add_u32 v17, v17, 1, v14
    v_lshlrev_b32 v16, 7, v16
    v_and_b32 v14, 3, v1
    v_lshl_add_u32 v16, v14, 3, v16
    s_lshl_b32 s3, s45, 13
    s_add_u32 s3, s3, 16384
    v_add_u32 v16, s3, v16
    v_xor_b32 v14, 0, v17
    v_lshl_add_u32 v4, v14, 5, v16
    v_xor_b32 v14, 1, v17
    v_lshl_add_u32 v5, v14, 5, v16
    v_xor_b32 v14, 2, v17
    v_lshl_add_u32 v6, v14, 5, v16
    v_xor_b32 v14, 3, v17
    v_lshl_add_u32 v7, v14, 5, v16
    s_mov_b32 s42, 32768
    v_add_u32 v8, s42, v3
    v_add_u32 v10, s42, v4
    v_add_u32 v11, s42, v5
    v_add_u32 v12, s42, v6
    v_add_u32 v13, s42, v7
    s_add_u32 s42, s42, 32768
    s_cmp_ge_u32 s42, 163840
    s_cselect_b32 s42, 0, s42
    s_waitcnt lgkmcnt(0)
    s_barrier
    ds_read_b128 v[40:43], v8 offset:0
    ds_read_b64_tr_b16 v[72:73], v10 offset:0
    ds_read_b64_tr_b16 v[74:75], v10 offset:512
    ds_read_b128 v[44:47], v8 offset:1024
    ds_read_b64_tr_b16 v[76:77], v11 offset:0
    ds_read_b64_tr_b16 v[78:79], v11 offset:512
    ds_read_b128 v[48:51], v8 offset:2048
    ds_read_b64_tr_b16 v[80:81], v12 offset:0
    ds_read_b64_tr_b16 v[82:83], v12 offset:512
    ds_read_b128 v[52:55], v8 offset:3072
    ds_read_b64_tr_b16 v[84:85], v13 offset:0
    ds_read_b64_tr_b16 v[86:87], v13 offset:512
    v_lshlrev_b32 v160, 16, v56
    v_and_b32 v161, 0xffff0000, v56
    v_lshlrev_b32 v162, 16, v57
    v_and_b32 v163, 0xffff0000, v57
    v_lshlrev_b32 v164, 16, v60
    v_and_b32 v165, 0xffff0000, v60
    v_lshlrev_b32 v166, 16, v61
    v_and_b32 v167, 0xffff0000, v61
    v_lshlrev_b32 v144, 16, v100
    v_and_b32 v145, 0xffff0000, v100
    v_lshlrev_b32 v146, 16, v101
    v_and_b32 v147, 0xffff0000, v101
    v_pk_add_f32 v[160:161], v[160:161], v[144:145]
    v_pk_add_f32 v[162:163], v[162:163], v[146:147]
    v_pk_add_f32 v[164:165], v[164:165], v[144:145]
    v_pk_add_f32 v[166:167], v[166:167], v[146:147]
    v_lshlrev_b32 v176, 16, v58
    v_and_b32 v177, 0xffff0000, v58
    v_lshlrev_b32 v178, 16, v59
    v_and_b32 v179, 0xffff0000, v59
    v_lshlrev_b32 v180, 16, v62
    v_and_b32 v181, 0xffff0000, v62
    v_lshlrev_b32 v182, 16, v63
    v_and_b32 v183, 0xffff0000, v63
    v_lshlrev_b32 v144, 16, v102
    v_and_b32 v145, 0xffff0000, v102
    v_lshlrev_b32 v146, 16, v103
    v_and_b32 v147, 0xffff0000, v103
    v_pk_add_f32 v[176:177], v[176:177], v[144:145]
    v_pk_add_f32 v[178:179], v[178:179], v[146:147]
    v_pk_add_f32 v[180:181], v[180:181], v[144:145]
    v_pk_add_f32 v[182:183], v[182:183], v[146:147]
    v_lshlrev_b32 v192, 16, v64
    v_and_b32 v193, 0xffff0000, v64
    v_lshlrev_b32 v194, 16, v65
    v_and_b32 v195, 0xffff0000, v65
    v_lshlrev_b32 v196, 16, v68
    v_and_b32 v197, 0xffff0000, v68
    v_lshlrev_b32 v198, 16, v69
    v_and_b32 v199, 0xffff0000, v69
    v_lshlrev_b32 v144, 16, v104
    v_and_b32 v145, 0xffff0000, v104
    v_lshlrev_b32 v146, 16, v105
    v_and_b32 v147, 0xffff0000, v105
    v_pk_add_f32 v[192:193], v[192:193], v[144:145]
    v_pk_add_f32 v[194:195], v[194:195], v[146:147]
    v_pk_add_f32 v[196:197], v[196:197], v[144:145]
    v_pk_add_f32 v[198:199], v[198:199], v[146:147]
    v_lshlrev_b32 v208, 16, v66
    v_and_b32 v209, 0xffff0000, v66
    v_lshlrev_b32 v210, 16, v67
    v_and_b32 v211, 0xffff0000, v67
    v_lshlrev_b32 v212, 16, v70
    v_and_b32 v213, 0xffff0000, v70
    v_lshlrev_b32 v214, 16, v71
    v_and_b32 v215, 0xffff0000, v71
    v_lshlrev_b32 v144, 16, v106
    v_and_b32 v145, 0xffff0000, v106
    v_lshlrev_b32 v146, 16, v107
    v_and_b32 v147, 0xffff0000, v107
    v_pk_add_f32 v[208:209], v[208:209], v[144:145]
    v_pk_add_f32 v[210:211], v[210:211], v[146:147]
    v_pk_add_f32 v[212:213], v[212:213], v[144:145]
    v_pk_add_f32 v[214:215], v[214:215], v[146:147]
    s_waitcnt lgkmcnt(0)
    s_mov_b32 s12, s34
    s_mov_b32 s13, s35
    s_and_b32 s13, s13, 0xffff
    s_mov_b32 s14, 4194304
    s_mov_b32 s15, 0x00020000
    s_add_u32 s84, s24, 37748736
    s_addc_u32 s85, s25, 0
    s_and_b32 s85, s85, 0xffff
    s_mov_b32 s86, 8388608
    s_mov_b32 s87, 0x00020000
    v_mfma_f32_16x16x32_bf16 v[168:171], v[72:75], v[48:51], 0
    ds_read_b128 v[24:27], v8 offset:8192
    v_mfma_f32_16x16x32_bf16 v[172:175], v[72:75], v[52:55], 0
    ds_read_b64_tr_b16 v[56:57], v10 offset:4096
    v_mfma_f32_16x16x32_bf16 v[160:163], v[72:75], v[40:43], v[160:163]
    ds_read_b64_tr_b16 v[58:59], v10 offset:4608
    v_mfma_f32_16x16x32_bf16 v[164:167], v[72:75], v[44:47], v[164:167]
    ds_read_b128 v[28:31], v8 offset:9216
    v_mfma_f32_16x16x32_bf16 v[184:187], v[76:79], v[48:51], 0
    ds_read_b64_tr_b16 v[60:61], v11 offset:4096
    v_mfma_f32_16x16x32_bf16 v[188:191], v[76:79], v[52:55], 0
    ds_read_b64_tr_b16 v[62:63], v11 offset:4608
    v_mfma_f32_16x16x32_bf16 v[176:179], v[76:79], v[40:43], v[176:179]
    ds_read_b128 v[32:35], v8 offset:10240
    v_mfma_f32_16x16x32_bf16 v[180:183], v[76:79], v[44:47], v[180:183]
    ds_read_b64_tr_b16 v[64:65], v12 offset:4096
    v_mfma_f32_16x16x32_bf16 v[200:203], v[80:83], v[48:51], 0
    ds_read_b64_tr_b16 v[66:67], v12 offset:4608
    v_mfma_f32_16x16x32_bf16 v[204:207], v[80:83], v[52:55], 0
    ds_read_b128 v[36:39], v8 offset:11264
    v_mfma_f32_16x16x32_bf16 v[192:195], v[80:83], v[40:43], v[192:195]
    ds_read_b64_tr_b16 v[68:69], v13 offset:4096
    v_mfma_f32_16x16x32_bf16 v[196:199], v[80:83], v[44:47], v[196:199]
    ds_read_b64_tr_b16 v[70:71], v13 offset:4608
    v_mfma_f32_16x16x32_bf16 v[216:219], v[84:87], v[48:51], 0
    v_add_u32 v8, s42, v3
    v_add_u32 v10, s42, v4
    v_add_u32 v11, s42, v5
    v_mfma_f32_16x16x32_bf16 v[220:223], v[84:87], v[52:55], 0
    v_add_u32 v12, s42, v6
    v_add_u32 v13, s42, v7
    s_add_u32 s42, s42, 32768
    v_mfma_f32_16x16x32_bf16 v[208:211], v[84:87], v[40:43], v[208:211]
    s_cmp_ge_u32 s42, 163840
    s_cselect_b32 s42, 0, s42
    s_mov_b32 s48, 24
    v_mfma_f32_16x16x32_bf16 v[212:215], v[84:87], v[44:47], v[212:215]
    s_cmp_eq_u32 s95, 0
    s_cselect_b32 s53, 23, 0
    s_waitcnt lgkmcnt(0)
    s_branch L_cnb_162
L_ft_159:
    s_waitcnt vmcnt(0)
    s_add_u32 s3, s100, 196608
    s_mov_b64 exec, 0xff
    buffer_store_dwordx4 v[246:249], v2, s[76:79], s3 offen sc0 sc1
    s_mov_b64 exec, -1
    s_branch L_ftb_160
L_cbar_161:
    s_barrier
L_cnb_162:
    v_mfma_f32_16x16x32_bf16 v[160:163], v[56:59], v[24:27], v[160:163]
    ds_read_b128 v[40:43], v8 offset:0
    v_mfma_f32_16x16x32_bf16 v[164:167], v[56:59], v[28:31], v[164:167]
    ds_read_b64_tr_b16 v[72:73], v10 offset:0
    v_mfma_f32_16x16x32_bf16 v[168:171], v[56:59], v[32:35], v[168:171]
    ds_read_b64_tr_b16 v[74:75], v10 offset:512
    v_mfma_f32_16x16x32_bf16 v[172:175], v[56:59], v[36:39], v[172:175]
    ds_read_b128 v[44:47], v8 offset:1024
    v_mfma_f32_16x16x32_bf16 v[176:179], v[60:63], v[24:27], v[176:179]
    ds_read_b64_tr_b16 v[76:77], v11 offset:0
    v_mfma_f32_16x16x32_bf16 v[180:183], v[60:63], v[28:31], v[180:183]
    ds_read_b64_tr_b16 v[78:79], v11 offset:512
    v_mfma_f32_16x16x32_bf16 v[184:187], v[60:63], v[32:35], v[184:187]
    ds_read_b128 v[48:51], v8 offset:2048
    v_mfma_f32_16x16x32_bf16 v[188:191], v[60:63], v[36:39], v[188:191]
    ds_read_b64_tr_b16 v[80:81], v12 offset:0
    v_mfma_f32_16x16x32_bf16 v[192:195], v[64:67], v[24:27], v[192:195]
    ds_read_b64_tr_b16 v[82:83], v12 offset:512
    v_mfma_f32_16x16x32_bf16 v[196:199], v[64:67], v[28:31], v[196:199]
    ds_read_b128 v[52:55], v8 offset:3072
    v_mfma_f32_16x16x32_bf16 v[200:203], v[64:67], v[32:35], v[200:203]
    ds_read_b64_tr_b16 v[84:85], v13 offset:0
    v_mfma_f32_16x16x32_bf16 v[204:207], v[64:67], v[36:39], v[204:207]
    ds_read_b64_tr_b16 v[86:87], v13 offset:512
    v_mfma_f32_16x16x32_bf16 v[208:211], v[68:71], v[24:27], v[208:211]
    s_cmp_eq_u32 s48, s53
    s_cbranch_scc1 L_ft_159
    L_ftb_160:
    v_mfma_f32_16x16x32_bf16 v[212:215], v[68:71], v[28:31], v[212:215]
    v_mfma_f32_16x16x32_bf16 v[216:219], v[68:71], v[32:35], v[216:219]
    v_mfma_f32_16x16x32_bf16 v[220:223], v[68:71], v[36:39], v[220:223]
    s_waitcnt lgkmcnt(0)
    v_mfma_f32_16x16x32_bf16 v[160:163], v[72:75], v[40:43], v[160:163]
    ds_read_b128 v[24:27], v8 offset:8192
    v_mfma_f32_16x16x32_bf16 v[164:167], v[72:75], v[44:47], v[164:167]
    ds_read_b64_tr_b16 v[56:57], v10 offset:4096
    v_mfma_f32_16x16x32_bf16 v[168:171], v[72:75], v[48:51], v[168:171]
    ds_read_b64_tr_b16 v[58:59], v10 offset:4608
    v_mfma_f32_16x16x32_bf16 v[172:175], v[72:75], v[52:55], v[172:175]
    ds_read_b128 v[28:31], v8 offset:9216
    v_mfma_f32_16x16x32_bf16 v[176:179], v[76:79], v[40:43], v[176:179]
    ds_read_b64_tr_b16 v[60:61], v11 offset:4096
    v_mfma_f32_16x16x32_bf16 v[180:183], v[76:79], v[44:47], v[180:183]
    ds_read_b64_tr_b16 v[62:63], v11 offset:4608
    v_mfma_f32_16x16x32_bf16 v[184:187], v[76:79], v[48:51], v[184:187]
    ds_read_b128 v[32:35], v8 offset:10240
    v_mfma_f32_16x16x32_bf16 v[188:191], v[76:79], v[52:55], v[188:191]
    ds_read_b64_tr_b16 v[64:65], v12 offset:4096
    v_mfma_f32_16x16x32_bf16 v[192:195], v[80:83], v[40:43], v[192:195]
    ds_read_b64_tr_b16 v[66:67], v12 offset:4608
    v_mfma_f32_16x16x32_bf16 v[196:199], v[80:83], v[44:47], v[196:199]
    ds_read_b128 v[36:39], v8 offset:11264
    v_mfma_f32_16x16x32_bf16 v[200:203], v[80:83], v[48:51], v[200:203]
    ds_read_b64_tr_b16 v[68:69], v13 offset:4096
    v_mfma_f32_16x16x32_bf16 v[204:207], v[80:83], v[52:55], v[204:207]
    ds_read_b64_tr_b16 v[70:71], v13 offset:4608
    v_mfma_f32_16x16x32_bf16 v[208:211], v[84:87], v[40:43], v[208:211]
    v_add_u32 v8, s42, v3
    v_add_u32 v10, s42, v4
    v_add_u32 v11, s42, v5
    v_mfma_f32_16x16x32_bf16 v[212:215], v[84:87], v[44:47], v[212:215]
    v_add_u32 v12, s42, v6
    v_add_u32 v13, s42, v7
    s_add_u32 s42, s42, 32768
    v_mfma_f32_16x16x32_bf16 v[216:219], v[84:87], v[48:51], v[216:219]
    s_cmp_ge_u32 s42, 163840
    s_cselect_b32 s42, 0, s42
    s_sub_u32 s48, s48, 1
    v_mfma_f32_16x16x32_bf16 v[220:223], v[84:87], v[52:55], v[220:223]
    s_sub_u32 s47, s48, 1
    s_cmp_lt_u32 s47, 22
    s_waitcnt lgkmcnt(0)
    s_cbranch_scc1 L_cbar_161
    s_cmp_lg_u32 s48, 0
    s_cbranch_scc1 L_cnb_162
    s_memrealtime s[96:97]
    s_lshl_b32 s94, s28, 4
    s_add_u32 s94, s94, s29
    s_lshl_b32 s94, s94, 2
    s_add_u32 s94, s94, s30
    s_lshl_b32 s50, s94, 13
    s_lshr_b32 s51, s50, 9
    s_xor_b32 s51, s51, s50
    s_bfe_u32 s51, s51, 0x1000d
    s_mul_i32 s51, s51, 4202496
    s_xor_b32 s50, s50, s51
    s_lshr_b32 s51, s50, 8
    s_and_b32 s51, s51, 0x2000
    s_xor_b32 s50, s50, s51
    v_readlane_b32 s51, v255, 20
    s_nop 0
    s_xor_b32 s50, s50, s51
    s_add_u32 s51, s50, 4096
    s_xor_b32 s52, s50, 0x8000
    s_xor_b32 s53, s51, 0x8000
    s_mov_b32 s54, 0xfffff000
    v_mov_b32 v14, 34816
    s_barrier
    v_mfma_f32_16x16x32_bf16 v[168:171], v[56:59], v[32:35], v[168:171]
    ds_read_b128 v[152:155], v14
    v_mfma_f32_16x16x32_bf16 v[172:175], v[56:59], v[36:39], v[172:175]
    ds_read_b128 v[40:43], v8 offset:0
    v_mfma_f32_16x16x32_bf16 v[184:187], v[60:63], v[32:35], v[184:187]
    ds_read_b64_tr_b16 v[72:73], v10 offset:0
    v_mfma_f32_16x16x32_bf16 v[188:191], v[60:63], v[36:39], v[188:191]
    ds_read_b64_tr_b16 v[74:75], v10 offset:512
    v_mfma_f32_16x16x32_bf16 v[200:203], v[64:67], v[32:35], v[200:203]
    ds_read_b128 v[44:47], v8 offset:1024
    v_mfma_f32_16x16x32_bf16 v[204:207], v[64:67], v[36:39], v[204:207]
    ds_read_b64_tr_b16 v[76:77], v11 offset:0
    v_mfma_f32_16x16x32_bf16 v[216:219], v[68:71], v[32:35], v[216:219]
    ds_read_b64_tr_b16 v[78:79], v11 offset:512
    v_mfma_f32_16x16x32_bf16 v[220:223], v[68:71], v[36:39], v[220:223]
    ds_read_b64_tr_b16 v[80:81], v12 offset:0
    v_mfma_f32_16x16x32_bf16 v[160:163], v[56:59], v[24:27], v[160:163]
    ds_read_b64_tr_b16 v[82:83], v12 offset:512
    v_mfma_f32_16x16x32_bf16 v[164:167], v[56:59], v[28:31], v[164:167]
    ds_read_b64_tr_b16 v[84:85], v13 offset:0
    v_mfma_f32_16x16x32_bf16 v[176:179], v[60:63], v[24:27], v[176:179]
    ds_read_b64_tr_b16 v[86:87], v13 offset:512
    v_mfma_f32_16x16x32_bf16 v[180:183], v[60:63], v[28:31], v[180:183]
    v_mfma_f32_16x16x32_bf16 v[192:195], v[64:67], v[24:27], v[192:195]
    v_mfma_f32_16x16x32_bf16 v[196:199], v[64:67], v[28:31], v[196:199]
    v_mfma_f32_16x16x32_bf16 v[208:211], v[68:71], v[24:27], v[208:211]
    v_mfma_f32_16x16x32_bf16 v[212:215], v[68:71], v[28:31], v[212:215]
    s_waitcnt lgkmcnt(0)
    s_and_b32 s3, s96, 0xfff
    s_bfe_u32 s46, s96, 0xc000c
    s_bfe_u64 s[98:99], s[96:97], 0xc0018
    s_bfe_u32 s47, s97, 0xc0004
    v_or3_b32 v152, v152, v153, v154
    v_or_b32 v152, v152, v155
    v_mov_b32 v144, s3
    v_mov_b32 v145, s46
    v_mov_b32 v146, s98
    v_mov_b32 v147, s47
    v_cmp_eq_u32 s[56:57], 0, v152
    v_mfma_f32_16x16x32_bf16 v[160:163], v[72:75], v[40:43], v[160:163]
    ds_read_b128 v[24:27], v8 offset:8192
    ds_read_b64_tr_b16 v[56:57], v10 offset:4096
    v_and_or_b32 v168, v168, s54, v144
    v_and_or_b32 v169, v169, s54, v145
    v_and_or_b32 v170, v170, s54, v146
    v_and_or_b32 v171, v171, s54, v147
    s_mov_b64 exec, s[56:57]
    buffer_store_dwordx4 v[168:171], v2, s[84:87], s50 offen offset:0 sc0 sc1
    s_mov_b64 exec, -1
    v_mfma_f32_16x16x32_bf16 v[164:167], v[72:75], v[44:47], v[164:167]
    ds_read_b64_tr_b16 v[58:59], v10 offset:4608
    ds_read_b128 v[28:31], v8 offset:9216
    v_mfma_f32_16x16x32_bf16 v[176:179], v[76:79], v[40:43], v[176:179]
    ds_read_b64_tr_b16 v[60:61], v11 offset:4096
    ds_read_b64_tr_b16 v[62:63], v11 offset:4608
    v_and_or_b32 v172, v172, s54, v144
    v_and_or_b32 v173, v173, s54, v145
    v_and_or_b32 v174, v174, s54, v146
    v_and_or_b32 v175, v175, s54, v147
    s_mov_b64 exec, s[56:57]
    buffer_store_dwordx4 v[172:175], v2, s[84:87], s50 offen offset:1024 sc0 sc1
    s_mov_b64 exec, -1
    v_mfma_f32_16x16x32_bf16 v[180:183], v[76:79], v[44:47], v[180:183]
    ds_read_b64_tr_b16 v[64:65], v12 offset:4096
    ds_read_b64_tr_b16 v[66:67], v12 offset:4608
    v_mfma_f32_16x16x32_bf16 v[192:195], v[80:83], v[40:43], v[192:195]
    ds_read_b64_tr_b16 v[68:69], v13 offset:4096
    ds_read_b64_tr_b16 v[70:71], v13 offset:4608
    v_and_or_b32 v184, v184, s54, v144
    v_and_or_b32 v185, v185, s54, v145
    v_and_or_b32 v186, v186, s54, v146
    v_and_or_b32 v187, v187, s54, v147
    s_mov_b64 exec, s[56:57]
    buffer_store_dwordx4 v[184:187], v2, s[84:87], s50 offen offset:2048 sc0 sc1
    s_mov_b64 exec, -1
    v_mfma_f32_16x16x32_bf16 v[196:199], v[80:83], v[44:47], v[196:199]
    v_mfma_f32_16x16x32_bf16 v[208:211], v[84:87], v[40:43], v[208:211]
    v_and_or_b32 v188, v188, s54, v144
    v_and_or_b32 v189, v189, s54, v145
    v_and_or_b32 v190, v190, s54, v146
    v_and_or_b32 v191, v191, s54, v147
    s_mov_b64 exec, s[56:57]
    buffer_store_dwordx4 v[188:191], v2, s[84:87], s50 offen offset:3072 sc0 sc1
    s_mov_b64 exec, -1
    v_mfma_f32_16x16x32_bf16 v[212:215], v[84:87], v[44:47], v[212:215]
    v_add_u32 v8, s42, v3
    v_add_u32 v10, s42, v4
    v_add_u32 v11, s42, v5
    v_add_u32 v12, s42, v6
    v_add_u32 v13, s42, v7
    s_add_u32 s42, s42, 32768
    s_cmp_ge_u32 s42, 163840
    s_cselect_b32 s42, 0, s42
    s_waitcnt lgkmcnt(0)
    s_barrier
    v_mfma_f32_16x16x32_bf16 v[160:163], v[56:59], v[24:27], v[160:163]
    ds_read_b128 v[40:43], v8 offset:0
    ds_read_b64_tr_b16 v[72:73], v10 offset:0
    v_and_or_b32 v200, v200, s54, v144
    v_and_or_b32 v201, v201, s54, v145
    v_and_or_b32 v202, v202, s54, v146
    v_and_or_b32 v203, v203, s54, v147
    s_mov_b64 exec, s[56:57]
    buffer_store_dwordx4 v[200:203], v2, s[84:87], s51 offen offset:0 sc0 sc1
    s_mov_b64 exec, -1
    v_mfma_f32_16x16x32_bf16 v[164:167], v[56:59], v[28:31], v[164:167]
    ds_read_b64_tr_b16 v[74:75], v10 offset:512
    ds_read_b128 v[44:47], v8 offset:1024
    v_mfma_f32_16x16x32_bf16 v[176:179], v[60:63], v[24:27], v[176:179]
    ds_read_b64_tr_b16 v[76:77], v11 offset:0
    ds_read_b64_tr_b16 v[78:79], v11 offset:512
    v_mfma_f32_16x16x32_bf16 v[180:183], v[60:63], v[28:31], v[180:183]
    ds_read_b64_tr_b16 v[80:81], v12 offset:0
    ds_read_b64_tr_b16 v[82:83], v12 offset:512
    v_mfma_f32_16x16x32_bf16 v[192:195], v[64:67], v[24:27], v[192:195]
    ds_read_b64_tr_b16 v[84:85], v13 offset:0
    ds_read_b64_tr_b16 v[86:87], v13 offset:512
    v_and_or_b32 v204, v204, s54, v144
    v_and_or_b32 v205, v205, s54, v145
    v_and_or_b32 v206, v206, s54, v146
    v_and_or_b32 v207, v207, s54, v147
    s_mov_b64 exec, s[56:57]
    buffer_store_dwordx4 v[204:207], v2, s[84:87], s51 offen offset:1024 sc0 sc1
    s_mov_b64 exec, -1
    v_mfma_f32_16x16x32_bf16 v[196:199], v[64:67], v[28:31], v[196:199]
    v_mfma_f32_16x16x32_bf16 v[208:211], v[68:71], v[24:27], v[208:211]
    v_mfma_f32_16x16x32_bf16 v[212:215], v[68:71], v[28:31], v[212:215]
    s_waitcnt lgkmcnt(0)
    v_mfma_f32_16x16x32_bf16 v[160:163], v[72:75], v[40:43], v[160:163]
    ds_read_b128 v[24:27], v8 offset:8192
    ds_read_b64_tr_b16 v[56:57], v10 offset:4096
    v_and_or_b32 v216, v216, s54, v144
    v_and_or_b32 v217, v217, s54, v145
    v_and_or_b32 v218, v218, s54, v146
    v_and_or_b32 v219, v219, s54, v147
    s_mov_b64 exec, s[56:57]
    buffer_store_dwordx4 v[216:219], v2, s[84:87], s51 offen offset:2048 sc0 sc1
    s_mov_b64 exec, -1
    v_mfma_f32_16x16x32_bf16 v[164:167], v[72:75], v[44:47], v[164:167]
    ds_read_b64_tr_b16 v[58:59], v10 offset:4608
    ds_read_b128 v[28:31], v8 offset:9216
    v_mfma_f32_16x16x32_bf16 v[176:179], v[76:79], v[40:43], v[176:179]
    ds_read_b64_tr_b16 v[60:61], v11 offset:4096
    ds_read_b64_tr_b16 v[62:63], v11 offset:4608
    v_mfma_f32_16x16x32_bf16 v[180:183], v[76:79], v[44:47], v[180:183]
    ds_read_b64_tr_b16 v[64:65], v12 offset:4096
    ds_read_b64_tr_b16 v[66:67], v12 offset:4608
    v_mfma_f32_16x16x32_bf16 v[192:195], v[80:83], v[40:43], v[192:195]
    ds_read_b64_tr_b16 v[68:69], v13 offset:4096
    ds_read_b64_tr_b16 v[70:71], v13 offset:4608
    v_and_or_b32 v220, v220, s54, v144
    v_and_or_b32 v221, v221, s54, v145
    v_and_or_b32 v222, v222, s54, v146
    v_and_or_b32 v223, v223, s54, v147
    s_mov_b64 exec, s[56:57]
    buffer_store_dwordx4 v[220:223], v2, s[84:87], s51 offen offset:3072 sc0 sc1
    s_mov_b64 exec, -1
    v_mfma_f32_16x16x32_bf16 v[196:199], v[80:83], v[44:47], v[196:199]
    v_mfma_f32_16x16x32_bf16 v[208:211], v[84:87], v[40:43], v[208:211]
    v_mfma_f32_16x16x32_bf16 v[212:215], v[84:87], v[44:47], v[212:215]
    v_add_u32 v8, s42, v3
    v_add_u32 v10, s42, v4
    v_add_u32 v11, s42, v5
    v_add_u32 v12, s42, v6
    v_add_u32 v13, s42, v7
    s_add_u32 s42, s42, 32768
    s_cmp_ge_u32 s42, 163840
    s_cselect_b32 s42, 0, s42
    s_waitcnt lgkmcnt(0)
    s_barrier
    v_mfma_f32_16x16x32_bf16 v[160:163], v[56:59], v[24:27], v[160:163]
    ds_read_b128 v[40:43], v8 offset:0
    ds_read_b64_tr_b16 v[72:73], v10 offset:0
    v_mfma_f32_16x16x32_bf16 v[164:167], v[56:59], v[28:31], v[164:167]
    ds_read_b64_tr_b16 v[74:75], v10 offset:512
    ds_read_b128 v[44:47], v8 offset:1024
    v_mfma_f32_16x16x32_bf16 v[176:179], v[60:63], v[24:27], v[176:179]
    ds_read_b64_tr_b16 v[76:77], v11 offset:0
    ds_read_b64_tr_b16 v[78:79], v11 offset:512
    v_mfma_f32_16x16x32_bf16 v[180:183], v[60:63], v[28:31], v[180:183]
    ds_read_b64_tr_b16 v[80:81], v12 offset:0
    ds_read_b64_tr_b16 v[82:83], v12 offset:512
    v_mfma_f32_16x16x32_bf16 v[192:195], v[64:67], v[24:27], v[192:195]
    ds_read_b64_tr_b16 v[84:85], v13 offset:0
    ds_read_b64_tr_b16 v[86:87], v13 offset:512
    v_mfma_f32_16x16x32_bf16 v[196:199], v[64:67], v[28:31], v[196:199]
    v_mfma_f32_16x16x32_bf16 v[208:211], v[68:71], v[24:27], v[208:211]
    v_mfma_f32_16x16x32_bf16 v[212:215], v[68:71], v[28:31], v[212:215]
    s_waitcnt lgkmcnt(0)
    v_mfma_f32_16x16x32_bf16 v[160:163], v[72:75], v[40:43], v[160:163]
    ds_read_b128 v[24:27], v8 offset:8192
    ds_read_b64_tr_b16 v[56:57], v10 offset:4096
    v_mfma_f32_16x16x32_bf16 v[164:167], v[72:75], v[44:47], v[164:167]
    ds_read_b64_tr_b16 v[58:59], v10 offset:4608
    ds_read_b128 v[28:31], v8 offset:9216
    v_mfma_f32_16x16x32_bf16 v[176:179], v[76:79], v[40:43], v[176:179]
    ds_read_b64_tr_b16 v[60:61], v11 offset:4096
    ds_read_b64_tr_b16 v[62:63], v11 offset:4608
    v_mfma_f32_16x16x32_bf16 v[180:183], v[76:79], v[44:47], v[180:183]
    ds_read_b64_tr_b16 v[64:65], v12 offset:4096
    ds_read_b64_tr_b16 v[66:67], v12 offset:4608
    v_mfma_f32_16x16x32_bf16 v[192:195], v[80:83], v[40:43], v[192:195]
    ds_read_b64_tr_b16 v[68:69], v13 offset:4096
    ds_read_b64_tr_b16 v[70:71], v13 offset:4608
    v_mfma_f32_16x16x32_bf16 v[196:199], v[80:83], v[44:47], v[196:199]
    v_add_u32 v8, s42, v3
    v_add_u32 v10, s42, v4
    v_add_u32 v11, s42, v5
    v_mfma_f32_16x16x32_bf16 v[208:211], v[84:87], v[40:43], v[208:211]
    v_add_u32 v12, s42, v6
    v_add_u32 v13, s42, v7
    s_add_u32 s42, s42, 32768
    v_mfma_f32_16x16x32_bf16 v[212:215], v[84:87], v[44:47], v[212:215]
    s_cmp_ge_u32 s42, 163840
    s_cselect_b32 s42, 0, s42
    s_waitcnt lgkmcnt(0)
    s_barrier
    v_mfma_f32_16x16x32_bf16 v[160:163], v[56:59], v[24:27], v[160:163]
    ds_read_b128 v[40:43], v8 offset:0
    ds_read_b64_tr_b16 v[72:73], v10 offset:0
    v_mfma_f32_16x16x32_bf16 v[164:167], v[56:59], v[28:31], v[164:167]
    ds_read_b64_tr_b16 v[74:75], v10 offset:512
    ds_read_b128 v[44:47], v8 offset:1024
    v_mfma_f32_16x16x32_bf16 v[176:179], v[60:63], v[24:27], v[176:179]
    ds_read_b64_tr_b16 v[76:77], v11 offset:0
    ds_read_b64_tr_b16 v[78:79], v11 offset:512
    v_mfma_f32_16x16x32_bf16 v[180:183], v[60:63], v[28:31], v[180:183]
    ds_read_b64_tr_b16 v[80:81], v12 offset:0
    ds_read_b64_tr_b16 v[82:83], v12 offset:512
    v_mfma_f32_16x16x32_bf16 v[192:195], v[64:67], v[24:27], v[192:195]
    ds_read_b64_tr_b16 v[84:85], v13 offset:0
    ds_read_b64_tr_b16 v[86:87], v13 offset:512
    v_mfma_f32_16x16x32_bf16 v[196:199], v[64:67], v[28:31], v[196:199]
    buffer_load_dwordx4 v[110:113], v2, s[84:87], s52 offen offset:0 sc0 sc1
    buffer_load_dwordx4 v[114:117], v2, s[84:87], s52 offen offset:1024 sc0 sc1
    buffer_load_dwordx4 v[118:121], v2, s[84:87], s52 offen offset:2048 sc0 sc1
    v_mfma_f32_16x16x32_bf16 v[208:211], v[68:71], v[24:27], v[208:211]
    buffer_load_dwordx4 v[122:125], v2, s[84:87], s52 offen offset:3072 sc0 sc1
    buffer_load_dwordx4 v[126:129], v2, s[84:87], s53 offen offset:0 sc0 sc1
    buffer_load_dwordx4 v[130:133], v2, s[84:87], s53 offen offset:1024 sc0 sc1
    v_mfma_f32_16x16x32_bf16 v[212:215], v[68:71], v[28:31], v[212:215]
    buffer_load_dwordx4 v[134:137], v2, s[84:87], s53 offen offset:2048 sc0 sc1
    buffer_load_dwordx4 v[138:141], v2, s[84:87], s53 offen offset:3072 sc0 sc1
    s_waitcnt lgkmcnt(0)
    v_mfma_f32_16x16x32_bf16 v[160:163], v[72:75], v[40:43], v[160:163]
    ds_read_b128 v[24:27], v8 offset:8192
    ds_read_b64_tr_b16 v[56:57], v10 offset:4096
    v_mfma_f32_16x16x32_bf16 v[164:167], v[72:75], v[44:47], v[164:167]
    ds_read_b64_tr_b16 v[58:59], v10 offset:4608
    ds_read_b128 v[28:31], v8 offset:9216
    v_mfma_f32_16x16x32_bf16 v[176:179], v[76:79], v[40:43], v[176:179]
    ds_read_b64_tr_b16 v[60:61], v11 offset:4096
    ds_read_b64_tr_b16 v[62:63], v11 offset:4608
    v_mfma_f32_16x16x32_bf16 v[180:183], v[76:79], v[44:47], v[180:183]
    ds_read_b64_tr_b16 v[64:65], v12 offset:4096
    ds_read_b64_tr_b16 v[66:67], v12 offset:4608
    v_mfma_f32_16x16x32_bf16 v[192:195], v[80:83], v[40:43], v[192:195]
    ds_read_b64_tr_b16 v[68:69], v13 offset:4096
    ds_read_b64_tr_b16 v[70:71], v13 offset:4608
    v_mfma_f32_16x16x32_bf16 v[196:199], v[80:83], v[44:47], v[196:199]
    v_add_u32 v8, s42, v3
    v_add_u32 v10, s42, v4
    v_add_u32 v11, s42, v5
    v_mfma_f32_16x16x32_bf16 v[208:211], v[84:87], v[40:43], v[208:211]
    v_add_u32 v12, s42, v6
    v_add_u32 v13, s42, v7
    s_add_u32 s42, s42, 32768
    v_mfma_f32_16x16x32_bf16 v[212:215], v[84:87], v[44:47], v[212:215]
    s_cmp_ge_u32 s42, 163840
    s_cselect_b32 s42, 0, s42
    s_waitcnt lgkmcnt(0)
    s_barrier
    v_mfma_f32_16x16x32_bf16 v[160:163], v[56:59], v[24:27], v[160:163]
    ds_read_b128 v[40:43], v8 offset:0
    ds_read_b64_tr_b16 v[72:73], v10 offset:0
    v_mfma_f32_16x16x32_bf16 v[164:167], v[56:59], v[28:31], v[164:167]
    ds_read_b64_tr_b16 v[74:75], v10 offset:512
    ds_read_b128 v[44:47], v8 offset:1024
    v_mfma_f32_16x16x32_bf16 v[176:179], v[60:63], v[24:27], v[176:179]
    ds_read_b64_tr_b16 v[76:77], v11 offset:0
    ds_read_b64_tr_b16 v[78:79], v11 offset:512
    v_mfma_f32_16x16x32_bf16 v[180:183], v[60:63], v[28:31], v[180:183]
    ds_read_b64_tr_b16 v[80:81], v12 offset:0
    ds_read_b64_tr_b16 v[82:83], v12 offset:512
    v_mfma_f32_16x16x32_bf16 v[192:195], v[64:67], v[24:27], v[192:195]
    ds_read_b64_tr_b16 v[84:85], v13 offset:0
    ds_read_b64_tr_b16 v[86:87], v13 offset:512
    v_mfma_f32_16x16x32_bf16 v[196:199], v[64:67], v[28:31], v[196:199]
    v_mfma_f32_16x16x32_bf16 v[208:211], v[68:71], v[24:27], v[208:211]
    v_mfma_f32_16x16x32_bf16 v[212:215], v[68:71], v[28:31], v[212:215]
    s_waitcnt lgkmcnt(0)
    v_mfma_f32_16x16x32_bf16 v[160:163], v[72:75], v[40:43], v[160:163]
    ds_read_b128 v[24:27], v8 offset:8192
    ds_read_b64_tr_b16 v[56:57], v10 offset:4096
    v_mfma_f32_16x16x32_bf16 v[164:167], v[72:75], v[44:47], v[164:167]
    ds_read_b64_tr_b16 v[58:59], v10 offset:4608
    ds_read_b128 v[28:31], v8 offset:9216
    v_mfma_f32_16x16x32_bf16 v[176:179], v[76:79], v[40:43], v[176:179]
    ds_read_b64_tr_b16 v[60:61], v11 offset:4096
    ds_read_b64_tr_b16 v[62:63], v11 offset:4608
    v_mfma_f32_16x16x32_bf16 v[180:183], v[76:79], v[44:47], v[180:183]
    ds_read_b64_tr_b16 v[64:65], v12 offset:4096
    ds_read_b64_tr_b16 v[66:67], v12 offset:4608
    v_mfma_f32_16x16x32_bf16 v[192:195], v[80:83], v[40:43], v[192:195]
    ds_read_b64_tr_b16 v[68:69], v13 offset:4096
    ds_read_b64_tr_b16 v[70:71], v13 offset:4608
    v_mfma_f32_16x16x32_bf16 v[196:199], v[80:83], v[44:47], v[196:199]
    v_add_u32 v8, s42, v3
    v_add_u32 v10, s42, v4
    v_add_u32 v11, s42, v5
    v_mfma_f32_16x16x32_bf16 v[208:211], v[84:87], v[40:43], v[208:211]
    v_add_u32 v12, s42, v6
    v_add_u32 v13, s42, v7
    s_add_u32 s42, s42, 32768
    v_mfma_f32_16x16x32_bf16 v[212:215], v[84:87], v[44:47], v[212:215]
    s_cmp_ge_u32 s42, 163840
    s_cselect_b32 s42, 0, s42
    s_waitcnt lgkmcnt(0)
    s_barrier
    v_mfma_f32_16x16x32_bf16 v[160:163], v[56:59], v[24:27], v[160:163]
    ds_read_b128 v[40:43], v8 offset:0
    ds_read_b64_tr_b16 v[72:73], v10 offset:0
    v_mfma_f32_16x16x32_bf16 v[164:167], v[56:59], v[28:31], v[164:167]
    ds_read_b64_tr_b16 v[74:75], v10 offset:512
    ds_read_b128 v[44:47], v8 offset:1024
    v_mfma_f32_16x16x32_bf16 v[176:179], v[60:63], v[24:27], v[176:179]
    ds_read_b64_tr_b16 v[76:77], v11 offset:0
    ds_read_b64_tr_b16 v[78:79], v11 offset:512
    v_mfma_f32_16x16x32_bf16 v[180:183], v[60:63], v[28:31], v[180:183]
    ds_read_b64_tr_b16 v[80:81], v12 offset:0
    ds_read_b64_tr_b16 v[82:83], v12 offset:512
    v_mfma_f32_16x16x32_bf16 v[192:195], v[64:67], v[24:27], v[192:195]
    ds_read_b64_tr_b16 v[84:85], v13 offset:0
    ds_read_b64_tr_b16 v[86:87], v13 offset:512
    v_mfma_f32_16x16x32_bf16 v[196:199], v[64:67], v[28:31], v[196:199]
    v_mfma_f32_16x16x32_bf16 v[208:211], v[68:71], v[24:27], v[208:211]
    v_mfma_f32_16x16x32_bf16 v[212:215], v[68:71], v[28:31], v[212:215]
    s_waitcnt lgkmcnt(0)
    v_mfma_f32_16x16x32_bf16 v[160:163], v[72:75], v[40:43], v[160:163]
    ds_read_b128 v[24:27], v8 offset:8192
    ds_read_b64_tr_b16 v[56:57], v10 offset:4096
    v_mfma_f32_16x16x32_bf16 v[164:167], v[72:75], v[44:47], v[164:167]
    ds_read_b64_tr_b16 v[58:59], v10 offset:4608
    ds_read_b128 v[28:31], v8 offset:9216
    v_mfma_f32_16x16x32_bf16 v[176:179], v[76:79], v[40:43], v[176:179]
    ds_read_b64_tr_b16 v[60:61], v11 offset:4096
    ds_read_b64_tr_b16 v[62:63], v11 offset:4608
    v_mfma_f32_16x16x32_bf16 v[180:183], v[76:79], v[44:47], v[180:183]
    ds_read_b64_tr_b16 v[64:65], v12 offset:4096
    ds_read_b64_tr_b16 v[66:67], v12 offset:4608
    v_mfma_f32_16x16x32_bf16 v[192:195], v[80:83], v[40:43], v[192:195]
    ds_read_b64_tr_b16 v[68:69], v13 offset:4096
    ds_read_b64_tr_b16 v[70:71], v13 offset:4608
    v_mfma_f32_16x16x32_bf16 v[196:199], v[80:83], v[44:47], v[196:199]
    v_mfma_f32_16x16x32_bf16 v[208:211], v[84:87], v[40:43], v[208:211]
    v_mfma_f32_16x16x32_bf16 v[212:215], v[84:87], v[44:47], v[212:215]
    s_waitcnt lgkmcnt(0)
    v_readlane_b32 s96, v255, 1
    v_readlane_b32 s97, v255, 2
    v_readlane_b32 s55, v255, 7
    v_writelane_b32 v255, 0, 7
    v_and_b32 v9, 15, v1
    v_bfe_u32 v14, v1, 4, 1
    v_lshlrev_b32 v9, 11, v9
    v_lshl_add_u32 v9, v14, 5, v9
    v_lshrrev_b32 v14, 5, v1
    v_lshl_add_u32 v9, v14, 4, v9
    s_and_b32 s97, s97, 0xffff
    s_add_u32 s98, s96, 0x1000000
    s_addc_u32 s99, s97, 0
    s_mov_b32 s48, 200
    s_movk_i32 s54, 0xfff
    v_mfma_f32_16x16x32_bf16 v[160:163], v[56:59], v[24:27], v[160:163]
    v_mfma_f32_16x16x32_bf16 v[164:167], v[56:59], v[28:31], v[164:167]
    s_waitcnt vmcnt(0)
    v_mfma_f32_16x16x32_bf16 v[176:179], v[60:63], v[24:27], v[176:179]
    v_xor_b32 v148, v114, v110
    v_xor_b32 v149, v115, v111
    v_xor_b32 v150, v116, v112
    v_mfma_f32_16x16x32_bf16 v[180:183], v[60:63], v[28:31], v[180:183]
    v_xor_b32 v151, v117, v113
    v_bitop3_b32 v148, v148, v118, v110 bitop3:0xf6
    v_bitop3_b32 v149, v149, v119, v111 bitop3:0xf6
    v_mfma_f32_16x16x32_bf16 v[192:195], v[64:67], v[24:27], v[192:195]
    v_bitop3_b32 v150, v150, v120, v112 bitop3:0xf6
    v_bitop3_b32 v151, v151, v121, v113 bitop3:0xf6
    v_bitop3_b32 v148, v148, v122, v110 bitop3:0xf6
    v_mfma_f32_16x16x32_bf16 v[196:199], v[64:67], v[28:31], v[196:199]
    v_bitop3_b32 v149, v149, v123, v111 bitop3:0xf6
    v_bitop3_b32 v150, v150, v124, v112 bitop3:0xf6
    v_bitop3_b32 v151, v151, v125, v113 bitop3:0xf6
    v_mfma_f32_16x16x32_bf16 v[208:211], v[68:71], v[24:27], v[208:211]
    v_bitop3_b32 v148, v148, v126, v110 bitop3:0xf6
    v_bitop3_b32 v149, v149, v127, v111 bitop3:0xf6
    v_bitop3_b32 v150, v150, v128, v112 bitop3:0xf6
    v_mfma_f32_16x16x32_bf16 v[212:215], v[68:71], v[28:31], v[212:215]
    v_bitop3_b32 v151, v151, v129, v113 bitop3:0xf6
    v_bitop3_b32 v148, v148, v130, v110 bitop3:0xf6
    v_bitop3_b32 v149, v149, v131, v111 bitop3:0xf6
    v_bitop3_b32 v150, v150, v132, v112 bitop3:0xf6
    v_bitop3_b32 v151, v151, v133, v113 bitop3:0xf6
    v_bitop3_b32 v148, v148, v134, v110 bitop3:0xf6
    v_bitop3_b32 v149, v149, v135, v111 bitop3:0xf6
    v_bitop3_b32 v150, v150, v136, v112 bitop3:0xf6
    v_bitop3_b32 v151, v151, v137, v113 bitop3:0xf6
    v_bitop3_b32 v148, v148, v138, v110 bitop3:0xf6
    v_bitop3_b32 v149, v149, v139, v111 bitop3:0xf6
    v_bitop3_b32 v150, v150, v140, v112 bitop3:0xf6
    v_bitop3_b32 v151, v151, v141, v113 bitop3:0xf6
    v_and_b32 v144, s54, v110
    v_and_b32 v146, s54, v111
    v_bfe_u32 v145, v112, 8, 4
    v_and_b32 v147, s54, v113
    v_or3_b32 v148, v148, v149, v150
    v_lshl_or_b32 v144, v146, 12, v144
    v_lshl_or_b32 v145, v147, 4, v145
    v_or_b32 v148, v148, v151
    v_lshl_or_b32 v144, v112, 24, v144
    v_lshl_or_b32 v145, v148, 20, v145
    v_cmp_lt_u64 vcc, s[96:97], v[144:145]
    v_cmp_gt_u64 s[46:47], s[98:99], v[144:145]
    s_nop 1
    s_and_b64 s[46:47], s[46:47], vcc
    s_cmp_eq_u64 s[46:47], exec
    s_cbranch_scc0 L_xp_164
L_xok_163:
    s_lshl_b32 s3, s28, 18
    s_lshl_b32 s46, s44, 17
    s_add_u32 s3, s3, s46
    s_lshl_b32 s46, s92, 16
    s_add_u32 s3, s3, s46
    s_lshl_b32 s46, s93, 8
    s_add_u32 s3, s3, s46
    s_lshl_b32 s46, s45, 7
    s_add_u32 s3, s3, s46
    s_add_u32 s46, s3, 32768
    s_mov_b64 exec, s[56:57]
    s_mov_b32 s54, 0xfffff000
    v_and_b32 v110, s54, v110
    v_and_b32 v111, s54, v111
    v_and_b32 v112, s54, v112
    v_and_b32 v113, s54, v113
    v_and_b32 v118, s54, v118
    v_and_b32 v119, s54, v119
    v_and_b32 v120, s54, v120
    v_and_b32_e64 v121, s54, v121
    v_pk_add_f32 v[160:161], v[160:161], v[110:111]
    v_pk_add_f32 v[162:163], v[162:163], v[112:113]
    v_pk_add_f32 v[176:177], v[176:177], v[118:119]
    v_pk_add_f32 v[178:179], v[178:179], v[120:121]
    v_cvt_pk_bf16_f32 v160, v160, v161
    v_cvt_pk_bf16_f32 v161, v162, v163
    v_cvt_pk_bf16_f32 v162, v176, v177
    v_cvt_pk_bf16_f32 v163, v178, v179
    v_and_b32 v114, s54, v114
    v_and_b32 v115, s54, v115
    v_and_b32 v116, s54, v116
    v_and_b32 v117, s54, v117
    v_and_b32 v122, s54, v122
    v_and_b32 v123, s54, v123
    v_and_b32 v124, s54, v124
    v_and_b32 v125, s54, v125
    v_pk_add_f32 v[164:165], v[164:165], v[114:115]
    v_pk_add_f32 v[166:167], v[166:167], v[116:117]
    v_pk_add_f32 v[180:181], v[180:181], v[122:123]
    v_pk_add_f32 v[182:183], v[182:183], v[124:125]
    v_cvt_pk_bf16_f32 v164, v164, v165
    v_cvt_pk_bf16_f32 v165, v166, v167
    v_cvt_pk_bf16_f32 v166, v180, v181
    v_cvt_pk_bf16_f32 v167, v182, v183
    v_permlane16_swap_b32 v160, v162
    v_permlane16_swap_b32 v161, v163
    v_and_b32 v126, s54, v126
    v_and_b32 v127, s54, v127
    v_and_b32 v128, s54, v128
    v_and_b32 v129, s54, v129
    v_and_b32 v134, s54, v134
    v_and_b32 v135, s54, v135
    v_and_b32 v136, s54, v136
    v_and_b32 v137, s54, v137
    v_pk_add_f32 v[192:193], v[192:193], v[126:127]
    v_pk_add_f32 v[194:195], v[194:195], v[128:129]
    v_pk_add_f32 v[208:209], v[208:209], v[134:135]
    v_pk_add_f32 v[210:211], v[210:211], v[136:137]
    v_cvt_pk_bf16_f32 v192, v192, v193
    v_cvt_pk_bf16_f32 v193, v194, v195
    v_cvt_pk_bf16_f32 v194, v208, v209
    v_cvt_pk_bf16_f32 v195, v210, v211
    v_permlane16_swap_b32 v164, v166
    v_permlane16_swap_b32 v165, v167
    buffer_store_dwordx4 v[160:163], v9, s[12:15], s3 offen offset:0
    v_and_b32 v130, s54, v130
    v_and_b32 v131, s54, v131
    v_and_b32 v132, s54, v132
    v_and_b32 v133, s54, v133
    v_and_b32 v138, s54, v138
    v_and_b32 v139, s54, v139
    v_and_b32 v140, s54, v140
    v_and_b32 v141, s54, v141
    v_pk_add_f32 v[196:197], v[196:197], v[130:131]
    v_pk_add_f32 v[198:199], v[198:199], v[132:133]
    v_pk_add_f32 v[212:213], v[212:213], v[138:139]
    v_pk_add_f32 v[214:215], v[214:215], v[140:141]
    v_cvt_pk_bf16_f32 v196, v196, v197
    v_cvt_pk_bf16_f32 v197, v198, v199
    v_cvt_pk_bf16_f32 v198, v212, v213
    v_cvt_pk_bf16_f32 v199, v214, v215
    v_permlane16_swap_b32 v192, v194
    v_permlane16_swap_b32 v193, v195
    buffer_store_dwordx4 v[164:167], v9, s[12:15], s46 offen offset:0
    s_nop 1
    v_permlane16_swap_b32 v196, v198
    v_permlane16_swap_b32 v197, v199
    buffer_store_dwordx4 v[192:195], v9, s[12:15], s3 offen offset:64
    s_nop 1
    buffer_store_dwordx4 v[196:199], v9, s[12:15], s46 offen offset:64
    s_mov_b32 s48, 1
    s_mov_b64 exec, -1
L_xno_165:
    s_cmp_eq_u32 s48, 0
    s_cselect_b32 s3, 1, 0
    s_lshl_b32 s46, s30, 2
    s_add_u32 s46, s46, 34832
    v_mov_b32 v14, s46
    v_mov_b32 v15, s3
    ds_write_b32 v14, v15
    s_waitcnt lgkmcnt(0)
L_fin_136:
    v_mov_b32 v14, 34816
    v_readlane_b32 s46, v255, 3
    s_barrier
    ds_read_b128 v[152:155], v14
    ds_read_b128 v[156:159], v14 offset:16
    s_waitcnt lgkmcnt(0)
    v_or3_b32 v152, v152, v153, v154
    v_or_b32 v152, v152, v155
    v_or3_b32 v156, v156, v157, v158
    v_or_b32 v156, v156, v159
    v_cmp_ne_u32 vcc, 0, v152
    s_cbranch_vccnz S_fail3
    s_cmp_lg_u32 s46, 0
    s_cbranch_scc1 L_h2_138
    v_cmp_ne_u32 vcc, 0, v156
    s_cbranch_vccnz S_fail4
    s_endpgm
L_xp_164:
    s_cmp_lg_u32 s55, 0
    s_cbranch_scc1 L_xok_163
    s_sub_u32 s48, s48, 1
    s_cmp_eq_u32 s48, 0
    s_cbranch_scc1 L_xno_165
    buffer_load_dwordx4 v[110:113], v2, s[84:87], s52 offen offset:0 sc0 sc1
    buffer_load_dwordx4 v[114:117], v2, s[84:87], s52 offen offset:1024 sc0 sc1
    buffer_load_dwordx4 v[118:121], v2, s[84:87], s52 offen offset:2048 sc0 sc1
    buffer_load_dwordx4 v[122:125], v2, s[84:87], s52 offen offset:3072 sc0 sc1
    buffer_load_dwordx4 v[126:129], v2, s[84:87], s53 offen offset:0 sc0 sc1
    buffer_load_dwordx4 v[130:133], v2, s[84:87], s53 offen offset:1024 sc0 sc1
    buffer_load_dwordx4 v[134:137], v2, s[84:87], s53 offen offset:2048 sc0 sc1
    buffer_load_dwordx4 v[138:141], v2, s[84:87], s53 offen offset:3072 sc0 sc1
    s_waitcnt vmcnt(0)
    v_xor_b32 v148, v114, v110
    v_xor_b32 v149, v115, v111
    v_xor_b32 v150, v116, v112
    v_xor_b32_e64 v151, v117, v113
    v_bitop3_b32 v148, v148, v118, v110 bitop3:0xf6
    v_bitop3_b32 v149, v149, v119, v111 bitop3:0xf6
    v_bitop3_b32 v150, v150, v120, v112 bitop3:0xf6
    v_bitop3_b32 v151, v151, v121, v113 bitop3:0xf6
    v_bitop3_b32 v148, v148, v122, v110 bitop3:0xf6
    v_bitop3_b32 v149, v149, v123, v111 bitop3:0xf6
    v_bitop3_b32 v150, v150, v124, v112 bitop3:0xf6
    v_bitop3_b32 v151, v151, v125, v113 bitop3:0xf6
    v_bitop3_b32 v148, v148, v126, v110 bitop3:0xf6
    v_bitop3_b32 v149, v149, v127, v111 bitop3:0xf6
    v_bitop3_b32 v150, v150, v128, v112 bitop3:0xf6
    v_bitop3_b32 v151, v151, v129, v113 bitop3:0xf6
    v_bitop3_b32 v148, v148, v130, v110 bitop3:0xf6
    v_bitop3_b32 v149, v149, v131, v111 bitop3:0xf6
    v_bitop3_b32 v150, v150, v132, v112 bitop3:0xf6
    v_bitop3_b32 v151, v151, v133, v113 bitop3:0xf6
    v_bitop3_b32 v148, v148, v134, v110 bitop3:0xf6
    v_bitop3_b32 v149, v149, v135, v111 bitop3:0xf6
    v_bitop3_b32 v150, v150, v136, v112 bitop3:0xf6
    v_bitop3_b32 v151, v151, v137, v113 bitop3:0xf6
    v_bitop3_b32 v148, v148, v138, v110 bitop3:0xf6
    v_bitop3_b32 v149, v149, v139, v111 bitop3:0xf6
    v_bitop3_b32 v150, v150, v140, v112 bitop3:0xf6
    v_bitop3_b32 v151, v151, v141, v113 bitop3:0xf6
    v_and_b32 v144, s54, v110
    v_and_b32 v146, s54, v111
    v_bfe_u32 v145, v112, 8, 4
    v_and_b32 v147, s54, v113
    v_or3_b32 v148, v148, v149, v150
    v_lshl_or_b32 v144, v146, 12, v144
    v_lshl_or_b32 v145, v147, 4, v145
    v_or_b32 v148, v148, v151
    v_lshl_or_b32 v144, v112, 24, v144
    v_lshl_or_b32 v145, v148, 20, v145
    v_cmp_lt_u64 vcc, s[96:97], v[144:145]
    v_cmp_gt_u64 s[46:47], s[98:99], v[144:145]
    s_nop 1
    s_and_b64 s[46:47], s[46:47], vcc
    s_cmp_eq_u64 s[46:47], exec
    s_cbranch_scc1 L_xok_163
    s_branch L_xp_164
S_fail1:
    s_waitcnt vmcnt(0) lgkmcnt(0)
    s_barrier
    v_readlane_b32 s46, v255, 3
    s_lshl_b32 s47, s29, 8
    s_or_b32 s47, s47, s28
    v_writelane_b32 v255, s47, 10
    v_writelane_b32 v255, 0, 11
    v_writelane_b32 v255, 1, 3
    s_cmp_lg_u32 s46, 0
    s_cbranch_scc1 S_next
    v_writelane_b32 v255, 1, 4
    s_branch S_next
S_fail2:
    s_waitcnt vmcnt(0) lgkmcnt(0)
    s_barrier
    v_readlane_b32 s46, v255, 3
    s_lshl_b32 s47, s29, 8
    s_or_b32 s47, s47, s28
    v_writelane_b32 v255, s47, 12
    v_writelane_b32 v255, 0, 13
    v_writelane_b32 v255, 2, 3
    s_cmp_lg_u32 s46, 0
    s_cbranch_scc1 S_next
    v_writelane_b32 v255, 2, 4
    s_branch S_next
S_fail3:
    s_waitcnt vmcnt(0) lgkmcnt(0)
    s_barrier
    v_readlane_b32 s46, v255, 3
    s_lshl_b32 s47, s29, 8
    s_or_b32 s47, s47, s28
    v_writelane_b32 v255, s47, 14
    v_writelane_b32 v255, 0, 15
    v_writelane_b32 v255, 3, 3
    s_cmp_lg_u32 s46, 0
    s_cbranch_scc1 S_next
    v_writelane_b32 v255, 3, 4
    s_branch S_next
S_fail4:
    s_cmp_lg_u32 s49, 1
    s_cbranch_scc1 L_c3w_166
    v_readlane_b32 s3, v255, 5
    v_mov_b32 v251, 143360
    s_nop 1
    v_mov_b32 v252, s3
    ds_write_b32 v251, v252 offset:4
    s_waitcnt lgkmcnt(0)
L_c3w_166:
    s_waitcnt vmcnt(0) lgkmcnt(0)
    s_barrier
    v_readlane_b32 s46, v255, 3
    s_lshl_b32 s47, s29, 8
    s_or_b32 s47, s47, s28
    v_writelane_b32 v255, s47, 16
    v_writelane_b32 v255, 0, 17
    v_writelane_b32 v255, 4, 3
    s_cmp_lg_u32 s46, 0
    s_cbranch_scc1 S_next
    v_writelane_b32 v255, 4, 4
    s_branch S_next
P_oproj_go:
    s_mov_b32 s55, 4
    s_branch P_oproj_g2
S_next:
    s_setprio 0
    s_nop 1
    v_readlane_b32 s3, v255, 3
    s_nop 3
    s_cmp_eq_u32 s3, 1
    s_cbranch_scc1 S_n1
    s_cmp_eq_u32 s3, 2
    s_cbranch_scc1 S_n2
    s_cmp_eq_u32 s3, 3
    s_cbranch_scc1 S_n3
S_n4:
    v_readlane_b32 s46, v255, 16
    v_readlane_b32 s47, v255, 17
    v_readlane_b32 s3, v255, 4
    s_nop 3
    s_and_b32 s28, s46, 15
    s_bfe_u32 s29, s46, 0x40008
    s_cmp_lt_u32 s47, 1
    s_cbranch_scc1 S_d4
    s_cmp_eq_u32 s3, 4
    s_cselect_b32 s3, 0, 5
    v_writelane_b32 v255, s3, 3
    s_mov_b32 s95, 1
    v_writelane_b32 v255, 1, 7
    s_branch P_ffn2_go
S_d4:
    s_add_u32 s3, s47, 1
    v_writelane_b32 v255, s3, 17
    s_xor_b32 s29, s29, 1
    s_mov_b32 s95, 0
    s_branch P_ffn2_go
S_n3:
    v_readlane_b32 s46, v255, 14
    v_readlane_b32 s47, v255, 15
    v_readlane_b32 s3, v255, 4
    s_nop 3
    s_and_b32 s28, s46, 15
    s_bfe_u32 s29, s46, 0x40008
    s_cmp_lt_u32 s47, 16
    s_cbranch_scc1 S_d3
    s_cmp_eq_u32 s3, 3
    s_cselect_b32 s3, 0, 4
    v_writelane_b32 v255, s3, 3
    s_mov_b32 s95, 1
    s_branch P_ffn2_go
S_d3:
    s_add_u32 s3, s47, 1
    v_writelane_b32 v255, s3, 15
    s_mov_b32 s29, s47
    s_branch P_ffn1_go
S_n2:
    v_readlane_b32 s46, v255, 12
    v_readlane_b32 s47, v255, 13
    v_readlane_b32 s3, v255, 4
    s_nop 3
    s_and_b32 s28, s46, 15
    s_bfe_u32 s29, s46, 0x40008
    s_cmp_lt_u32 s47, 32
    s_cbranch_scc1 S_d2
    s_cmp_eq_u32 s3, 2
    s_cselect_b32 s3, 0, 3
    v_writelane_b32 v255, s3, 3
    v_writelane_b32 v255, 1, 6
    s_branch P_ffn1_go
S_d2:
    s_add_u32 s3, s47, 1
    v_writelane_b32 v255, s3, 13
    s_lshl_b32 s3, s29, 4
    s_mov_b32 s29, s47
    s_cmp_lt_u32 s47, 16
    s_cbranch_scc1 P_oproj_go
    s_add_u32 s3, s3, s47
    s_sub_u32 s3, s3, 16
    s_lshr_b32 s28, s3, 5
    s_and_b32 s29, s3, 31
    s_branch Q_help
S_n1:
    v_readlane_b32 s46, v255, 10
    v_readlane_b32 s47, v255, 11
    v_readlane_b32 s3, v255, 4
    s_nop 3
    s_and_b32 s28, s46, 15
    s_bfe_u32 s29, s46, 0x40008
    s_cmp_lt_u32 s47, 32
    s_cbranch_scc1 S_d1
    s_cmp_eq_u32 s3, 1
    s_cselect_b32 s3, 0, 2
    v_writelane_b32 v255, s3, 3
    v_writelane_b32 v255, 1, 6
    s_branch P_oproj_go
S_d1:
    s_add_u32 s3, s47, 1
    v_writelane_b32 v255, s3, 11
    s_lshr_b32 s28, s28, 1
    s_mov_b32 s29, s47
    s_branch Q_help
L_code_end:
.section .rodata,"a"
.p2align 6
.amdhsa_kernel qa_kernel
  .amdhsa_next_free_vgpr 256
  .amdhsa_next_free_sgpr 102
  .amdhsa_accum_offset 256
  .amdhsa_group_segment_fixed_size 0
  .amdhsa_kernarg_size 88
  .amdhsa_user_sgpr_count 2
  .amdhsa_user_sgpr_kernarg_segment_ptr 1
  .amdhsa_system_sgpr_workgroup_id_x 1
.end_amdhsa_kernel
```
